```python
import torch

def _softmax(x, axis=-1):
    return torch.softmax(x, dim=axis)

def _gelu(x):
    return torch.nn.functional.gelu(x, approximate='tanh')

def _silu(x):
    return torch.nn.functional.silu(x)

def _sigmoid(x):
    return torch.sigmoid(x)

def _layernorm(x, axis=-1, eps=1e-05):
    m = x.mean(dim=axis, keepdim=True)
    v = x.var(dim=axis, keepdim=True, unbiased=False)
    return (x - m) / torch.sqrt(v + eps)

def _scatter_add(tgt, idx, src, axis=0):
    return tgt.clone().index_add_(axis, idx, src)

def _segment_sum(src, seg, n):
    out = torch.zeros((n,) + src.shape[1:], dtype=src.dtype)
    return out.index_add_(0, seg, src)

def _pad(x, pw):
    flat = tuple((v for pair in reversed(pw) for v in pair))
    return torch.nn.functional.pad(x, flat)
kernel_name = 'adaLN_cond__mha_block_cached__glu_gated_bilinear__decode'

def setup_inputs():

    _w = lambda a: (lambda t: t.to(torch.bfloat16) if t.is_floating_point() else t)(torch.as_tensor(a))

    def _A_setup():
        B, Sq, D = (2, 1, 512)
        H, Sk, Dh = (32, 32768, 128)
        return {'x': _w((lambda *s: torch.randn(*s, dtype=torch.bfloat16) * 0.05)(B, Sq, D)), 'k_cache': _w((lambda *s: torch.randn(*s, dtype=torch.bfloat16) * 0.8)(B, H, Sk, Dh)), 'v_cache': _w((lambda *s: torch.randn(*s, dtype=torch.bfloat16) * 3.2)(B, H, Sk, Dh)), 'wq': _w((lambda *s: torch.randn(*s, dtype=torch.bfloat16) * 0.8)(D, H * Dh) * D ** (-0.5)), 'wo': _w((lambda *s: torch.randn(*s, dtype=torch.bfloat16) * 3.2)(H * Dh, D) * (H * Dh) ** (-0.5))}
    _A_in = _A_setup()

    def _B_setup():
        B, S, D, F = (2, 1, 512, 1792)
        return {'x': _w((lambda *s: torch.randn(*s, dtype=torch.bfloat16) * 0.05)(B, S, D)), 'w_gate': _w((lambda *s: torch.randn(*s, dtype=torch.bfloat16) * 3.2)(D, F) * D ** (-0.5)), 'w_up': _w((lambda *s: torch.randn(*s, dtype=torch.bfloat16) * 3.2)(D, F) * D ** (-0.5)), 'w_down': _w((lambda *s: torch.randn(*s, dtype=torch.bfloat16) * 3.2)(F, D) * F ** (-0.5))}
    _B_in = _B_setup()
    return {'A_x': _A_in['x'], 'A_k_cache': _A_in['k_cache'], 'A_v_cache': _A_in['v_cache'], 'A_wq': _A_in['wq'], 'A_wo': _A_in['wo'], 'B_x': _B_in['x'], 'B_w_gate': _B_in['w_gate'], 'B_w_up': _B_in['w_up'], 'B_w_down': _B_in['w_down'], 'c': _w((lambda *s: torch.randn(*s, dtype=torch.bfloat16) * 0.2)(2, 512) * 8.0), 'w_mod': _w((lambda *s: torch.randn(*s, dtype=torch.bfloat16) * 0.2)(512, 6 * 512) * 512 ** (-0.5) * 8.0)}

def reference(A_x, A_k_cache, A_v_cache, A_wq, A_wo, B_x, B_w_gate, B_w_up, B_w_down, c, w_mod):

    def _A_ref(x, k_cache, v_cache, wq, wo):
        B, Sq, D = x.shape
        H, Dh = (32, 128)
        q = (lambda x, *d: x.permute(*d))((x @ wq).reshape(B, Sq, H, Dh), 0, 2, 1, 3)
        scores = torch.einsum('bhqd,bhkd->bhqk', q, k_cache) * Dh ** (-0.5)
        p = _softmax(scores, axis=-1)
        o = torch.einsum('bhqk,bhkd->bhqd', p, v_cache)
        return (lambda x, *d: x.permute(*d))(o, 0, 2, 1, 3).reshape(B, Sq, H * Dh) @ wo

    def _B_ref(x, w_gate, w_up, w_down):
        g = torch.einsum('bsd,df->bsf', x, w_gate)
        u = torch.einsum('bsd,df->bsf', x, w_up)
        h = g * u
        return torch.einsum('bsf,fd->bsd', h, w_down)
    x = A_x
    mod = (_silu(c) @ w_mod).reshape(c.shape[0], 6, 1, -1)
    sa, ca, ga, sb, cb, gb = (mod[:, 0].clone(), mod[:, 1].clone(), mod[:, 2].clone(), mod[:, 3].clone(), mod[:, 4].clone(), mod[:, 5].clone())
    h = _layernorm(x, axis=-1) * (1 + ca) + sa
    x = x + ga * _A_ref(h, A_k_cache, A_v_cache, A_wq, A_wo)
    h = _layernorm(x, axis=-1) * (1 + cb) + sb
    x = x + gb * _B_ref(h, B_w_gate, B_w_up, B_w_down)
    return x
```

```asm
; @launch grid=(256,1,1) block=(512,1,1) lds=151552
.amdgcn_target "amdgcn-amd-amdhsa--gfx950"
.text
.globl adaLN_cond__mha_block_cached__glu_gated_bilinear__decode_kernel
.p2align 8
.type adaLN_cond__mha_block_cached__glu_gated_bilinear__decode_kernel,@function
adaLN_cond__mha_block_cached__glu_gated_bilinear__decode_kernel:
	s_cmp_ge_u32 s2, 256
	s_cbranch_scc1 L_exit
	s_load_dwordx16 s[4:19], s[0:1], 0
	s_load_dwordx8 s[20:27], s[0:1], 64
	s_load_dwordx4 s[28:31], s[0:1], 96
	v_lshrrev_b32 v1, 6, v0
	v_and_b32 v0, 63, v0
	v_readfirstlane_b32 s3, v1
	s_bfe_u32 s34, s2, 0x20001
	s_bfe_u32 s60, s2, 0x20006
	s_lshl_b32 s60, s60, 2
	s_or_b32 s34, s34, s60
	s_bfe_u32 s60, s2, 0x10000
	s_lshl_b32 s60, s60, 4
	s_or_b32 s34, s34, s60
	s_bfe_u32 s35, s2, 0x10005
	s_bfe_u32 s60, s2, 0x20003
	s_lshl2_add_u32 s37, s34, s60
	s_lshl_b32 s60, s35, 7
	s_add_u32 s37, s37, s60
	s_cmp_ge_u32 s3, 4
	s_cbranch_scc1 L_helper
	s_lshl_b32 s60, s37, 21
	v_lshlrev_b32 v1, 4, v0
	s_mul_i32 s63, s3, 32768
	s_add_u32 s63, s63, 20480
	s_mov_b32 m0, s63
	s_lshl_b32 s64, s3, 3
	s_lshr_b32 s64, 0x9080100, s64
	s_and_b32 s65, s2, 24
	s_lshr_b32 s65, 0x19100900, s65
	s_xor_b32 s64, s64, s65
	s_mul_i32 s65, s35, 4
	s_xor_b32 s64, s64, s65
	s_and_b32 s64, s64, 31
	s_lshl_b32 s64, s64, 10
	v_add_u32 v1, s64, v1
	s_waitcnt lgkmcnt(0)
	s_add_u32 s44, s6, s60
	s_addc_u32 s45, s7, 0
	s_mov_b32 s46, 2097152
	s_mov_b32 s47, 0x20000
	s_add_u32 s48, s8, s60
	s_addc_u32 s49, s9, 0
	buffer_load_dwordx4 v1, s[44:47], 0 offen nt lds
	s_add_u32 m0, m0, 0x400
	v_xor_b32 v1, 0x800, v1
	buffer_load_dwordx4 v1, s[44:47], 0 offen nt lds
	s_add_u32 m0, m0, 0x400
	v_xor_b32 v1, 0x1800, v1
	buffer_load_dwordx4 v1, s[44:47], 0 offen nt lds
	s_add_u32 m0, m0, 0x400
	v_xor_b32 v1, 0x800, v1
	buffer_load_dwordx4 v1, s[44:47], 0 offen nt lds
	s_add_u32 m0, m0, 0x400
	v_xor_b32 v1, 0x5800, v1
	buffer_load_dwordx4 v1, s[44:47], 0 offen nt lds
	s_add_u32 m0, m0, 0x400
	v_xor_b32 v1, 0x800, v1
	buffer_load_dwordx4 v1, s[44:47], 0 offen nt lds
	s_add_u32 m0, m0, 0x400
	v_xor_b32 v1, 0x1800, v1
	s_setprio 1
	v_mov_b32 v11, 0xfe967699
	v_mov_b32 v8, 0
	v_mov_b32 v16, 0
	v_mov_b32 v17, 0
	v_mov_b32 v18, 0
	v_mov_b32 v19, 0
	v_mov_b32 v20, 0
	v_mov_b32 v21, 0
	v_mov_b32 v22, 0
	v_mov_b32 v23, 0
	v_and_b32 v9, 15, v0
	v_lshlrev_b32 v9, 4, v9
	v_and_b32 v2, 48, v0
	s_lshl_b32 s61, s3, 12
	s_add_u32 s61, s61, 4736
	v_add_u32 v2, s61, v2
	v_lshl_add_u32 v0, v0, 4, s63
	s_lshl_b32 s61, s3, 2
	v_mov_b32 v10, s61
	v_mov_b32 v3, 2
	v_mov_b32 v4, 172032
	ds_write_b32 v10, v4 offset:3072
	ds_write_b32 v10, v3 offset:3088
	ds_write_b32 v10, v8 offset:3104
	ds_write_b32 v8, v8 offset:3120
	s_waitcnt lgkmcnt(0)
	s_barrier
	s_waitcnt vmcnt(5)
	buffer_load_dwordx4 v1, s[44:47], 0 offen nt lds
	s_add_u32 m0, m0, 0x400
	v_xor_b32 v1, 0x800, v1
	s_waitcnt vmcnt(5)
	buffer_load_dwordx4 v1, s[44:47], 0 offen nt lds
	s_add_u32 m0, m0, 0x400
	v_xor_b32 v1, 0x5800, v1
	v_add_u32 v1, 0x8000, v1
	s_waitcnt vmcnt(5)
	buffer_load_dwordx4 v1, s[44:47], 0 offen nt lds
	s_add_u32 m0, m0, 0x400
	v_xor_b32 v1, 0x800, v1
	s_waitcnt vmcnt(5)
	buffer_load_dwordx4 v1, s[44:47], 0 offen nt lds
	s_add_u32 m0, m0, 0x400
	v_xor_b32 v1, 0x1800, v1
	s_waitcnt vmcnt(5)
	buffer_load_dwordx4 v1, s[44:47], 0 offen nt lds
	s_add_u32 m0, m0, 0x400
	v_xor_b32 v1, 0x800, v1
	s_waitcnt vmcnt(5)
	buffer_load_dwordx4 v1, s[44:47], 0 offen nt lds
	s_add_u32 m0, m0, 0x400
	v_xor_b32 v1, 0x5800, v1
	s_waitcnt vmcnt(5)
	buffer_load_dwordx4 v1, s[44:47], 0 offen nt lds
	s_add_u32 m0, m0, 0x400
	v_xor_b32 v1, 0x800, v1
	s_waitcnt vmcnt(5)
	buffer_load_dwordx4 v1, s[44:47], 0 offen nt lds
	s_add_u32 m0, m0, 0x400
	v_xor_b32 v1, 0x1800, v1
	s_waitcnt vmcnt(5)
	buffer_load_dwordx4 v1, s[44:47], 0 offen nt lds
	s_add_u32 m0, m0, 0x400
	v_xor_b32 v1, 0x800, v1
	s_waitcnt vmcnt(5)
	buffer_load_dwordx4 v1, s[44:47], 0 offen nt lds
	s_add_u32 m0, m0, 0x400
	v_xor_b32 v1, 0x5800, v1
	v_add_u32 v1, 0x8000, v1
	s_waitcnt vmcnt(5)
	buffer_load_dwordx4 v1, s[44:47], 0 offen nt lds
	s_add_u32 m0, m0, 0x400
	v_xor_b32 v1, 0x800, v1
	s_waitcnt vmcnt(5)
	buffer_load_dwordx4 v1, s[44:47], 0 offen nt lds
	s_add_u32 m0, m0, 0x400
	v_xor_b32 v1, 0x1800, v1
	s_waitcnt vmcnt(5)
	buffer_load_dwordx4 v1, s[44:47], 0 offen nt lds
	s_add_u32 m0, m0, 0x400
	v_xor_b32 v1, 0x800, v1
	s_waitcnt vmcnt(5)
	buffer_load_dwordx4 v1, s[44:47], 0 offen nt lds
	s_add_u32 m0, m0, 0x400
	v_xor_b32 v1, 0x5800, v1
	s_waitcnt vmcnt(5)
	buffer_load_dwordx4 v1, s[44:47], 0 offen nt lds
	s_add_u32 m0, m0, 0x400
	v_xor_b32 v1, 0x800, v1
	s_waitcnt vmcnt(5)
	buffer_load_dwordx4 v1, s[44:47], 0 offen nt lds
	s_add_u32 m0, m0, 0x400
	v_xor_b32 v1, 0x1800, v1
	s_waitcnt vmcnt(5)
	buffer_load_dwordx4 v1, s[44:47], 0 offen nt lds
	s_add_u32 m0, m0, 0x400
	v_xor_b32 v1, 0x800, v1
	s_waitcnt vmcnt(5)
	buffer_load_dwordx4 v1, s[44:47], 0 offen nt lds
	s_add_u32 m0, m0, 0x400
	v_xor_b32 v1, 0x5800, v1
	v_add_u32 v1, 0x8000, v1
	s_waitcnt vmcnt(5)
	buffer_load_dwordx4 v1, s[44:47], 0 offen nt lds
	s_add_u32 m0, m0, 0x400
	v_xor_b32 v1, 0x800, v1
	s_waitcnt vmcnt(5)
	buffer_load_dwordx4 v1, s[44:47], 0 offen nt lds
	s_add_u32 m0, m0, 0x400
	v_xor_b32 v1, 0x1800, v1
	s_waitcnt vmcnt(5)
	buffer_load_dwordx4 v1, s[44:47], 0 offen nt lds
	s_add_u32 m0, m0, 0x400
	v_xor_b32 v1, 0x800, v1
	s_waitcnt vmcnt(5)
	buffer_load_dwordx4 v1, s[44:47], 0 offen nt lds
	s_add_u32 m0, m0, 0x400
	v_xor_b32 v1, 0x5800, v1
	s_waitcnt vmcnt(5)
	buffer_load_dwordx4 v1, s[44:47], 0 offen nt lds
	s_add_u32 m0, m0, 0x400
	v_xor_b32 v1, 0x800, v1
	s_waitcnt vmcnt(5)
	buffer_load_dwordx4 v1, s[44:47], 0 offen nt lds
	s_add_u32 m0, m0, 0x400
	v_xor_b32 v1, 0x1800, v1
	s_waitcnt vmcnt(5)
	buffer_load_dwordx4 v1, s[44:47], 0 offen nt lds
	s_add_u32 m0, m0, 0x400
	v_xor_b32 v1, 0x800, v1
	s_waitcnt vmcnt(5)
	buffer_load_dwordx4 v1, s[44:47], 0 offen nt lds
	v_xor_b32 v1, 0x5800, v1
	v_add_u32 v1, 0x8000, v1
	s_waitcnt vmcnt(5)
	buffer_load_dwordx4 v[56:59], v1, s[44:47], 0 offen nt
	v_xor_b32 v1, 0x800, v1
	s_waitcnt vmcnt(5)
	buffer_load_dwordx4 v[60:63], v1, s[44:47], 0 offen nt
	v_xor_b32 v1, 0x1800, v1
	s_waitcnt vmcnt(5)
	buffer_load_dwordx4 v[64:67], v1, s[44:47], 0 offen nt
	v_xor_b32 v1, 0x800, v1
	s_waitcnt vmcnt(5)
	buffer_load_dwordx4 v[68:71], v1, s[44:47], 0 offen nt
	v_xor_b32 v1, 0x5800, v1
	s_waitcnt vmcnt(5)
	buffer_load_dwordx4 v[72:75], v1, s[44:47], 0 offen nt
	v_xor_b32 v1, 0x800, v1
	s_waitcnt vmcnt(5)
	buffer_load_dwordx4 v[76:79], v1, s[44:47], 0 offen nt
	v_xor_b32 v1, 0x1800, v1
	s_waitcnt vmcnt(5)
	buffer_load_dwordx4 v[80:83], v1, s[44:47], 0 offen nt
	v_xor_b32 v1, 0x800, v1
	s_waitcnt vmcnt(5)
	buffer_load_dwordx4 v[84:87], v1, s[44:47], 0 offen nt
	v_xor_b32 v1, 0x5800, v1
	v_add_u32 v1, 0x8000, v1
	s_waitcnt vmcnt(5)
	buffer_load_dwordx4 v[88:91], v1, s[44:47], 0 offen nt
	v_xor_b32 v1, 0x800, v1
	s_waitcnt vmcnt(5)
	buffer_load_dwordx4 v[92:95], v1, s[44:47], 0 offen nt
	v_xor_b32 v1, 0x1800, v1
	s_waitcnt vmcnt(5)
	buffer_load_dwordx4 v[96:99], v1, s[44:47], 0 offen nt
	v_xor_b32 v1, 0x800, v1
	s_waitcnt vmcnt(5)
	buffer_load_dwordx4 v[100:103], v1, s[44:47], 0 offen nt
	v_xor_b32 v1, 0x5800, v1
	s_waitcnt vmcnt(5)
	buffer_load_dwordx4 v[104:107], v1, s[44:47], 0 offen nt
	v_xor_b32 v1, 0x800, v1
	s_waitcnt vmcnt(5)
	buffer_load_dwordx4 v[108:111], v1, s[44:47], 0 offen nt
	v_xor_b32 v1, 0x1800, v1
	s_waitcnt vmcnt(5)
	buffer_load_dwordx4 v[112:115], v1, s[44:47], 0 offen nt
	v_xor_b32 v1, 0x800, v1
	s_waitcnt vmcnt(5)
	buffer_load_dwordx4 v[116:119], v1, s[44:47], 0 offen nt
	v_xor_b32 v1, 0x5800, v1
	v_add_u32 v1, 0x8000, v1
	s_waitcnt vmcnt(5)
	buffer_load_dwordx4 v[120:123], v1, s[44:47], 0 offen nt
	v_xor_b32 v1, 0x800, v1
	s_waitcnt vmcnt(5)
	buffer_load_dwordx4 v[124:127], v1, s[44:47], 0 offen nt
	v_xor_b32 v1, 0x1800, v1
	s_waitcnt vmcnt(5)
	buffer_load_dwordx4 v[128:131], v1, s[44:47], 0 offen nt
	v_xor_b32 v1, 0x800, v1
	s_waitcnt vmcnt(5)
	buffer_load_dwordx4 v[132:135], v1, s[44:47], 0 offen nt
	v_xor_b32 v1, 0x5800, v1
	s_waitcnt vmcnt(5)
	buffer_load_dwordx4 v[136:139], v1, s[44:47], 0 offen nt
	v_xor_b32 v1, 0x800, v1
	s_waitcnt vmcnt(5)
	buffer_load_dwordx4 v[140:143], v1, s[44:47], 0 offen nt
	v_xor_b32 v1, 0x1800, v1
	s_waitcnt vmcnt(5)
	buffer_load_dwordx4 v[144:147], v1, s[44:47], 0 offen nt
	v_xor_b32 v1, 0x800, v1
	s_waitcnt vmcnt(5)
	buffer_load_dwordx4 v[148:151], v1, s[44:47], 0 offen nt
	v_xor_b32 v1, 0x5800, v1
	v_add_u32 v1, 0x8000, v1
	s_waitcnt vmcnt(5)
	buffer_load_dwordx4 v[152:155], v1, s[44:47], 0 offen nt
	v_xor_b32 v1, 0x800, v1
	s_waitcnt vmcnt(5)
	buffer_load_dwordx4 v[156:159], v1, s[44:47], 0 offen nt
	v_xor_b32 v1, 0x1800, v1
	s_waitcnt vmcnt(5)
	buffer_load_dwordx4 v[160:163], v1, s[44:47], 0 offen nt
	v_xor_b32 v1, 0x800, v1
	s_waitcnt vmcnt(5)
	buffer_load_dwordx4 v[164:167], v1, s[44:47], 0 offen nt
	v_xor_b32 v1, 0x5800, v1
	s_waitcnt vmcnt(5)
	buffer_load_dwordx4 v[168:171], v1, s[44:47], 0 offen nt
	v_xor_b32 v1, 0x800, v1
	s_waitcnt vmcnt(5)
	buffer_load_dwordx4 v[172:175], v1, s[44:47], 0 offen nt
	v_xor_b32 v1, 0x1800, v1
	s_waitcnt vmcnt(5)
	buffer_load_dwordx4 v[176:179], v1, s[44:47], 0 offen nt
	v_xor_b32 v1, 0x800, v1
	s_waitcnt vmcnt(5)
	buffer_load_dwordx4 v[180:183], v1, s[44:47], 0 offen nt
	v_xor_b32 v1, 0x5800, v1
	v_add_u32 v1, 0x8000, v1
	s_waitcnt vmcnt(5)
	buffer_load_dwordx4 v[184:187], v1, s[44:47], 0 offen nt
	v_xor_b32 v1, 0x800, v1
	s_waitcnt vmcnt(5)
	buffer_load_dwordx4 v[188:191], v1, s[44:47], 0 offen nt
	v_xor_b32 v1, 0x1800, v1
	s_waitcnt vmcnt(5)
	buffer_load_dwordx4 v[192:195], v1, s[44:47], 0 offen nt
	v_xor_b32 v1, 0x800, v1
	s_waitcnt vmcnt(5)
	buffer_load_dwordx4 v[196:199], v1, s[44:47], 0 offen nt
	v_xor_b32 v1, 0x5800, v1
	s_waitcnt vmcnt(5)
	buffer_load_dwordx4 v[200:203], v1, s[44:47], 0 offen nt
	v_xor_b32 v1, 0x800, v1
	s_waitcnt vmcnt(5)
	buffer_load_dwordx4 v[204:207], v1, s[44:47], 0 offen nt
	v_xor_b32 v1, 0x1800, v1
	s_waitcnt vmcnt(5)
	buffer_load_dwordx4 v[208:211], v1, s[44:47], 0 offen nt
	v_xor_b32 v1, 0x800, v1
	s_waitcnt vmcnt(5)
	buffer_load_dwordx4 v[212:215], v1, s[44:47], 0 offen nt
	v_xor_b32 v1, 0x5800, v1
	v_add_u32 v1, 0x8000, v1
	s_waitcnt vmcnt(5)
	buffer_load_dwordx4 v[216:219], v1, s[44:47], 0 offen nt
	v_xor_b32 v1, 0x800, v1
	s_waitcnt vmcnt(5)
	buffer_load_dwordx4 v[220:223], v1, s[44:47], 0 offen nt
	v_xor_b32 v1, 0x1800, v1
	s_waitcnt vmcnt(5)
	buffer_load_dwordx4 v[224:227], v1, s[44:47], 0 offen nt
	v_xor_b32 v1, 0x800, v1
	s_waitcnt vmcnt(5)
	buffer_load_dwordx4 v[228:231], v1, s[44:47], 0 offen nt
	v_xor_b32 v1, 0x5800, v1
	s_waitcnt vmcnt(5)
	buffer_load_dwordx4 v[232:235], v1, s[44:47], 0 offen nt
	v_xor_b32 v1, 0x800, v1
	s_waitcnt vmcnt(5)
	buffer_load_dwordx4 v[236:239], v1, s[44:47], 0 offen nt
	v_xor_b32 v1, 0x1800, v1
	s_waitcnt vmcnt(5)
	buffer_load_dwordx4 v[240:243], v1, s[44:47], 0 offen nt
	v_xor_b32 v1, 0x800, v1
	s_waitcnt vmcnt(5)
	buffer_load_dwordx4 v[244:247], v1, s[44:47], 0 offen nt
	v_xor_b32 v1, 0x5800, v1
	v_add_u32 v1, 0x8000, v1
	s_waitcnt vmcnt(5)
	buffer_load_dwordx4 v[24:27], v1, s[44:47], 0 offen nt
	v_xor_b32 v1, 0x800, v1
	s_waitcnt vmcnt(5)
	buffer_load_dwordx4 v[28:31], v1, s[44:47], 0 offen nt
	v_xor_b32 v1, 0x1800, v1
	s_waitcnt vmcnt(5)
	buffer_load_dwordx4 v[32:35], v1, s[44:47], 0 offen nt
	v_xor_b32 v1, 0x800, v1
	s_waitcnt vmcnt(5)
	buffer_load_dwordx4 v[36:39], v1, s[44:47], 0 offen nt
	v_xor_b32 v1, 0x5800, v1
	s_waitcnt vmcnt(5)
	buffer_load_dwordx4 v[40:43], v1, s[44:47], 0 offen nt
	v_xor_b32 v1, 0x800, v1
	s_waitcnt vmcnt(5)
	buffer_load_dwordx4 v[44:47], v1, s[44:47], 0 offen nt
	v_xor_b32 v1, 0x1800, v1
	s_mov_b32 s67, 172032
	s_mov_b32 s62, 53
	s_mov_b32 s60, 0
	s_mov_b32 s68, 0
L_s_q:
	ds_read_b32 v3, v8 offset:3120
	ds_read_b128 v[12:15], v9 offset:0
	s_waitcnt lgkmcnt(0)
	v_cmp_eq_u32 vcc, 0, v3
	s_cbranch_vccz L_s_go
	s_add_u32 s68, s68, 1
	s_cmp_lt_u32 s68, 1048576
	s_cbranch_scc1 L_s_q
L_s_go:
	s_waitcnt vmcnt(6)
	s_branch L_k2
.p2align 4
L_k0:
	s_waitcnt vmcnt(5)
	v_dot2_f32_bf16 v252, v24, v12, 0
	v_dot2_f32_bf16 v252, v25, v13, v252
	v_dot2_f32_bf16 v252, v26, v14, v252
	v_dot2_f32_bf16 v252, v27, v15, v252
	s_nop 2
	v_add_f32_dpp v252, v252, v252 row_ror:8 row_mask:0xf bank_mask:0xf
	s_nop 1
	v_add_f32_dpp v252, v252, v252 row_ror:4 row_mask:0xf bank_mask:0xf
	s_nop 1
	v_add_f32_dpp v252, v252, v252 row_ror:2 row_mask:0xf bank_mask:0xf
	s_nop 1
	v_add_f32_dpp v252, v252, v252 row_ror:1 row_mask:0xf bank_mask:0xf
	v_cvt_pk_bf16_f32 v252, 0, v252
	v_mul_f32 v252, 0x3db504f3, v252
	s_waitcnt vmcnt(4)
	s_add_u32 s67, s67, 0x1000
	v_mov_b32 v3, s67
	ds_write_b32 v10, v3 offset:3072
	v_dot2_f32_bf16 v253, v28, v12, 0
	v_dot2_f32_bf16 v253, v29, v13, v253
	v_dot2_f32_bf16 v253, v30, v14, v253
	v_dot2_f32_bf16 v253, v31, v15, v253
	s_nop 2
	v_add_f32_dpp v253, v253, v253 row_ror:8 row_mask:0xf bank_mask:0xf
	s_nop 1
	v_add_f32_dpp v253, v253, v253 row_ror:4 row_mask:0xf bank_mask:0xf
	s_nop 1
	v_add_f32_dpp v253, v253, v253 row_ror:2 row_mask:0xf bank_mask:0xf
	s_nop 1
	v_add_f32_dpp v253, v253, v253 row_ror:1 row_mask:0xf bank_mask:0xf
	v_cvt_pk_bf16_f32 v253, 0, v253
	v_mul_f32 v253, 0x3db504f3, v253
	v_max3_f32 v11, v11, v252, v253
	v_cvt_pk_bf16_f32 v248, v252, v253
	s_waitcnt vmcnt(3)
	v_dot2_f32_bf16 v252, v32, v12, 0
	v_dot2_f32_bf16 v252, v33, v13, v252
	v_dot2_f32_bf16 v252, v34, v14, v252
	v_dot2_f32_bf16 v252, v35, v15, v252
	s_nop 2
	v_add_f32_dpp v252, v252, v252 row_ror:8 row_mask:0xf bank_mask:0xf
	s_nop 1
	v_add_f32_dpp v252, v252, v252 row_ror:4 row_mask:0xf bank_mask:0xf
	s_nop 1
	v_add_f32_dpp v252, v252, v252 row_ror:2 row_mask:0xf bank_mask:0xf
	s_nop 1
	v_add_f32_dpp v252, v252, v252 row_ror:1 row_mask:0xf bank_mask:0xf
	v_cvt_pk_bf16_f32 v252, 0, v252
	v_mul_f32 v252, 0x3db504f3, v252
	s_waitcnt vmcnt(2)
	buffer_load_dwordx4 v[48:51], v1, s[44:47], 0 offen nt
	v_xor_b32 v1, 0x800, v1
	s_add_u32 s67, s67, 0x1000
	v_mov_b32 v3, s67
	ds_write_b32 v10, v3 offset:3072
	v_dot2_f32_bf16 v253, v36, v12, 0
	v_dot2_f32_bf16 v253, v37, v13, v253
	v_dot2_f32_bf16 v253, v38, v14, v253
	v_dot2_f32_bf16 v253, v39, v15, v253
	s_nop 2
	v_add_f32_dpp v253, v253, v253 row_ror:8 row_mask:0xf bank_mask:0xf
	s_nop 1
	v_add_f32_dpp v253, v253, v253 row_ror:4 row_mask:0xf bank_mask:0xf
	s_nop 1
	v_add_f32_dpp v253, v253, v253 row_ror:2 row_mask:0xf bank_mask:0xf
	s_nop 1
	v_add_f32_dpp v253, v253, v253 row_ror:1 row_mask:0xf bank_mask:0xf
	v_cvt_pk_bf16_f32 v253, 0, v253
	v_mul_f32 v253, 0x3db504f3, v253
	v_max3_f32 v11, v11, v252, v253
	v_cvt_pk_bf16_f32 v249, v252, v253
	s_waitcnt vmcnt(2)
	buffer_load_dwordx4 v[52:55], v1, s[44:47], 0 offen nt
	v_xor_b32 v1, 0x5800, v1
	v_add_u32 v1, 0x8000, v1
	v_dot2_f32_bf16 v252, v40, v12, 0
	v_dot2_f32_bf16 v252, v41, v13, v252
	v_dot2_f32_bf16 v252, v42, v14, v252
	v_dot2_f32_bf16 v252, v43, v15, v252
	s_nop 2
	v_add_f32_dpp v252, v252, v252 row_ror:8 row_mask:0xf bank_mask:0xf
	s_nop 1
	v_add_f32_dpp v252, v252, v252 row_ror:4 row_mask:0xf bank_mask:0xf
	s_nop 1
	v_add_f32_dpp v252, v252, v252 row_ror:2 row_mask:0xf bank_mask:0xf
	s_nop 1
	v_add_f32_dpp v252, v252, v252 row_ror:1 row_mask:0xf bank_mask:0xf
	v_cvt_pk_bf16_f32 v252, 0, v252
	v_mul_f32 v252, 0x3db504f3, v252
	s_waitcnt vmcnt(2)
	s_sub_u32 s62, s62, 1
	s_cbranch_scc1 L_c_1
L_c_1_b:
	buffer_load_dwordx4 v[24:27], v1, s[44:47], 0 offen nt
	v_xor_b32 v1, 0x800, v1
	buffer_load_dwordx4 v[28:31], v1, s[44:47], 0 offen nt
	v_xor_b32 v1, 0x1800, v1
	s_add_u32 s67, s67, 0x1000
	v_mov_b32 v3, s67
	ds_write_b32 v10, v3 offset:3072
	v_dot2_f32_bf16 v253, v44, v12, 0
	v_dot2_f32_bf16 v253, v45, v13, v253
	v_dot2_f32_bf16 v253, v46, v14, v253
	v_dot2_f32_bf16 v253, v47, v15, v253
	s_nop 2
	v_add_f32_dpp v253, v253, v253 row_ror:8 row_mask:0xf bank_mask:0xf
	s_nop 1
	v_add_f32_dpp v253, v253, v253 row_ror:4 row_mask:0xf bank_mask:0xf
	s_nop 1
	v_add_f32_dpp v253, v253, v253 row_ror:2 row_mask:0xf bank_mask:0xf
	s_nop 1
	v_add_f32_dpp v253, v253, v253 row_ror:1 row_mask:0xf bank_mask:0xf
	v_cvt_pk_bf16_f32 v253, 0, v253
	v_mul_f32 v253, 0x3db504f3, v253
	v_max3_f32 v11, v11, v252, v253
	v_cvt_pk_bf16_f32 v250, v252, v253
	s_waitcnt vmcnt(3)
	buffer_load_dwordx4 v[32:35], v1, s[44:47], 0 offen nt
	v_xor_b32 v1, 0x800, v1
	buffer_load_dwordx4 v[36:39], v1, s[44:47], 0 offen nt
	v_xor_b32 v1, 0x5800, v1
	v_dot2_f32_bf16 v252, v48, v12, 0
	v_dot2_f32_bf16 v252, v49, v13, v252
	v_dot2_f32_bf16 v252, v50, v14, v252
	v_dot2_f32_bf16 v252, v51, v15, v252
	s_nop 2
	v_add_f32_dpp v252, v252, v252 row_ror:8 row_mask:0xf bank_mask:0xf
	s_nop 1
	v_add_f32_dpp v252, v252, v252 row_ror:4 row_mask:0xf bank_mask:0xf
	s_nop 1
	v_add_f32_dpp v252, v252, v252 row_ror:2 row_mask:0xf bank_mask:0xf
	s_nop 1
	v_add_f32_dpp v252, v252, v252 row_ror:1 row_mask:0xf bank_mask:0xf
	v_cvt_pk_bf16_f32 v252, 0, v252
	v_mul_f32 v252, 0x3db504f3, v252
	s_waitcnt vmcnt(4)
	buffer_load_dwordx4 v[40:43], v1, s[44:47], 0 offen nt
	v_xor_b32 v1, 0x800, v1
	buffer_load_dwordx4 v[44:47], v1, s[44:47], 0 offen nt
	v_xor_b32 v1, 0x1800, v1
	s_add_u32 s67, s67, 0x1000
	v_mov_b32 v3, s67
	ds_write_b32 v10, v3 offset:3072
	ds_read_b32 v9, v10 offset:3088
	s_sub_u32 s61, s60, 24
	s_cmp_lt_u32 s61, 16
	s_cbranch_scc0 L_k0_nl
	ds_read_b128 v[48:51], v0
L_k0_nl:
	v_dot2_f32_bf16 v253, v52, v12, 0
	v_dot2_f32_bf16 v253, v53, v13, v253
	v_dot2_f32_bf16 v253, v54, v14, v253
	v_dot2_f32_bf16 v253, v55, v15, v253
	s_nop 2
	v_add_f32_dpp v253, v253, v253 row_ror:8 row_mask:0xf bank_mask:0xf
	s_nop 1
	v_add_f32_dpp v253, v253, v253 row_ror:4 row_mask:0xf bank_mask:0xf
	s_nop 1
	v_add_f32_dpp v253, v253, v253 row_ror:2 row_mask:0xf bank_mask:0xf
	s_nop 1
	v_add_f32_dpp v253, v253, v253 row_ror:1 row_mask:0xf bank_mask:0xf
	v_cvt_pk_bf16_f32 v253, 0, v253
	v_mul_f32 v253, 0x3db504f3, v253
	v_max3_f32 v11, v11, v252, v253
	v_cvt_pk_bf16_f32 v251, v252, v253
	s_mov_b32 exec_lo, 0x10001
	s_mov_b32 exec_hi, 0x10001
	ds_write_b128 v2, v[248:251]
	s_mov_b64 exec, -1
	v_add_u32 v2, 64, v2
	s_waitcnt lgkmcnt(1)
	v_readfirstlane_b32 s61, v9
	s_cmp_lt_u32 s60, 40
	s_cbranch_scc1 L_c_2
L_c_2_b:
	s_add_u32 s60, s60, 1
	s_cmp_eq_u32 s60, 54
	s_cbranch_scc1 L_k0_sw
	s_cmp_eq_u32 s61, 0
	s_cbranch_scc1 L_k0
	s_cmp_eq_u32 s61, 2
	s_cbranch_scc1 L_k2
	s_cmp_eq_u32 s61, 1
	s_cbranch_scc1 L_k1
	s_cmp_eq_u32 s61, 3
	s_cbranch_scc1 L_k3
	s_cmp_eq_u32 s61, 4
	s_cbranch_scc1 L_k4
	s_branch L_kT
L_k0_sw:
	s_call_b64 s[42:43], L_max
	s_cmp_eq_u32 s61, 0
	s_cbranch_scc1 L_v0
	s_cmp_eq_u32 s61, 2
	s_cbranch_scc1 L_v2
	s_cmp_eq_u32 s61, 1
	s_cbranch_scc1 L_v1
	s_cmp_eq_u32 s61, 3
	s_cbranch_scc1 L_v3
	s_cmp_eq_u32 s61, 4
	s_cbranch_scc1 L_v4
	s_branch L_vT
.p2align 4
L_k1:
	s_waitcnt vmcnt(5)
	v_dot2_f32_bf16 v252, v24, v12, 0
	v_dot2_f32_bf16 v252, v25, v13, v252
	v_dot2_f32_bf16 v252, v26, v14, v252
	v_dot2_f32_bf16 v252, v27, v15, v252
	s_nop 2
	v_add_f32_dpp v252, v252, v252 row_ror:8 row_mask:0xf bank_mask:0xf
	s_nop 1
	v_add_f32_dpp v252, v252, v252 row_ror:4 row_mask:0xf bank_mask:0xf
	s_nop 1
	v_add_f32_dpp v252, v252, v252 row_ror:2 row_mask:0xf bank_mask:0xf
	s_nop 1
	v_add_f32_dpp v252, v252, v252 row_ror:1 row_mask:0xf bank_mask:0xf
	v_cvt_pk_bf16_f32 v252, 0, v252
	v_mul_f32 v252, 0x3db504f3, v252
	s_waitcnt vmcnt(4)
	s_add_u32 s67, s67, 0x1000
	v_mov_b32 v3, s67
	ds_write_b32 v10, v3 offset:3072
	v_dot2_f32_bf16 v253, v28, v12, 0
	v_dot2_f32_bf16 v253, v29, v13, v253
	v_dot2_f32_bf16 v253, v30, v14, v253
	v_dot2_f32_bf16 v253, v31, v15, v253
	s_nop 2
	v_add_f32_dpp v253, v253, v253 row_ror:8 row_mask:0xf bank_mask:0xf
	s_nop 1
	v_add_f32_dpp v253, v253, v253 row_ror:4 row_mask:0xf bank_mask:0xf
	s_nop 1
	v_add_f32_dpp v253, v253, v253 row_ror:2 row_mask:0xf bank_mask:0xf
	s_nop 1
	v_add_f32_dpp v253, v253, v253 row_ror:1 row_mask:0xf bank_mask:0xf
	v_cvt_pk_bf16_f32 v253, 0, v253
	v_mul_f32 v253, 0x3db504f3, v253
	v_max3_f32 v11, v11, v252, v253
	v_cvt_pk_bf16_f32 v248, v252, v253
	s_waitcnt vmcnt(3)
	buffer_load_dwordx4 v[48:51], v1, s[44:47], 0 offen nt
	v_xor_b32 v1, 0x800, v1
	v_dot2_f32_bf16 v252, v32, v12, 0
	v_dot2_f32_bf16 v252, v33, v13, v252
	v_dot2_f32_bf16 v252, v34, v14, v252
	v_dot2_f32_bf16 v252, v35, v15, v252
	s_nop 2
	v_add_f32_dpp v252, v252, v252 row_ror:8 row_mask:0xf bank_mask:0xf
	s_nop 1
	v_add_f32_dpp v252, v252, v252 row_ror:4 row_mask:0xf bank_mask:0xf
	s_nop 1
	v_add_f32_dpp v252, v252, v252 row_ror:2 row_mask:0xf bank_mask:0xf
	s_nop 1
	v_add_f32_dpp v252, v252, v252 row_ror:1 row_mask:0xf bank_mask:0xf
	v_cvt_pk_bf16_f32 v252, 0, v252
	v_mul_f32 v252, 0x3db504f3, v252
	s_waitcnt vmcnt(3)
	buffer_load_dwordx4 v[52:55], v1, s[44:47], 0 offen nt
	v_xor_b32 v1, 0x5800, v1
	v_add_u32 v1, 0x8000, v1
	s_add_u32 s67, s67, 0x1000
	v_mov_b32 v3, s67
	ds_write_b32 v10, v3 offset:3072
	v_dot2_f32_bf16 v253, v36, v12, 0
	v_dot2_f32_bf16 v253, v37, v13, v253
	v_dot2_f32_bf16 v253, v38, v14, v253
	v_dot2_f32_bf16 v253, v39, v15, v253
	s_nop 2
	v_add_f32_dpp v253, v253, v253 row_ror:8 row_mask:0xf bank_mask:0xf
	s_nop 1
	v_add_f32_dpp v253, v253, v253 row_ror:4 row_mask:0xf bank_mask:0xf
	s_nop 1
	v_add_f32_dpp v253, v253, v253 row_ror:2 row_mask:0xf bank_mask:0xf
	s_nop 1
	v_add_f32_dpp v253, v253, v253 row_ror:1 row_mask:0xf bank_mask:0xf
	v_cvt_pk_bf16_f32 v253, 0, v253
	v_mul_f32 v253, 0x3db504f3, v253
	v_max3_f32 v11, v11, v252, v253
	v_cvt_pk_bf16_f32 v249, v252, v253
	s_waitcnt vmcnt(3)
	s_sub_u32 s62, s62, 1
	s_cbranch_scc1 L_c_3
L_c_3_b:
	buffer_load_dwordx4 v[24:27], v1, s[44:47], 0 offen nt
	v_xor_b32 v1, 0x800, v1
	v_dot2_f32_bf16 v252, v40, v12, 0
	v_dot2_f32_bf16 v252, v41, v13, v252
	v_dot2_f32_bf16 v252, v42, v14, v252
	v_dot2_f32_bf16 v252, v43, v15, v252
	s_nop 2
	v_add_f32_dpp v252, v252, v252 row_ror:8 row_mask:0xf bank_mask:0xf
	s_nop 1
	v_add_f32_dpp v252, v252, v252 row_ror:4 row_mask:0xf bank_mask:0xf
	s_nop 1
	v_add_f32_dpp v252, v252, v252 row_ror:2 row_mask:0xf bank_mask:0xf
	s_nop 1
	v_add_f32_dpp v252, v252, v252 row_ror:1 row_mask:0xf bank_mask:0xf
	v_cvt_pk_bf16_f32 v252, 0, v252
	v_mul_f32 v252, 0x3db504f3, v252
	s_waitcnt vmcnt(3)
	buffer_load_dwordx4 v[28:31], v1, s[44:47], 0 offen nt
	v_xor_b32 v1, 0x1800, v1
	s_add_u32 s67, s67, 0x1000
	v_mov_b32 v3, s67
	ds_write_b32 v10, v3 offset:3072
	v_dot2_f32_bf16 v253, v44, v12, 0
	v_dot2_f32_bf16 v253, v45, v13, v253
	v_dot2_f32_bf16 v253, v46, v14, v253
	v_dot2_f32_bf16 v253, v47, v15, v253
	s_nop 2
	v_add_f32_dpp v253, v253, v253 row_ror:8 row_mask:0xf bank_mask:0xf
	s_nop 1
	v_add_f32_dpp v253, v253, v253 row_ror:4 row_mask:0xf bank_mask:0xf
	s_nop 1
	v_add_f32_dpp v253, v253, v253 row_ror:2 row_mask:0xf bank_mask:0xf
	s_nop 1
	v_add_f32_dpp v253, v253, v253 row_ror:1 row_mask:0xf bank_mask:0xf
	v_cvt_pk_bf16_f32 v253, 0, v253
	v_mul_f32 v253, 0x3db504f3, v253
	v_max3_f32 v11, v11, v252, v253
	v_cvt_pk_bf16_f32 v250, v252, v253
	s_waitcnt vmcnt(3)
	buffer_load_dwordx4 v[32:35], v1, s[44:47], 0 offen nt
	v_xor_b32 v1, 0x800, v1
	buffer_load_dwordx4 v[36:39], v1, s[44:47], 0 offen nt
	v_xor_b32 v1, 0x5800, v1
	v_dot2_f32_bf16 v252, v48, v12, 0
	v_dot2_f32_bf16 v252, v49, v13, v252
	v_dot2_f32_bf16 v252, v50, v14, v252
	v_dot2_f32_bf16 v252, v51, v15, v252
	s_nop 2
	v_add_f32_dpp v252, v252, v252 row_ror:8 row_mask:0xf bank_mask:0xf
	s_nop 1
	v_add_f32_dpp v252, v252, v252 row_ror:4 row_mask:0xf bank_mask:0xf
	s_nop 1
	v_add_f32_dpp v252, v252, v252 row_ror:2 row_mask:0xf bank_mask:0xf
	s_nop 1
	v_add_f32_dpp v252, v252, v252 row_ror:1 row_mask:0xf bank_mask:0xf
	v_cvt_pk_bf16_f32 v252, 0, v252
	v_mul_f32 v252, 0x3db504f3, v252
	s_waitcnt vmcnt(4)
	buffer_load_dwordx4 v[40:43], v1, s[44:47], 0 offen nt
	v_xor_b32 v1, 0x800, v1
	buffer_load_dwordx4 v[44:47], v1, s[44:47], 0 offen nt
	v_xor_b32 v1, 0x1800, v1
	s_add_u32 s67, s67, 0x1000
	v_mov_b32 v3, s67
	ds_write_b32 v10, v3 offset:3072
	ds_read_b32 v9, v10 offset:3088
	s_sub_u32 s61, s60, 24
	s_cmp_lt_u32 s61, 16
	s_cbranch_scc0 L_k1_nl
	ds_read_b128 v[48:51], v0
L_k1_nl:
	v_dot2_f32_bf16 v253, v52, v12, 0
	v_dot2_f32_bf16 v253, v53, v13, v253
	v_dot2_f32_bf16 v253, v54, v14, v253
	v_dot2_f32_bf16 v253, v55, v15, v253
	s_nop 2
	v_add_f32_dpp v253, v253, v253 row_ror:8 row_mask:0xf bank_mask:0xf
	s_nop 1
	v_add_f32_dpp v253, v253, v253 row_ror:4 row_mask:0xf bank_mask:0xf
	s_nop 1
	v_add_f32_dpp v253, v253, v253 row_ror:2 row_mask:0xf bank_mask:0xf
	s_nop 1
	v_add_f32_dpp v253, v253, v253 row_ror:1 row_mask:0xf bank_mask:0xf
	v_cvt_pk_bf16_f32 v253, 0, v253
	v_mul_f32 v253, 0x3db504f3, v253
	v_max3_f32 v11, v11, v252, v253
	v_cvt_pk_bf16_f32 v251, v252, v253
	s_mov_b32 exec_lo, 0x10001
	s_mov_b32 exec_hi, 0x10001
	ds_write_b128 v2, v[248:251]
	s_mov_b64 exec, -1
	v_add_u32 v2, 64, v2
	s_waitcnt lgkmcnt(1)
	v_readfirstlane_b32 s61, v9
	s_cmp_lt_u32 s60, 40
	s_cbranch_scc1 L_c_4
L_c_4_b:
	s_add_u32 s60, s60, 1
	s_cmp_eq_u32 s60, 54
	s_cbranch_scc1 L_k1_sw
	s_cmp_eq_u32 s61, 1
	s_cbranch_scc1 L_k1
	s_cmp_eq_u32 s61, 2
	s_cbranch_scc1 L_k2
	s_cmp_eq_u32 s61, 3
	s_cbranch_scc1 L_k3
	s_cmp_eq_u32 s61, 0
	s_cbranch_scc1 L_k0
	s_cmp_eq_u32 s61, 4
	s_cbranch_scc1 L_k4
	s_branch L_kT
L_k1_sw:
	s_call_b64 s[42:43], L_max
	s_cmp_eq_u32 s61, 1
	s_cbranch_scc1 L_v1
	s_cmp_eq_u32 s61, 2
	s_cbranch_scc1 L_v2
	s_cmp_eq_u32 s61, 3
	s_cbranch_scc1 L_v3
	s_cmp_eq_u32 s61, 0
	s_cbranch_scc1 L_v0
	s_cmp_eq_u32 s61, 4
	s_cbranch_scc1 L_v4
	s_branch L_vT
.p2align 4
L_k2:
	s_waitcnt vmcnt(5)
	v_dot2_f32_bf16 v252, v24, v12, 0
	v_dot2_f32_bf16 v252, v25, v13, v252
	v_dot2_f32_bf16 v252, v26, v14, v252
	v_dot2_f32_bf16 v252, v27, v15, v252
	s_nop 2
	v_add_f32_dpp v252, v252, v252 row_ror:8 row_mask:0xf bank_mask:0xf
	s_nop 1
	v_add_f32_dpp v252, v252, v252 row_ror:4 row_mask:0xf bank_mask:0xf
	s_nop 1
	v_add_f32_dpp v252, v252, v252 row_ror:2 row_mask:0xf bank_mask:0xf
	s_nop 1
	v_add_f32_dpp v252, v252, v252 row_ror:1 row_mask:0xf bank_mask:0xf
	v_cvt_pk_bf16_f32 v252, 0, v252
	v_mul_f32 v252, 0x3db504f3, v252
	s_waitcnt vmcnt(4)
	buffer_load_dwordx4 v[48:51], v1, s[44:47], 0 offen nt
	v_xor_b32 v1, 0x800, v1
	s_add_u32 s67, s67, 0x1000
	v_mov_b32 v3, s67
	ds_write_b32 v10, v3 offset:3072
	v_dot2_f32_bf16 v253, v28, v12, 0
	v_dot2_f32_bf16 v253, v29, v13, v253
	v_dot2_f32_bf16 v253, v30, v14, v253
	v_dot2_f32_bf16 v253, v31, v15, v253
	s_nop 2
	v_add_f32_dpp v253, v253, v253 row_ror:8 row_mask:0xf bank_mask:0xf
	s_nop 1
	v_add_f32_dpp v253, v253, v253 row_ror:4 row_mask:0xf bank_mask:0xf
	s_nop 1
	v_add_f32_dpp v253, v253, v253 row_ror:2 row_mask:0xf bank_mask:0xf
	s_nop 1
	v_add_f32_dpp v253, v253, v253 row_ror:1 row_mask:0xf bank_mask:0xf
	v_cvt_pk_bf16_f32 v253, 0, v253
	v_mul_f32 v253, 0x3db504f3, v253
	v_max3_f32 v11, v11, v252, v253
	v_cvt_pk_bf16_f32 v248, v252, v253
	s_waitcnt vmcnt(4)
	buffer_load_dwordx4 v[52:55], v1, s[44:47], 0 offen nt
	v_xor_b32 v1, 0x5800, v1
	v_add_u32 v1, 0x8000, v1
	v_dot2_f32_bf16 v252, v32, v12, 0
	v_dot2_f32_bf16 v252, v33, v13, v252
	v_dot2_f32_bf16 v252, v34, v14, v252
	v_dot2_f32_bf16 v252, v35, v15, v252
	s_nop 2
	v_add_f32_dpp v252, v252, v252 row_ror:8 row_mask:0xf bank_mask:0xf
	s_nop 1
	v_add_f32_dpp v252, v252, v252 row_ror:4 row_mask:0xf bank_mask:0xf
	s_nop 1
	v_add_f32_dpp v252, v252, v252 row_ror:2 row_mask:0xf bank_mask:0xf
	s_nop 1
	v_add_f32_dpp v252, v252, v252 row_ror:1 row_mask:0xf bank_mask:0xf
	v_cvt_pk_bf16_f32 v252, 0, v252
	v_mul_f32 v252, 0x3db504f3, v252
	s_waitcnt vmcnt(4)
	s_sub_u32 s62, s62, 1
	s_cbranch_scc1 L_c_5
L_c_5_b:
	buffer_load_dwordx4 v[24:27], v1, s[44:47], 0 offen nt
	v_xor_b32 v1, 0x800, v1
	s_add_u32 s67, s67, 0x1000
	v_mov_b32 v3, s67
	ds_write_b32 v10, v3 offset:3072
	v_dot2_f32_bf16 v253, v36, v12, 0
	v_dot2_f32_bf16 v253, v37, v13, v253
	v_dot2_f32_bf16 v253, v38, v14, v253
	v_dot2_f32_bf16 v253, v39, v15, v253
	s_nop 2
	v_add_f32_dpp v253, v253, v253 row_ror:8 row_mask:0xf bank_mask:0xf
	s_nop 1
	v_add_f32_dpp v253, v253, v253 row_ror:4 row_mask:0xf bank_mask:0xf
	s_nop 1
	v_add_f32_dpp v253, v253, v253 row_ror:2 row_mask:0xf bank_mask:0xf
	s_nop 1
	v_add_f32_dpp v253, v253, v253 row_ror:1 row_mask:0xf bank_mask:0xf
	v_cvt_pk_bf16_f32 v253, 0, v253
	v_mul_f32 v253, 0x3db504f3, v253
	v_max3_f32 v11, v11, v252, v253
	v_cvt_pk_bf16_f32 v249, v252, v253
	s_waitcnt vmcnt(4)
	buffer_load_dwordx4 v[28:31], v1, s[44:47], 0 offen nt
	v_xor_b32 v1, 0x1800, v1
	v_dot2_f32_bf16 v252, v40, v12, 0
	v_dot2_f32_bf16 v252, v41, v13, v252
	v_dot2_f32_bf16 v252, v42, v14, v252
	v_dot2_f32_bf16 v252, v43, v15, v252
	s_nop 2
	v_add_f32_dpp v252, v252, v252 row_ror:8 row_mask:0xf bank_mask:0xf
	s_nop 1
	v_add_f32_dpp v252, v252, v252 row_ror:4 row_mask:0xf bank_mask:0xf
	s_nop 1
	v_add_f32_dpp v252, v252, v252 row_ror:2 row_mask:0xf bank_mask:0xf
	s_nop 1
	v_add_f32_dpp v252, v252, v252 row_ror:1 row_mask:0xf bank_mask:0xf
	v_cvt_pk_bf16_f32 v252, 0, v252
	v_mul_f32 v252, 0x3db504f3, v252
	s_waitcnt vmcnt(4)
	buffer_load_dwordx4 v[32:35], v1, s[44:47], 0 offen nt
	v_xor_b32 v1, 0x800, v1
	s_add_u32 s67, s67, 0x1000
	v_mov_b32 v3, s67
	ds_write_b32 v10, v3 offset:3072
	v_dot2_f32_bf16 v253, v44, v12, 0
	v_dot2_f32_bf16 v253, v45, v13, v253
	v_dot2_f32_bf16 v253, v46, v14, v253
	v_dot2_f32_bf16 v253, v47, v15, v253
	s_nop 2
	v_add_f32_dpp v253, v253, v253 row_ror:8 row_mask:0xf bank_mask:0xf
	s_nop 1
	v_add_f32_dpp v253, v253, v253 row_ror:4 row_mask:0xf bank_mask:0xf
	s_nop 1
	v_add_f32_dpp v253, v253, v253 row_ror:2 row_mask:0xf bank_mask:0xf
	s_nop 1
	v_add_f32_dpp v253, v253, v253 row_ror:1 row_mask:0xf bank_mask:0xf
	v_cvt_pk_bf16_f32 v253, 0, v253
	v_mul_f32 v253, 0x3db504f3, v253
	v_max3_f32 v11, v11, v252, v253
	v_cvt_pk_bf16_f32 v250, v252, v253
	s_waitcnt vmcnt(4)
	buffer_load_dwordx4 v[36:39], v1, s[44:47], 0 offen nt
	v_xor_b32 v1, 0x5800, v1
	v_dot2_f32_bf16 v252, v48, v12, 0
	v_dot2_f32_bf16 v252, v49, v13, v252
	v_dot2_f32_bf16 v252, v50, v14, v252
	v_dot2_f32_bf16 v252, v51, v15, v252
	s_nop 2
	v_add_f32_dpp v252, v252, v252 row_ror:8 row_mask:0xf bank_mask:0xf
	s_nop 1
	v_add_f32_dpp v252, v252, v252 row_ror:4 row_mask:0xf bank_mask:0xf
	s_nop 1
	v_add_f32_dpp v252, v252, v252 row_ror:2 row_mask:0xf bank_mask:0xf
	s_nop 1
	v_add_f32_dpp v252, v252, v252 row_ror:1 row_mask:0xf bank_mask:0xf
	v_cvt_pk_bf16_f32 v252, 0, v252
	v_mul_f32 v252, 0x3db504f3, v252
	s_waitcnt vmcnt(4)
	buffer_load_dwordx4 v[40:43], v1, s[44:47], 0 offen nt
	v_xor_b32 v1, 0x800, v1
	buffer_load_dwordx4 v[44:47], v1, s[44:47], 0 offen nt
	v_xor_b32 v1, 0x1800, v1
	s_add_u32 s67, s67, 0x1000
	v_mov_b32 v3, s67
	ds_write_b32 v10, v3 offset:3072
	ds_read_b32 v9, v10 offset:3088
	s_sub_u32 s61, s60, 24
	s_cmp_lt_u32 s61, 16
	s_cbranch_scc0 L_k2_nl
	ds_read_b128 v[48:51], v0
L_k2_nl:
	v_dot2_f32_bf16 v253, v52, v12, 0
	v_dot2_f32_bf16 v253, v53, v13, v253
	v_dot2_f32_bf16 v253, v54, v14, v253
	v_dot2_f32_bf16 v253, v55, v15, v253
	s_nop 2
	v_add_f32_dpp v253, v253, v253 row_ror:8 row_mask:0xf bank_mask:0xf
	s_nop 1
	v_add_f32_dpp v253, v253, v253 row_ror:4 row_mask:0xf bank_mask:0xf
	s_nop 1
	v_add_f32_dpp v253, v253, v253 row_ror:2 row_mask:0xf bank_mask:0xf
	s_nop 1
	v_add_f32_dpp v253, v253, v253 row_ror:1 row_mask:0xf bank_mask:0xf
	v_cvt_pk_bf16_f32 v253, 0, v253
	v_mul_f32 v253, 0x3db504f3, v253
	v_max3_f32 v11, v11, v252, v253
	v_cvt_pk_bf16_f32 v251, v252, v253
	s_mov_b32 exec_lo, 0x10001
	s_mov_b32 exec_hi, 0x10001
	ds_write_b128 v2, v[248:251]
	s_mov_b64 exec, -1
	v_add_u32 v2, 64, v2
	s_waitcnt lgkmcnt(1)
	v_readfirstlane_b32 s61, v9
	s_cmp_lt_u32 s60, 40
	s_cbranch_scc1 L_c_6
L_c_6_b:
	s_add_u32 s60, s60, 1
	s_cmp_eq_u32 s60, 54
	s_cbranch_scc1 L_k2_sw
	s_cmp_eq_u32 s61, 2
	s_cbranch_scc1 L_k2
	s_cmp_eq_u32 s61, 1
	s_cbranch_scc1 L_k1
	s_cmp_eq_u32 s61, 3
	s_cbranch_scc1 L_k3
	s_cmp_eq_u32 s61, 0
	s_cbranch_scc1 L_k0
	s_cmp_eq_u32 s61, 4
	s_cbranch_scc1 L_k4
	s_branch L_kT
L_k2_sw:
	s_call_b64 s[42:43], L_max
	s_cmp_eq_u32 s61, 2
	s_cbranch_scc1 L_v2
	s_cmp_eq_u32 s61, 1
	s_cbranch_scc1 L_v1
	s_cmp_eq_u32 s61, 3
	s_cbranch_scc1 L_v3
	s_cmp_eq_u32 s61, 0
	s_cbranch_scc1 L_v0
	s_cmp_eq_u32 s61, 4
	s_cbranch_scc1 L_v4
	s_branch L_vT
.p2align 4
L_k3:
	s_waitcnt vmcnt(5)
	buffer_load_dwordx4 v[48:51], v1, s[44:47], 0 offen nt
	v_xor_b32 v1, 0x800, v1
	v_dot2_f32_bf16 v252, v24, v12, 0
	v_dot2_f32_bf16 v252, v25, v13, v252
	v_dot2_f32_bf16 v252, v26, v14, v252
	v_dot2_f32_bf16 v252, v27, v15, v252
	s_nop 2
	v_add_f32_dpp v252, v252, v252 row_ror:8 row_mask:0xf bank_mask:0xf
	s_nop 1
	v_add_f32_dpp v252, v252, v252 row_ror:4 row_mask:0xf bank_mask:0xf
	s_nop 1
	v_add_f32_dpp v252, v252, v252 row_ror:2 row_mask:0xf bank_mask:0xf
	s_nop 1
	v_add_f32_dpp v252, v252, v252 row_ror:1 row_mask:0xf bank_mask:0xf
	v_cvt_pk_bf16_f32 v252, 0, v252
	v_mul_f32 v252, 0x3db504f3, v252
	s_waitcnt vmcnt(5)
	buffer_load_dwordx4 v[52:55], v1, s[44:47], 0 offen nt
	v_xor_b32 v1, 0x5800, v1
	v_add_u32 v1, 0x8000, v1
	s_add_u32 s67, s67, 0x1000
	v_mov_b32 v3, s67
	ds_write_b32 v10, v3 offset:3072
	v_dot2_f32_bf16 v253, v28, v12, 0
	v_dot2_f32_bf16 v253, v29, v13, v253
	v_dot2_f32_bf16 v253, v30, v14, v253
	v_dot2_f32_bf16 v253, v31, v15, v253
	s_nop 2
	v_add_f32_dpp v253, v253, v253 row_ror:8 row_mask:0xf bank_mask:0xf
	s_nop 1
	v_add_f32_dpp v253, v253, v253 row_ror:4 row_mask:0xf bank_mask:0xf
	s_nop 1
	v_add_f32_dpp v253, v253, v253 row_ror:2 row_mask:0xf bank_mask:0xf
	s_nop 1
	v_add_f32_dpp v253, v253, v253 row_ror:1 row_mask:0xf bank_mask:0xf
	v_cvt_pk_bf16_f32 v253, 0, v253
	v_mul_f32 v253, 0x3db504f3, v253
	v_max3_f32 v11, v11, v252, v253
	v_cvt_pk_bf16_f32 v248, v252, v253
	s_waitcnt vmcnt(5)
	s_sub_u32 s62, s62, 1
	s_cbranch_scc1 L_c_7
L_c_7_b:
	buffer_load_dwordx4 v[24:27], v1, s[44:47], 0 offen nt
	v_xor_b32 v1, 0x800, v1
	v_dot2_f32_bf16 v252, v32, v12, 0
	v_dot2_f32_bf16 v252, v33, v13, v252
	v_dot2_f32_bf16 v252, v34, v14, v252
	v_dot2_f32_bf16 v252, v35, v15, v252
	s_nop 2
	v_add_f32_dpp v252, v252, v252 row_ror:8 row_mask:0xf bank_mask:0xf
	s_nop 1
	v_add_f32_dpp v252, v252, v252 row_ror:4 row_mask:0xf bank_mask:0xf
	s_nop 1
	v_add_f32_dpp v252, v252, v252 row_ror:2 row_mask:0xf bank_mask:0xf
	s_nop 1
	v_add_f32_dpp v252, v252, v252 row_ror:1 row_mask:0xf bank_mask:0xf
	v_cvt_pk_bf16_f32 v252, 0, v252
	v_mul_f32 v252, 0x3db504f3, v252
	s_waitcnt vmcnt(5)
	buffer_load_dwordx4 v[28:31], v1, s[44:47], 0 offen nt
	v_xor_b32 v1, 0x1800, v1
	s_add_u32 s67, s67, 0x1000
	v_mov_b32 v3, s67
	ds_write_b32 v10, v3 offset:3072
	v_dot2_f32_bf16 v253, v36, v12, 0
	v_dot2_f32_bf16 v253, v37, v13, v253
	v_dot2_f32_bf16 v253, v38, v14, v253
	v_dot2_f32_bf16 v253, v39, v15, v253
	s_nop 2
	v_add_f32_dpp v253, v253, v253 row_ror:8 row_mask:0xf bank_mask:0xf
	s_nop 1
	v_add_f32_dpp v253, v253, v253 row_ror:4 row_mask:0xf bank_mask:0xf
	s_nop 1
	v_add_f32_dpp v253, v253, v253 row_ror:2 row_mask:0xf bank_mask:0xf
	s_nop 1
	v_add_f32_dpp v253, v253, v253 row_ror:1 row_mask:0xf bank_mask:0xf
	v_cvt_pk_bf16_f32 v253, 0, v253
	v_mul_f32 v253, 0x3db504f3, v253
	v_max3_f32 v11, v11, v252, v253
	v_cvt_pk_bf16_f32 v249, v252, v253
	s_waitcnt vmcnt(5)
	buffer_load_dwordx4 v[32:35], v1, s[44:47], 0 offen nt
	v_xor_b32 v1, 0x800, v1
	v_dot2_f32_bf16 v252, v40, v12, 0
	v_dot2_f32_bf16 v252, v41, v13, v252
	v_dot2_f32_bf16 v252, v42, v14, v252
	v_dot2_f32_bf16 v252, v43, v15, v252
	s_nop 2
	v_add_f32_dpp v252, v252, v252 row_ror:8 row_mask:0xf bank_mask:0xf
	s_nop 1
	v_add_f32_dpp v252, v252, v252 row_ror:4 row_mask:0xf bank_mask:0xf
	s_nop 1
	v_add_f32_dpp v252, v252, v252 row_ror:2 row_mask:0xf bank_mask:0xf
	s_nop 1
	v_add_f32_dpp v252, v252, v252 row_ror:1 row_mask:0xf bank_mask:0xf
	v_cvt_pk_bf16_f32 v252, 0, v252
	v_mul_f32 v252, 0x3db504f3, v252
	s_waitcnt vmcnt(5)
	buffer_load_dwordx4 v[36:39], v1, s[44:47], 0 offen nt
	v_xor_b32 v1, 0x5800, v1
	s_add_u32 s67, s67, 0x1000
	v_mov_b32 v3, s67
	ds_write_b32 v10, v3 offset:3072
	v_dot2_f32_bf16 v253, v44, v12, 0
	v_dot2_f32_bf16 v253, v45, v13, v253
	v_dot2_f32_bf16 v253, v46, v14, v253
	v_dot2_f32_bf16 v253, v47, v15, v253
	s_nop 2
	v_add_f32_dpp v253, v253, v253 row_ror:8 row_mask:0xf bank_mask:0xf
	s_nop 1
	v_add_f32_dpp v253, v253, v253 row_ror:4 row_mask:0xf bank_mask:0xf
	s_nop 1
	v_add_f32_dpp v253, v253, v253 row_ror:2 row_mask:0xf bank_mask:0xf
	s_nop 1
	v_add_f32_dpp v253, v253, v253 row_ror:1 row_mask:0xf bank_mask:0xf
	v_cvt_pk_bf16_f32 v253, 0, v253
	v_mul_f32 v253, 0x3db504f3, v253
	v_max3_f32 v11, v11, v252, v253
	v_cvt_pk_bf16_f32 v250, v252, v253
	s_waitcnt vmcnt(5)
	buffer_load_dwordx4 v[40:43], v1, s[44:47], 0 offen nt
	v_xor_b32 v1, 0x800, v1
	v_dot2_f32_bf16 v252, v48, v12, 0
	v_dot2_f32_bf16 v252, v49, v13, v252
	v_dot2_f32_bf16 v252, v50, v14, v252
	v_dot2_f32_bf16 v252, v51, v15, v252
	s_nop 2
	v_add_f32_dpp v252, v252, v252 row_ror:8 row_mask:0xf bank_mask:0xf
	s_nop 1
	v_add_f32_dpp v252, v252, v252 row_ror:4 row_mask:0xf bank_mask:0xf
	s_nop 1
	v_add_f32_dpp v252, v252, v252 row_ror:2 row_mask:0xf bank_mask:0xf
	s_nop 1
	v_add_f32_dpp v252, v252, v252 row_ror:1 row_mask:0xf bank_mask:0xf
	v_cvt_pk_bf16_f32 v252, 0, v252
	v_mul_f32 v252, 0x3db504f3, v252
	s_waitcnt vmcnt(5)
	buffer_load_dwordx4 v[44:47], v1, s[44:47], 0 offen nt
	v_xor_b32 v1, 0x1800, v1
	s_add_u32 s67, s67, 0x1000
	v_mov_b32 v3, s67
	ds_write_b32 v10, v3 offset:3072
	ds_read_b32 v9, v10 offset:3088
	s_sub_u32 s61, s60, 24
	s_cmp_lt_u32 s61, 16
	s_cbranch_scc0 L_k3_nl
	ds_read_b128 v[48:51], v0
L_k3_nl:
	v_dot2_f32_bf16 v253, v52, v12, 0
	v_dot2_f32_bf16 v253, v53, v13, v253
	v_dot2_f32_bf16 v253, v54, v14, v253
	v_dot2_f32_bf16 v253, v55, v15, v253
	s_nop 2
	v_add_f32_dpp v253, v253, v253 row_ror:8 row_mask:0xf bank_mask:0xf
	s_nop 1
	v_add_f32_dpp v253, v253, v253 row_ror:4 row_mask:0xf bank_mask:0xf
	s_nop 1
	v_add_f32_dpp v253, v253, v253 row_ror:2 row_mask:0xf bank_mask:0xf
	s_nop 1
	v_add_f32_dpp v253, v253, v253 row_ror:1 row_mask:0xf bank_mask:0xf
	v_cvt_pk_bf16_f32 v253, 0, v253
	v_mul_f32 v253, 0x3db504f3, v253
	v_max3_f32 v11, v11, v252, v253
	v_cvt_pk_bf16_f32 v251, v252, v253
	s_mov_b32 exec_lo, 0x10001
	s_mov_b32 exec_hi, 0x10001
	ds_write_b128 v2, v[248:251]
	s_mov_b64 exec, -1
	v_add_u32 v2, 64, v2
	s_waitcnt lgkmcnt(1)
	v_readfirstlane_b32 s61, v9
	s_cmp_lt_u32 s60, 40
	s_cbranch_scc1 L_c_8
L_c_8_b:
	s_add_u32 s60, s60, 1
	s_cmp_eq_u32 s60, 54
	s_cbranch_scc1 L_k3_sw
	s_cmp_eq_u32 s61, 3
	s_cbranch_scc1 L_k3
	s_cmp_eq_u32 s61, 2
	s_cbranch_scc1 L_k2
	s_cmp_eq_u32 s61, 1
	s_cbranch_scc1 L_k1
	s_cmp_eq_u32 s61, 0
	s_cbranch_scc1 L_k0
	s_cmp_eq_u32 s61, 4
	s_cbranch_scc1 L_k4
	s_branch L_kT
L_k3_sw:
	s_call_b64 s[42:43], L_max
	s_cmp_eq_u32 s61, 3
	s_cbranch_scc1 L_v3
	s_cmp_eq_u32 s61, 2
	s_cbranch_scc1 L_v2
	s_cmp_eq_u32 s61, 1
	s_cbranch_scc1 L_v1
	s_cmp_eq_u32 s61, 0
	s_cbranch_scc1 L_v0
	s_cmp_eq_u32 s61, 4
	s_cbranch_scc1 L_v4
	s_branch L_vT
.p2align 4
L_k4:
	s_waitcnt vmcnt(5)
	buffer_load_dwordx4 v[48:51], v1, s[44:47], 0 offen nt
	v_xor_b32 v1, 0x800, v1
	buffer_load_dwordx4 v[52:55], v1, s[44:47], 0 offen nt
	v_xor_b32 v1, 0x5800, v1
	v_add_u32 v1, 0x8000, v1
	v_dot2_f32_bf16 v252, v24, v12, 0
	v_dot2_f32_bf16 v252, v25, v13, v252
	v_dot2_f32_bf16 v252, v26, v14, v252
	v_dot2_f32_bf16 v252, v27, v15, v252
	s_nop 2
	v_add_f32_dpp v252, v252, v252 row_ror:8 row_mask:0xf bank_mask:0xf
	s_nop 1
	v_add_f32_dpp v252, v252, v252 row_ror:4 row_mask:0xf bank_mask:0xf
	s_nop 1
	v_add_f32_dpp v252, v252, v252 row_ror:2 row_mask:0xf bank_mask:0xf
	s_nop 1
	v_add_f32_dpp v252, v252, v252 row_ror:1 row_mask:0xf bank_mask:0xf
	v_cvt_pk_bf16_f32 v252, 0, v252
	v_mul_f32 v252, 0x3db504f3, v252
	s_waitcnt vmcnt(6)
	s_sub_u32 s62, s62, 1
	s_cbranch_scc1 L_c_9
L_c_9_b:
	buffer_load_dwordx4 v[24:27], v1, s[44:47], 0 offen nt
	v_xor_b32 v1, 0x800, v1
	s_add_u32 s67, s67, 0x1000
	v_mov_b32 v3, s67
	ds_write_b32 v10, v3 offset:3072
	v_dot2_f32_bf16 v253, v28, v12, 0
	v_dot2_f32_bf16 v253, v29, v13, v253
	v_dot2_f32_bf16 v253, v30, v14, v253
	v_dot2_f32_bf16 v253, v31, v15, v253
	s_nop 2
	v_add_f32_dpp v253, v253, v253 row_ror:8 row_mask:0xf bank_mask:0xf
	s_nop 1
	v_add_f32_dpp v253, v253, v253 row_ror:4 row_mask:0xf bank_mask:0xf
	s_nop 1
	v_add_f32_dpp v253, v253, v253 row_ror:2 row_mask:0xf bank_mask:0xf
	s_nop 1
	v_add_f32_dpp v253, v253, v253 row_ror:1 row_mask:0xf bank_mask:0xf
	v_cvt_pk_bf16_f32 v253, 0, v253
	v_mul_f32 v253, 0x3db504f3, v253
	v_max3_f32 v11, v11, v252, v253
	v_cvt_pk_bf16_f32 v248, v252, v253
	s_waitcnt vmcnt(6)
	buffer_load_dwordx4 v[28:31], v1, s[44:47], 0 offen nt
	v_xor_b32 v1, 0x1800, v1
	v_dot2_f32_bf16 v252, v32, v12, 0
	v_dot2_f32_bf16 v252, v33, v13, v252
	v_dot2_f32_bf16 v252, v34, v14, v252
	v_dot2_f32_bf16 v252, v35, v15, v252
	s_nop 2
	v_add_f32_dpp v252, v252, v252 row_ror:8 row_mask:0xf bank_mask:0xf
	s_nop 1
	v_add_f32_dpp v252, v252, v252 row_ror:4 row_mask:0xf bank_mask:0xf
	s_nop 1
	v_add_f32_dpp v252, v252, v252 row_ror:2 row_mask:0xf bank_mask:0xf
	s_nop 1
	v_add_f32_dpp v252, v252, v252 row_ror:1 row_mask:0xf bank_mask:0xf
	v_cvt_pk_bf16_f32 v252, 0, v252
	v_mul_f32 v252, 0x3db504f3, v252
	s_waitcnt vmcnt(6)
	buffer_load_dwordx4 v[32:35], v1, s[44:47], 0 offen nt
	v_xor_b32 v1, 0x800, v1
	s_add_u32 s67, s67, 0x1000
	v_mov_b32 v3, s67
	ds_write_b32 v10, v3 offset:3072
	v_dot2_f32_bf16 v253, v36, v12, 0
	v_dot2_f32_bf16 v253, v37, v13, v253
	v_dot2_f32_bf16 v253, v38, v14, v253
	v_dot2_f32_bf16 v253, v39, v15, v253
	s_nop 2
	v_add_f32_dpp v253, v253, v253 row_ror:8 row_mask:0xf bank_mask:0xf
	s_nop 1
	v_add_f32_dpp v253, v253, v253 row_ror:4 row_mask:0xf bank_mask:0xf
	s_nop 1
	v_add_f32_dpp v253, v253, v253 row_ror:2 row_mask:0xf bank_mask:0xf
	s_nop 1
	v_add_f32_dpp v253, v253, v253 row_ror:1 row_mask:0xf bank_mask:0xf
	v_cvt_pk_bf16_f32 v253, 0, v253
	v_mul_f32 v253, 0x3db504f3, v253
	v_max3_f32 v11, v11, v252, v253
	v_cvt_pk_bf16_f32 v249, v252, v253
	s_waitcnt vmcnt(6)
	buffer_load_dwordx4 v[36:39], v1, s[44:47], 0 offen nt
	v_xor_b32 v1, 0x5800, v1
	v_dot2_f32_bf16 v252, v40, v12, 0
	v_dot2_f32_bf16 v252, v41, v13, v252
	v_dot2_f32_bf16 v252, v42, v14, v252
	v_dot2_f32_bf16 v252, v43, v15, v252
	s_nop 2
	v_add_f32_dpp v252, v252, v252 row_ror:8 row_mask:0xf bank_mask:0xf
	s_nop 1
	v_add_f32_dpp v252, v252, v252 row_ror:4 row_mask:0xf bank_mask:0xf
	s_nop 1
	v_add_f32_dpp v252, v252, v252 row_ror:2 row_mask:0xf bank_mask:0xf
	s_nop 1
	v_add_f32_dpp v252, v252, v252 row_ror:1 row_mask:0xf bank_mask:0xf
	v_cvt_pk_bf16_f32 v252, 0, v252
	v_mul_f32 v252, 0x3db504f3, v252
	s_waitcnt vmcnt(6)
	buffer_load_dwordx4 v[40:43], v1, s[44:47], 0 offen nt
	v_xor_b32 v1, 0x800, v1
	s_add_u32 s67, s67, 0x1000
	v_mov_b32 v3, s67
	ds_write_b32 v10, v3 offset:3072
	v_dot2_f32_bf16 v253, v44, v12, 0
	v_dot2_f32_bf16 v253, v45, v13, v253
	v_dot2_f32_bf16 v253, v46, v14, v253
	v_dot2_f32_bf16 v253, v47, v15, v253
	s_nop 2
	v_add_f32_dpp v253, v253, v253 row_ror:8 row_mask:0xf bank_mask:0xf
	s_nop 1
	v_add_f32_dpp v253, v253, v253 row_ror:4 row_mask:0xf bank_mask:0xf
	s_nop 1
	v_add_f32_dpp v253, v253, v253 row_ror:2 row_mask:0xf bank_mask:0xf
	s_nop 1
	v_add_f32_dpp v253, v253, v253 row_ror:1 row_mask:0xf bank_mask:0xf
	v_cvt_pk_bf16_f32 v253, 0, v253
	v_mul_f32 v253, 0x3db504f3, v253
	v_max3_f32 v11, v11, v252, v253
	v_cvt_pk_bf16_f32 v250, v252, v253
	s_waitcnt vmcnt(6)
	buffer_load_dwordx4 v[44:47], v1, s[44:47], 0 offen nt
	v_xor_b32 v1, 0x1800, v1
	v_dot2_f32_bf16 v252, v48, v12, 0
	v_dot2_f32_bf16 v252, v49, v13, v252
	v_dot2_f32_bf16 v252, v50, v14, v252
	v_dot2_f32_bf16 v252, v51, v15, v252
	s_nop 2
	v_add_f32_dpp v252, v252, v252 row_ror:8 row_mask:0xf bank_mask:0xf
	s_nop 1
	v_add_f32_dpp v252, v252, v252 row_ror:4 row_mask:0xf bank_mask:0xf
	s_nop 1
	v_add_f32_dpp v252, v252, v252 row_ror:2 row_mask:0xf bank_mask:0xf
	s_nop 1
	v_add_f32_dpp v252, v252, v252 row_ror:1 row_mask:0xf bank_mask:0xf
	v_cvt_pk_bf16_f32 v252, 0, v252
	v_mul_f32 v252, 0x3db504f3, v252
	s_waitcnt vmcnt(6)
	s_add_u32 s67, s67, 0x1000
	v_mov_b32 v3, s67
	ds_write_b32 v10, v3 offset:3072
	ds_read_b32 v9, v10 offset:3088
	s_sub_u32 s61, s60, 24
	s_cmp_lt_u32 s61, 16
	s_cbranch_scc0 L_k4_nl
	ds_read_b128 v[48:51], v0
L_k4_nl:
	v_dot2_f32_bf16 v253, v52, v12, 0
	v_dot2_f32_bf16 v253, v53, v13, v253
	v_dot2_f32_bf16 v253, v54, v14, v253
	v_dot2_f32_bf16 v253, v55, v15, v253
	s_nop 2
	v_add_f32_dpp v253, v253, v253 row_ror:8 row_mask:0xf bank_mask:0xf
	s_nop 1
	v_add_f32_dpp v253, v253, v253 row_ror:4 row_mask:0xf bank_mask:0xf
	s_nop 1
	v_add_f32_dpp v253, v253, v253 row_ror:2 row_mask:0xf bank_mask:0xf
	s_nop 1
	v_add_f32_dpp v253, v253, v253 row_ror:1 row_mask:0xf bank_mask:0xf
	v_cvt_pk_bf16_f32 v253, 0, v253
	v_mul_f32 v253, 0x3db504f3, v253
	v_max3_f32 v11, v11, v252, v253
	v_cvt_pk_bf16_f32 v251, v252, v253
	s_mov_b32 exec_lo, 0x10001
	s_mov_b32 exec_hi, 0x10001
	ds_write_b128 v2, v[248:251]
	s_mov_b64 exec, -1
	v_add_u32 v2, 64, v2
	s_waitcnt lgkmcnt(1)
	v_readfirstlane_b32 s61, v9
	s_cmp_lt_u32 s60, 40
	s_cbranch_scc1 L_c_10
L_c_10_b:
	s_add_u32 s60, s60, 1
	s_cmp_eq_u32 s60, 54
	s_cbranch_scc1 L_k4_sw
	s_cmp_eq_u32 s61, 4
	s_cbranch_scc1 L_k4
	s_cmp_eq_u32 s61, 2
	s_cbranch_scc1 L_k2
	s_cmp_eq_u32 s61, 1
	s_cbranch_scc1 L_k1
	s_cmp_eq_u32 s61, 3
	s_cbranch_scc1 L_k3
	s_cmp_eq_u32 s61, 0
	s_cbranch_scc1 L_k0
	s_branch L_kT
L_k4_sw:
	s_call_b64 s[42:43], L_max
	s_cmp_eq_u32 s61, 4
	s_cbranch_scc1 L_v4
	s_cmp_eq_u32 s61, 2
	s_cbranch_scc1 L_v2
	s_cmp_eq_u32 s61, 1
	s_cbranch_scc1 L_v1
	s_cmp_eq_u32 s61, 3
	s_cbranch_scc1 L_v3
	s_cmp_eq_u32 s61, 0
	s_cbranch_scc1 L_v0
	s_branch L_vT
L_kT:
	s_cmp_lt_u32 s60, 40
	s_cbranch_scc1 L_k4
	s_bitcmp1_b32 s60, 0
	s_cbranch_scc1 L_k4
.p2align 4
L_kE:
	s_waitcnt vmcnt(5)
	buffer_load_dwordx4 v[48:51], v1, s[44:47], 0 offen nt
	v_xor_b32 v1, 0x800, v1
	buffer_load_dwordx4 v[52:55], v1, s[44:47], 0 offen nt
	v_xor_b32 v1, 0x5800, v1
	v_add_u32 v1, 0x8000, v1
	v_dot2_f32_bf16 v252, v24, v12, 0
	v_dot2_f32_bf16 v252, v25, v13, v252
	v_dot2_f32_bf16 v252, v26, v14, v252
	v_dot2_f32_bf16 v252, v27, v15, v252
	s_nop 2
	v_add_f32_dpp v252, v252, v252 row_ror:8 row_mask:0xf bank_mask:0xf
	s_nop 1
	v_add_f32_dpp v252, v252, v252 row_ror:4 row_mask:0xf bank_mask:0xf
	s_nop 1
	v_add_f32_dpp v252, v252, v252 row_ror:2 row_mask:0xf bank_mask:0xf
	s_nop 1
	v_add_f32_dpp v252, v252, v252 row_ror:1 row_mask:0xf bank_mask:0xf
	v_cvt_pk_bf16_f32 v252, 0, v252
	v_mul_f32 v252, 0x3db504f3, v252
	s_waitcnt vmcnt(6)
	s_sub_u32 s62, s62, 1
	s_cbranch_scc1 L_c_11
L_c_11_b:
	buffer_load_dwordx4 v[56:59], v1, s[44:47], 0 offen nt
	v_xor_b32 v1, 0x800, v1
	buffer_load_dwordx4 v[60:63], v1, s[44:47], 0 offen nt
	v_xor_b32 v1, 0x1800, v1
	s_add_u32 s67, s67, 0x1000
	v_mov_b32 v3, s67
	ds_write_b32 v10, v3 offset:3072
	v_dot2_f32_bf16 v253, v28, v12, 0
	v_dot2_f32_bf16 v253, v29, v13, v253
	v_dot2_f32_bf16 v253, v30, v14, v253
	v_dot2_f32_bf16 v253, v31, v15, v253
	s_nop 2
	v_add_f32_dpp v253, v253, v253 row_ror:8 row_mask:0xf bank_mask:0xf
	s_nop 1
	v_add_f32_dpp v253, v253, v253 row_ror:4 row_mask:0xf bank_mask:0xf
	s_nop 1
	v_add_f32_dpp v253, v253, v253 row_ror:2 row_mask:0xf bank_mask:0xf
	s_nop 1
	v_add_f32_dpp v253, v253, v253 row_ror:1 row_mask:0xf bank_mask:0xf
	v_cvt_pk_bf16_f32 v253, 0, v253
	v_mul_f32 v253, 0x3db504f3, v253
	v_max3_f32 v11, v11, v252, v253
	v_cvt_pk_bf16_f32 v248, v252, v253
	s_waitcnt vmcnt(7)
	buffer_load_dwordx4 v[64:67], v1, s[44:47], 0 offen nt
	v_xor_b32 v1, 0x800, v1
	buffer_load_dwordx4 v[68:71], v1, s[44:47], 0 offen nt
	v_xor_b32 v1, 0x5800, v1
	v_dot2_f32_bf16 v252, v32, v12, 0
	v_dot2_f32_bf16 v252, v33, v13, v252
	v_dot2_f32_bf16 v252, v34, v14, v252
	v_dot2_f32_bf16 v252, v35, v15, v252
	s_nop 2
	v_add_f32_dpp v252, v252, v252 row_ror:8 row_mask:0xf bank_mask:0xf
	s_nop 1
	v_add_f32_dpp v252, v252, v252 row_ror:4 row_mask:0xf bank_mask:0xf
	s_nop 1
	v_add_f32_dpp v252, v252, v252 row_ror:2 row_mask:0xf bank_mask:0xf
	s_nop 1
	v_add_f32_dpp v252, v252, v252 row_ror:1 row_mask:0xf bank_mask:0xf
	v_cvt_pk_bf16_f32 v252, 0, v252
	v_mul_f32 v252, 0x3db504f3, v252
	s_waitcnt vmcnt(8)
	buffer_load_dwordx4 v[72:75], v1, s[44:47], 0 offen nt
	v_xor_b32 v1, 0x800, v1
	s_add_u32 s67, s67, 0x1000
	v_mov_b32 v3, s67
	ds_write_b32 v10, v3 offset:3072
	v_dot2_f32_bf16 v253, v36, v12, 0
	v_dot2_f32_bf16 v253, v37, v13, v253
	v_dot2_f32_bf16 v253, v38, v14, v253
	v_dot2_f32_bf16 v253, v39, v15, v253
	s_nop 2
	v_add_f32_dpp v253, v253, v253 row_ror:8 row_mask:0xf bank_mask:0xf
	s_nop 1
	v_add_f32_dpp v253, v253, v253 row_ror:4 row_mask:0xf bank_mask:0xf
	s_nop 1
	v_add_f32_dpp v253, v253, v253 row_ror:2 row_mask:0xf bank_mask:0xf
	s_nop 1
	v_add_f32_dpp v253, v253, v253 row_ror:1 row_mask:0xf bank_mask:0xf
	v_cvt_pk_bf16_f32 v253, 0, v253
	v_mul_f32 v253, 0x3db504f3, v253
	v_max3_f32 v11, v11, v252, v253
	v_cvt_pk_bf16_f32 v249, v252, v253
	s_waitcnt vmcnt(8)
	buffer_load_dwordx4 v[76:79], v1, s[44:47], 0 offen nt
	v_xor_b32 v1, 0x1800, v1
	v_dot2_f32_bf16 v252, v40, v12, 0
	v_dot2_f32_bf16 v252, v41, v13, v252
	v_dot2_f32_bf16 v252, v42, v14, v252
	v_dot2_f32_bf16 v252, v43, v15, v252
	s_nop 2
	v_add_f32_dpp v252, v252, v252 row_ror:8 row_mask:0xf bank_mask:0xf
	s_nop 1
	v_add_f32_dpp v252, v252, v252 row_ror:4 row_mask:0xf bank_mask:0xf
	s_nop 1
	v_add_f32_dpp v252, v252, v252 row_ror:2 row_mask:0xf bank_mask:0xf
	s_nop 1
	v_add_f32_dpp v252, v252, v252 row_ror:1 row_mask:0xf bank_mask:0xf
	v_cvt_pk_bf16_f32 v252, 0, v252
	v_mul_f32 v252, 0x3db504f3, v252
	s_waitcnt vmcnt(8)
	buffer_load_dwordx4 v[80:83], v1, s[44:47], 0 offen nt
	v_xor_b32 v1, 0x800, v1
	s_add_u32 s67, s67, 0x1000
	v_mov_b32 v3, s67
	ds_write_b32 v10, v3 offset:3072
	v_dot2_f32_bf16 v253, v44, v12, 0
	v_dot2_f32_bf16 v253, v45, v13, v253
	v_dot2_f32_bf16 v253, v46, v14, v253
	v_dot2_f32_bf16 v253, v47, v15, v253
	s_nop 2
	v_add_f32_dpp v253, v253, v253 row_ror:8 row_mask:0xf bank_mask:0xf
	s_nop 1
	v_add_f32_dpp v253, v253, v253 row_ror:4 row_mask:0xf bank_mask:0xf
	s_nop 1
	v_add_f32_dpp v253, v253, v253 row_ror:2 row_mask:0xf bank_mask:0xf
	s_nop 1
	v_add_f32_dpp v253, v253, v253 row_ror:1 row_mask:0xf bank_mask:0xf
	v_cvt_pk_bf16_f32 v253, 0, v253
	v_mul_f32 v253, 0x3db504f3, v253
	v_max3_f32 v11, v11, v252, v253
	v_cvt_pk_bf16_f32 v250, v252, v253
	s_waitcnt vmcnt(8)
	buffer_load_dwordx4 v[84:87], v1, s[44:47], 0 offen nt
	v_xor_b32 v1, 0x5800, v1
	v_add_u32 v1, 0x8000, v1
	v_dot2_f32_bf16 v252, v48, v12, 0
	v_dot2_f32_bf16 v252, v49, v13, v252
	v_dot2_f32_bf16 v252, v50, v14, v252
	v_dot2_f32_bf16 v252, v51, v15, v252
	s_nop 2
	v_add_f32_dpp v252, v252, v252 row_ror:8 row_mask:0xf bank_mask:0xf
	s_nop 1
	v_add_f32_dpp v252, v252, v252 row_ror:4 row_mask:0xf bank_mask:0xf
	s_nop 1
	v_add_f32_dpp v252, v252, v252 row_ror:2 row_mask:0xf bank_mask:0xf
	s_nop 1
	v_add_f32_dpp v252, v252, v252 row_ror:1 row_mask:0xf bank_mask:0xf
	v_cvt_pk_bf16_f32 v252, 0, v252
	v_mul_f32 v252, 0x3db504f3, v252
	s_waitcnt vmcnt(8)
	s_sub_u32 s62, s62, 1
	s_cbranch_scc1 L_c_12
L_c_12_b:
	buffer_load_dwordx4 v[24:27], v1, s[44:47], 0 offen nt
	v_xor_b32 v1, 0x800, v1
	s_add_u32 s67, s67, 0x1000
	v_mov_b32 v3, s67
	ds_write_b32 v10, v3 offset:3072
	ds_read_b32 v9, v10 offset:3088
	v_dot2_f32_bf16 v253, v52, v12, 0
	v_dot2_f32_bf16 v253, v53, v13, v253
	v_dot2_f32_bf16 v253, v54, v14, v253
	v_dot2_f32_bf16 v253, v55, v15, v253
	s_nop 2
	v_add_f32_dpp v253, v253, v253 row_ror:8 row_mask:0xf bank_mask:0xf
	s_nop 1
	v_add_f32_dpp v253, v253, v253 row_ror:4 row_mask:0xf bank_mask:0xf
	s_nop 1
	v_add_f32_dpp v253, v253, v253 row_ror:2 row_mask:0xf bank_mask:0xf
	s_nop 1
	v_add_f32_dpp v253, v253, v253 row_ror:1 row_mask:0xf bank_mask:0xf
	v_cvt_pk_bf16_f32 v253, 0, v253
	v_mul_f32 v253, 0x3db504f3, v253
	v_max3_f32 v11, v11, v252, v253
	v_cvt_pk_bf16_f32 v251, v252, v253
	s_mov_b32 exec_lo, 0x10001
	s_mov_b32 exec_hi, 0x10001
	ds_write_b128 v2, v[248:251]
	s_mov_b64 exec, -1
	v_add_u32 v2, 64, v2
	s_waitcnt lgkmcnt(1)
	v_readfirstlane_b32 s61, v9
	s_add_u32 s60, s60, 1
	s_cmp_eq_u32 s60, 54
	s_cbranch_scc1 L_kE_sw
	s_cmp_eq_u32 s61, 5
	s_cbranch_scc1 L_kB
	s_branch L_kX
L_kE_sw:
	s_call_b64 s[42:43], L_max
	s_cmp_eq_u32 s61, 5
	s_cbranch_scc1 L_vB
	s_branch L_vX
.p2align 4
L_kA:
	s_waitcnt vmcnt(8)
	buffer_load_dwordx4 v[60:63], v1, s[44:47], 0 offen nt
	v_xor_b32 v1, 0x1800, v1
	v_dot2_f32_bf16 v252, v24, v12, 0
	v_dot2_f32_bf16 v252, v25, v13, v252
	v_dot2_f32_bf16 v252, v26, v14, v252
	v_dot2_f32_bf16 v252, v27, v15, v252
	s_nop 2
	v_add_f32_dpp v252, v252, v252 row_ror:8 row_mask:0xf bank_mask:0xf
	s_nop 1
	v_add_f32_dpp v252, v252, v252 row_ror:4 row_mask:0xf bank_mask:0xf
	s_nop 1
	v_add_f32_dpp v252, v252, v252 row_ror:2 row_mask:0xf bank_mask:0xf
	s_nop 1
	v_add_f32_dpp v252, v252, v252 row_ror:1 row_mask:0xf bank_mask:0xf
	v_cvt_pk_bf16_f32 v252, 0, v252
	v_mul_f32 v252, 0x3db504f3, v252
	s_waitcnt vmcnt(8)
	buffer_load_dwordx4 v[64:67], v1, s[44:47], 0 offen nt
	v_xor_b32 v1, 0x800, v1
	s_add_u32 s67, s67, 0x1000
	v_mov_b32 v3, s67
	ds_write_b32 v10, v3 offset:3072
	v_dot2_f32_bf16 v253, v28, v12, 0
	v_dot2_f32_bf16 v253, v29, v13, v253
	v_dot2_f32_bf16 v253, v30, v14, v253
	v_dot2_f32_bf16 v253, v31, v15, v253
	s_nop 2
	v_add_f32_dpp v253, v253, v253 row_ror:8 row_mask:0xf bank_mask:0xf
	s_nop 1
	v_add_f32_dpp v253, v253, v253 row_ror:4 row_mask:0xf bank_mask:0xf
	s_nop 1
	v_add_f32_dpp v253, v253, v253 row_ror:2 row_mask:0xf bank_mask:0xf
	s_nop 1
	v_add_f32_dpp v253, v253, v253 row_ror:1 row_mask:0xf bank_mask:0xf
	v_cvt_pk_bf16_f32 v253, 0, v253
	v_mul_f32 v253, 0x3db504f3, v253
	v_max3_f32 v11, v11, v252, v253
	v_cvt_pk_bf16_f32 v248, v252, v253
	s_waitcnt vmcnt(8)
	buffer_load_dwordx4 v[68:71], v1, s[44:47], 0 offen nt
	v_xor_b32 v1, 0x5800, v1
	v_dot2_f32_bf16 v252, v32, v12, 0
	v_dot2_f32_bf16 v252, v33, v13, v252
	v_dot2_f32_bf16 v252, v34, v14, v252
	v_dot2_f32_bf16 v252, v35, v15, v252
	s_nop 2
	v_add_f32_dpp v252, v252, v252 row_ror:8 row_mask:0xf bank_mask:0xf
	s_nop 1
	v_add_f32_dpp v252, v252, v252 row_ror:4 row_mask:0xf bank_mask:0xf
	s_nop 1
	v_add_f32_dpp v252, v252, v252 row_ror:2 row_mask:0xf bank_mask:0xf
	s_nop 1
	v_add_f32_dpp v252, v252, v252 row_ror:1 row_mask:0xf bank_mask:0xf
	v_cvt_pk_bf16_f32 v252, 0, v252
	v_mul_f32 v252, 0x3db504f3, v252
	s_waitcnt vmcnt(8)
	buffer_load_dwordx4 v[72:75], v1, s[44:47], 0 offen nt
	v_xor_b32 v1, 0x800, v1
	s_add_u32 s67, s67, 0x1000
	v_mov_b32 v3, s67
	ds_write_b32 v10, v3 offset:3072
	v_dot2_f32_bf16 v253, v36, v12, 0
	v_dot2_f32_bf16 v253, v37, v13, v253
	v_dot2_f32_bf16 v253, v38, v14, v253
	v_dot2_f32_bf16 v253, v39, v15, v253
	s_nop 2
	v_add_f32_dpp v253, v253, v253 row_ror:8 row_mask:0xf bank_mask:0xf
	s_nop 1
	v_add_f32_dpp v253, v253, v253 row_ror:4 row_mask:0xf bank_mask:0xf
	s_nop 1
	v_add_f32_dpp v253, v253, v253 row_ror:2 row_mask:0xf bank_mask:0xf
	s_nop 1
	v_add_f32_dpp v253, v253, v253 row_ror:1 row_mask:0xf bank_mask:0xf
	v_cvt_pk_bf16_f32 v253, 0, v253
	v_mul_f32 v253, 0x3db504f3, v253
	v_max3_f32 v11, v11, v252, v253
	v_cvt_pk_bf16_f32 v249, v252, v253
	s_waitcnt vmcnt(8)
	buffer_load_dwordx4 v[76:79], v1, s[44:47], 0 offen nt
	v_xor_b32 v1, 0x1800, v1
	v_dot2_f32_bf16 v252, v40, v12, 0
	v_dot2_f32_bf16 v252, v41, v13, v252
	v_dot2_f32_bf16 v252, v42, v14, v252
	v_dot2_f32_bf16 v252, v43, v15, v252
	s_nop 2
	v_add_f32_dpp v252, v252, v252 row_ror:8 row_mask:0xf bank_mask:0xf
	s_nop 1
	v_add_f32_dpp v252, v252, v252 row_ror:4 row_mask:0xf bank_mask:0xf
	s_nop 1
	v_add_f32_dpp v252, v252, v252 row_ror:2 row_mask:0xf bank_mask:0xf
	s_nop 1
	v_add_f32_dpp v252, v252, v252 row_ror:1 row_mask:0xf bank_mask:0xf
	v_cvt_pk_bf16_f32 v252, 0, v252
	v_mul_f32 v252, 0x3db504f3, v252
	s_waitcnt vmcnt(8)
	buffer_load_dwordx4 v[80:83], v1, s[44:47], 0 offen nt
	v_xor_b32 v1, 0x800, v1
	s_add_u32 s67, s67, 0x1000
	v_mov_b32 v3, s67
	ds_write_b32 v10, v3 offset:3072
	v_dot2_f32_bf16 v253, v44, v12, 0
	v_dot2_f32_bf16 v253, v45, v13, v253
	v_dot2_f32_bf16 v253, v46, v14, v253
	v_dot2_f32_bf16 v253, v47, v15, v253
	s_nop 2
	v_add_f32_dpp v253, v253, v253 row_ror:8 row_mask:0xf bank_mask:0xf
	s_nop 1
	v_add_f32_dpp v253, v253, v253 row_ror:4 row_mask:0xf bank_mask:0xf
	s_nop 1
	v_add_f32_dpp v253, v253, v253 row_ror:2 row_mask:0xf bank_mask:0xf
	s_nop 1
	v_add_f32_dpp v253, v253, v253 row_ror:1 row_mask:0xf bank_mask:0xf
	v_cvt_pk_bf16_f32 v253, 0, v253
	v_mul_f32 v253, 0x3db504f3, v253
	v_max3_f32 v11, v11, v252, v253
	v_cvt_pk_bf16_f32 v250, v252, v253
	s_waitcnt vmcnt(8)
	buffer_load_dwordx4 v[84:87], v1, s[44:47], 0 offen nt
	v_xor_b32 v1, 0x5800, v1
	v_add_u32 v1, 0x8000, v1
	v_dot2_f32_bf16 v252, v48, v12, 0
	v_dot2_f32_bf16 v252, v49, v13, v252
	v_dot2_f32_bf16 v252, v50, v14, v252
	v_dot2_f32_bf16 v252, v51, v15, v252
	s_nop 2
	v_add_f32_dpp v252, v252, v252 row_ror:8 row_mask:0xf bank_mask:0xf
	s_nop 1
	v_add_f32_dpp v252, v252, v252 row_ror:4 row_mask:0xf bank_mask:0xf
	s_nop 1
	v_add_f32_dpp v252, v252, v252 row_ror:2 row_mask:0xf bank_mask:0xf
	s_nop 1
	v_add_f32_dpp v252, v252, v252 row_ror:1 row_mask:0xf bank_mask:0xf
	v_cvt_pk_bf16_f32 v252, 0, v252
	v_mul_f32 v252, 0x3db504f3, v252
	s_waitcnt vmcnt(8)
	s_sub_u32 s62, s62, 1
	s_cbranch_scc1 L_c_13
L_c_13_b:
	buffer_load_dwordx4 v[24:27], v1, s[44:47], 0 offen nt
	v_xor_b32 v1, 0x800, v1
	s_add_u32 s67, s67, 0x1000
	v_mov_b32 v3, s67
	ds_write_b32 v10, v3 offset:3072
	ds_read_b32 v9, v10 offset:3088
	v_dot2_f32_bf16 v253, v52, v12, 0
	v_dot2_f32_bf16 v253, v53, v13, v253
	v_dot2_f32_bf16 v253, v54, v14, v253
	v_dot2_f32_bf16 v253, v55, v15, v253
	s_nop 2
	v_add_f32_dpp v253, v253, v253 row_ror:8 row_mask:0xf bank_mask:0xf
	s_nop 1
	v_add_f32_dpp v253, v253, v253 row_ror:4 row_mask:0xf bank_mask:0xf
	s_nop 1
	v_add_f32_dpp v253, v253, v253 row_ror:2 row_mask:0xf bank_mask:0xf
	s_nop 1
	v_add_f32_dpp v253, v253, v253 row_ror:1 row_mask:0xf bank_mask:0xf
	v_cvt_pk_bf16_f32 v253, 0, v253
	v_mul_f32 v253, 0x3db504f3, v253
	v_max3_f32 v11, v11, v252, v253
	v_cvt_pk_bf16_f32 v251, v252, v253
	s_mov_b32 exec_lo, 0x10001
	s_mov_b32 exec_hi, 0x10001
	ds_write_b128 v2, v[248:251]
	s_mov_b64 exec, -1
	v_add_u32 v2, 64, v2
	s_waitcnt lgkmcnt(1)
	v_readfirstlane_b32 s61, v9
	s_add_u32 s60, s60, 1
	s_cmp_eq_u32 s60, 54
	s_cbranch_scc1 L_kA_sw
	s_cmp_eq_u32 s61, 5
	s_cbranch_scc1 L_kB
	s_branch L_kX
L_kA_sw:
	s_call_b64 s[42:43], L_max
	s_cmp_eq_u32 s61, 5
	s_cbranch_scc1 L_vB
	s_branch L_vX
.p2align 4
L_kB:
	s_waitcnt vmcnt(8)
	buffer_load_dwordx4 v[28:31], v1, s[44:47], 0 offen nt
	v_xor_b32 v1, 0x1800, v1
	v_dot2_f32_bf16 v252, v56, v12, 0
	v_dot2_f32_bf16 v252, v57, v13, v252
	v_dot2_f32_bf16 v252, v58, v14, v252
	v_dot2_f32_bf16 v252, v59, v15, v252
	s_nop 2
	v_add_f32_dpp v252, v252, v252 row_ror:8 row_mask:0xf bank_mask:0xf
	s_nop 1
	v_add_f32_dpp v252, v252, v252 row_ror:4 row_mask:0xf bank_mask:0xf
	s_nop 1
	v_add_f32_dpp v252, v252, v252 row_ror:2 row_mask:0xf bank_mask:0xf
	s_nop 1
	v_add_f32_dpp v252, v252, v252 row_ror:1 row_mask:0xf bank_mask:0xf
	v_cvt_pk_bf16_f32 v252, 0, v252
	v_mul_f32 v252, 0x3db504f3, v252
	s_waitcnt vmcnt(8)
	buffer_load_dwordx4 v[32:35], v1, s[44:47], 0 offen nt
	v_xor_b32 v1, 0x800, v1
	s_add_u32 s67, s67, 0x1000
	v_mov_b32 v3, s67
	ds_write_b32 v10, v3 offset:3072
	v_dot2_f32_bf16 v253, v60, v12, 0
	v_dot2_f32_bf16 v253, v61, v13, v253
	v_dot2_f32_bf16 v253, v62, v14, v253
	v_dot2_f32_bf16 v253, v63, v15, v253
	s_nop 2
	v_add_f32_dpp v253, v253, v253 row_ror:8 row_mask:0xf bank_mask:0xf
	s_nop 1
	v_add_f32_dpp v253, v253, v253 row_ror:4 row_mask:0xf bank_mask:0xf
	s_nop 1
	v_add_f32_dpp v253, v253, v253 row_ror:2 row_mask:0xf bank_mask:0xf
	s_nop 1
	v_add_f32_dpp v253, v253, v253 row_ror:1 row_mask:0xf bank_mask:0xf
	v_cvt_pk_bf16_f32 v253, 0, v253
	v_mul_f32 v253, 0x3db504f3, v253
	v_max3_f32 v11, v11, v252, v253
	v_cvt_pk_bf16_f32 v248, v252, v253
	s_waitcnt vmcnt(8)
	buffer_load_dwordx4 v[36:39], v1, s[44:47], 0 offen nt
	v_xor_b32 v1, 0x5800, v1
	v_dot2_f32_bf16 v252, v64, v12, 0
	v_dot2_f32_bf16 v252, v65, v13, v252
	v_dot2_f32_bf16 v252, v66, v14, v252
	v_dot2_f32_bf16 v252, v67, v15, v252
	s_nop 2
	v_add_f32_dpp v252, v252, v252 row_ror:8 row_mask:0xf bank_mask:0xf
	s_nop 1
	v_add_f32_dpp v252, v252, v252 row_ror:4 row_mask:0xf bank_mask:0xf
	s_nop 1
	v_add_f32_dpp v252, v252, v252 row_ror:2 row_mask:0xf bank_mask:0xf
	s_nop 1
	v_add_f32_dpp v252, v252, v252 row_ror:1 row_mask:0xf bank_mask:0xf
	v_cvt_pk_bf16_f32 v252, 0, v252
	v_mul_f32 v252, 0x3db504f3, v252
	s_waitcnt vmcnt(8)
	buffer_load_dwordx4 v[40:43], v1, s[44:47], 0 offen nt
	v_xor_b32 v1, 0x800, v1
	s_add_u32 s67, s67, 0x1000
	v_mov_b32 v3, s67
	ds_write_b32 v10, v3 offset:3072
	v_dot2_f32_bf16 v253, v68, v12, 0
	v_dot2_f32_bf16 v253, v69, v13, v253
	v_dot2_f32_bf16 v253, v70, v14, v253
	v_dot2_f32_bf16 v253, v71, v15, v253
	s_nop 2
	v_add_f32_dpp v253, v253, v253 row_ror:8 row_mask:0xf bank_mask:0xf
	s_nop 1
	v_add_f32_dpp v253, v253, v253 row_ror:4 row_mask:0xf bank_mask:0xf
	s_nop 1
	v_add_f32_dpp v253, v253, v253 row_ror:2 row_mask:0xf bank_mask:0xf
	s_nop 1
	v_add_f32_dpp v253, v253, v253 row_ror:1 row_mask:0xf bank_mask:0xf
	v_cvt_pk_bf16_f32 v253, 0, v253
	v_mul_f32 v253, 0x3db504f3, v253
	v_max3_f32 v11, v11, v252, v253
	v_cvt_pk_bf16_f32 v249, v252, v253
	s_waitcnt vmcnt(8)
	buffer_load_dwordx4 v[44:47], v1, s[44:47], 0 offen nt
	v_xor_b32 v1, 0x1800, v1
	v_dot2_f32_bf16 v252, v72, v12, 0
	v_dot2_f32_bf16 v252, v73, v13, v252
	v_dot2_f32_bf16 v252, v74, v14, v252
	v_dot2_f32_bf16 v252, v75, v15, v252
	s_nop 2
	v_add_f32_dpp v252, v252, v252 row_ror:8 row_mask:0xf bank_mask:0xf
	s_nop 1
	v_add_f32_dpp v252, v252, v252 row_ror:4 row_mask:0xf bank_mask:0xf
	s_nop 1
	v_add_f32_dpp v252, v252, v252 row_ror:2 row_mask:0xf bank_mask:0xf
	s_nop 1
	v_add_f32_dpp v252, v252, v252 row_ror:1 row_mask:0xf bank_mask:0xf
	v_cvt_pk_bf16_f32 v252, 0, v252
	v_mul_f32 v252, 0x3db504f3, v252
	s_waitcnt vmcnt(8)
	buffer_load_dwordx4 v[48:51], v1, s[44:47], 0 offen nt
	v_xor_b32 v1, 0x800, v1
	s_add_u32 s67, s67, 0x1000
	v_mov_b32 v3, s67
	ds_write_b32 v10, v3 offset:3072
	v_dot2_f32_bf16 v253, v76, v12, 0
	v_dot2_f32_bf16 v253, v77, v13, v253
	v_dot2_f32_bf16 v253, v78, v14, v253
	v_dot2_f32_bf16 v253, v79, v15, v253
	s_nop 2
	v_add_f32_dpp v253, v253, v253 row_ror:8 row_mask:0xf bank_mask:0xf
	s_nop 1
	v_add_f32_dpp v253, v253, v253 row_ror:4 row_mask:0xf bank_mask:0xf
	s_nop 1
	v_add_f32_dpp v253, v253, v253 row_ror:2 row_mask:0xf bank_mask:0xf
	s_nop 1
	v_add_f32_dpp v253, v253, v253 row_ror:1 row_mask:0xf bank_mask:0xf
	v_cvt_pk_bf16_f32 v253, 0, v253
	v_mul_f32 v253, 0x3db504f3, v253
	v_max3_f32 v11, v11, v252, v253
	v_cvt_pk_bf16_f32 v250, v252, v253
	s_waitcnt vmcnt(8)
	buffer_load_dwordx4 v[52:55], v1, s[44:47], 0 offen nt
	v_xor_b32 v1, 0x5800, v1
	v_add_u32 v1, 0x8000, v1
	v_dot2_f32_bf16 v252, v80, v12, 0
	v_dot2_f32_bf16 v252, v81, v13, v252
	v_dot2_f32_bf16 v252, v82, v14, v252
	v_dot2_f32_bf16 v252, v83, v15, v252
	s_nop 2
	v_add_f32_dpp v252, v252, v252 row_ror:8 row_mask:0xf bank_mask:0xf
	s_nop 1
	v_add_f32_dpp v252, v252, v252 row_ror:4 row_mask:0xf bank_mask:0xf
	s_nop 1
	v_add_f32_dpp v252, v252, v252 row_ror:2 row_mask:0xf bank_mask:0xf
	s_nop 1
	v_add_f32_dpp v252, v252, v252 row_ror:1 row_mask:0xf bank_mask:0xf
	v_cvt_pk_bf16_f32 v252, 0, v252
	v_mul_f32 v252, 0x3db504f3, v252
	s_waitcnt vmcnt(8)
	s_sub_u32 s62, s62, 1
	s_cbranch_scc1 L_c_14
L_c_14_b:
	buffer_load_dwordx4 v[56:59], v1, s[44:47], 0 offen nt
	v_xor_b32 v1, 0x800, v1
	s_add_u32 s67, s67, 0x1000
	v_mov_b32 v3, s67
	ds_write_b32 v10, v3 offset:3072
	ds_read_b32 v9, v10 offset:3088
	v_dot2_f32_bf16 v253, v84, v12, 0
	v_dot2_f32_bf16 v253, v85, v13, v253
	v_dot2_f32_bf16 v253, v86, v14, v253
	v_dot2_f32_bf16 v253, v87, v15, v253
	s_nop 2
	v_add_f32_dpp v253, v253, v253 row_ror:8 row_mask:0xf bank_mask:0xf
	s_nop 1
	v_add_f32_dpp v253, v253, v253 row_ror:4 row_mask:0xf bank_mask:0xf
	s_nop 1
	v_add_f32_dpp v253, v253, v253 row_ror:2 row_mask:0xf bank_mask:0xf
	s_nop 1
	v_add_f32_dpp v253, v253, v253 row_ror:1 row_mask:0xf bank_mask:0xf
	v_cvt_pk_bf16_f32 v253, 0, v253
	v_mul_f32 v253, 0x3db504f3, v253
	v_max3_f32 v11, v11, v252, v253
	v_cvt_pk_bf16_f32 v251, v252, v253
	s_mov_b32 exec_lo, 0x10001
	s_mov_b32 exec_hi, 0x10001
	ds_write_b128 v2, v[248:251]
	s_mov_b64 exec, -1
	v_add_u32 v2, 64, v2
	s_waitcnt lgkmcnt(1)
	v_readfirstlane_b32 s61, v9
	s_add_u32 s60, s60, 1
	s_cmp_eq_u32 s60, 54
	s_cbranch_scc1 L_kB_sw
	s_branch L_kA
L_kB_sw:
	s_call_b64 s[42:43], L_max
	s_branch L_vA
.p2align 4
L_kX:
	s_waitcnt vmcnt(8)
	buffer_load_dwordx4 v[28:31], v1, s[44:47], 0 offen nt
	v_xor_b32 v1, 0x1800, v1
	v_dot2_f32_bf16 v252, v56, v12, 0
	v_dot2_f32_bf16 v252, v57, v13, v252
	v_dot2_f32_bf16 v252, v58, v14, v252
	v_dot2_f32_bf16 v252, v59, v15, v252
	s_nop 2
	v_add_f32_dpp v252, v252, v252 row_ror:8 row_mask:0xf bank_mask:0xf
	s_nop 1
	v_add_f32_dpp v252, v252, v252 row_ror:4 row_mask:0xf bank_mask:0xf
	s_nop 1
	v_add_f32_dpp v252, v252, v252 row_ror:2 row_mask:0xf bank_mask:0xf
	s_nop 1
	v_add_f32_dpp v252, v252, v252 row_ror:1 row_mask:0xf bank_mask:0xf
	v_cvt_pk_bf16_f32 v252, 0, v252
	v_mul_f32 v252, 0x3db504f3, v252
	s_waitcnt vmcnt(8)
	buffer_load_dwordx4 v[32:35], v1, s[44:47], 0 offen nt
	v_xor_b32 v1, 0x800, v1
	s_add_u32 s67, s67, 0x1000
	v_mov_b32 v3, s67
	ds_write_b32 v10, v3 offset:3072
	v_dot2_f32_bf16 v253, v60, v12, 0
	v_dot2_f32_bf16 v253, v61, v13, v253
	v_dot2_f32_bf16 v253, v62, v14, v253
	v_dot2_f32_bf16 v253, v63, v15, v253
	s_nop 2
	v_add_f32_dpp v253, v253, v253 row_ror:8 row_mask:0xf bank_mask:0xf
	s_nop 1
	v_add_f32_dpp v253, v253, v253 row_ror:4 row_mask:0xf bank_mask:0xf
	s_nop 1
	v_add_f32_dpp v253, v253, v253 row_ror:2 row_mask:0xf bank_mask:0xf
	s_nop 1
	v_add_f32_dpp v253, v253, v253 row_ror:1 row_mask:0xf bank_mask:0xf
	v_cvt_pk_bf16_f32 v253, 0, v253
	v_mul_f32 v253, 0x3db504f3, v253
	v_max3_f32 v11, v11, v252, v253
	v_cvt_pk_bf16_f32 v248, v252, v253
	s_waitcnt vmcnt(8)
	buffer_load_dwordx4 v[36:39], v1, s[44:47], 0 offen nt
	v_xor_b32 v1, 0x5800, v1
	v_dot2_f32_bf16 v252, v64, v12, 0
	v_dot2_f32_bf16 v252, v65, v13, v252
	v_dot2_f32_bf16 v252, v66, v14, v252
	v_dot2_f32_bf16 v252, v67, v15, v252
	s_nop 2
	v_add_f32_dpp v252, v252, v252 row_ror:8 row_mask:0xf bank_mask:0xf
	s_nop 1
	v_add_f32_dpp v252, v252, v252 row_ror:4 row_mask:0xf bank_mask:0xf
	s_nop 1
	v_add_f32_dpp v252, v252, v252 row_ror:2 row_mask:0xf bank_mask:0xf
	s_nop 1
	v_add_f32_dpp v252, v252, v252 row_ror:1 row_mask:0xf bank_mask:0xf
	v_cvt_pk_bf16_f32 v252, 0, v252
	v_mul_f32 v252, 0x3db504f3, v252
	s_waitcnt vmcnt(8)
	buffer_load_dwordx4 v[40:43], v1, s[44:47], 0 offen nt
	v_xor_b32 v1, 0x800, v1
	s_add_u32 s67, s67, 0x1000
	v_mov_b32 v3, s67
	ds_write_b32 v10, v3 offset:3072
	v_dot2_f32_bf16 v253, v68, v12, 0
	v_dot2_f32_bf16 v253, v69, v13, v253
	v_dot2_f32_bf16 v253, v70, v14, v253
	v_dot2_f32_bf16 v253, v71, v15, v253
	s_nop 2
	v_add_f32_dpp v253, v253, v253 row_ror:8 row_mask:0xf bank_mask:0xf
	s_nop 1
	v_add_f32_dpp v253, v253, v253 row_ror:4 row_mask:0xf bank_mask:0xf
	s_nop 1
	v_add_f32_dpp v253, v253, v253 row_ror:2 row_mask:0xf bank_mask:0xf
	s_nop 1
	v_add_f32_dpp v253, v253, v253 row_ror:1 row_mask:0xf bank_mask:0xf
	v_cvt_pk_bf16_f32 v253, 0, v253
	v_mul_f32 v253, 0x3db504f3, v253
	v_max3_f32 v11, v11, v252, v253
	v_cvt_pk_bf16_f32 v249, v252, v253
	s_waitcnt vmcnt(8)
	buffer_load_dwordx4 v[44:47], v1, s[44:47], 0 offen nt
	v_xor_b32 v1, 0x1800, v1
	v_dot2_f32_bf16 v252, v72, v12, 0
	v_dot2_f32_bf16 v252, v73, v13, v252
	v_dot2_f32_bf16 v252, v74, v14, v252
	v_dot2_f32_bf16 v252, v75, v15, v252
	s_nop 2
	v_add_f32_dpp v252, v252, v252 row_ror:8 row_mask:0xf bank_mask:0xf
	s_nop 1
	v_add_f32_dpp v252, v252, v252 row_ror:4 row_mask:0xf bank_mask:0xf
	s_nop 1
	v_add_f32_dpp v252, v252, v252 row_ror:2 row_mask:0xf bank_mask:0xf
	s_nop 1
	v_add_f32_dpp v252, v252, v252 row_ror:1 row_mask:0xf bank_mask:0xf
	v_cvt_pk_bf16_f32 v252, 0, v252
	v_mul_f32 v252, 0x3db504f3, v252
	s_waitcnt vmcnt(8)
	s_add_u32 s67, s67, 0x1000
	v_mov_b32 v3, s67
	ds_write_b32 v10, v3 offset:3072
	v_dot2_f32_bf16 v253, v76, v12, 0
	v_dot2_f32_bf16 v253, v77, v13, v253
	v_dot2_f32_bf16 v253, v78, v14, v253
	v_dot2_f32_bf16 v253, v79, v15, v253
	s_nop 2
	v_add_f32_dpp v253, v253, v253 row_ror:8 row_mask:0xf bank_mask:0xf
	s_nop 1
	v_add_f32_dpp v253, v253, v253 row_ror:4 row_mask:0xf bank_mask:0xf
	s_nop 1
	v_add_f32_dpp v253, v253, v253 row_ror:2 row_mask:0xf bank_mask:0xf
	s_nop 1
	v_add_f32_dpp v253, v253, v253 row_ror:1 row_mask:0xf bank_mask:0xf
	v_cvt_pk_bf16_f32 v253, 0, v253
	v_mul_f32 v253, 0x3db504f3, v253
	v_max3_f32 v11, v11, v252, v253
	v_cvt_pk_bf16_f32 v250, v252, v253
	s_waitcnt vmcnt(7)
	v_dot2_f32_bf16 v252, v80, v12, 0
	v_dot2_f32_bf16 v252, v81, v13, v252
	v_dot2_f32_bf16 v252, v82, v14, v252
	v_dot2_f32_bf16 v252, v83, v15, v252
	s_nop 2
	v_add_f32_dpp v252, v252, v252 row_ror:8 row_mask:0xf bank_mask:0xf
	s_nop 1
	v_add_f32_dpp v252, v252, v252 row_ror:4 row_mask:0xf bank_mask:0xf
	s_nop 1
	v_add_f32_dpp v252, v252, v252 row_ror:2 row_mask:0xf bank_mask:0xf
	s_nop 1
	v_add_f32_dpp v252, v252, v252 row_ror:1 row_mask:0xf bank_mask:0xf
	v_cvt_pk_bf16_f32 v252, 0, v252
	v_mul_f32 v252, 0x3db504f3, v252
	s_waitcnt vmcnt(6)
	s_add_u32 s67, s67, 0x1000
	v_mov_b32 v3, s67
	ds_write_b32 v10, v3 offset:3072
	ds_read_b32 v9, v10 offset:3088
	v_dot2_f32_bf16 v253, v84, v12, 0
	v_dot2_f32_bf16 v253, v85, v13, v253
	v_dot2_f32_bf16 v253, v86, v14, v253
	v_dot2_f32_bf16 v253, v87, v15, v253
	s_nop 2
	v_add_f32_dpp v253, v253, v253 row_ror:8 row_mask:0xf bank_mask:0xf
	s_nop 1
	v_add_f32_dpp v253, v253, v253 row_ror:4 row_mask:0xf bank_mask:0xf
	s_nop 1
	v_add_f32_dpp v253, v253, v253 row_ror:2 row_mask:0xf bank_mask:0xf
	s_nop 1
	v_add_f32_dpp v253, v253, v253 row_ror:1 row_mask:0xf bank_mask:0xf
	v_cvt_pk_bf16_f32 v253, 0, v253
	v_mul_f32 v253, 0x3db504f3, v253
	v_max3_f32 v11, v11, v252, v253
	v_cvt_pk_bf16_f32 v251, v252, v253
	s_mov_b32 exec_lo, 0x10001
	s_mov_b32 exec_hi, 0x10001
	ds_write_b128 v2, v[248:251]
	s_mov_b64 exec, -1
	v_add_u32 v2, 64, v2
	s_waitcnt lgkmcnt(1)
	v_readfirstlane_b32 s61, v9
	s_add_u32 s60, s60, 1
	s_cmp_eq_u32 s60, 54
	s_cbranch_scc1 L_kX_sw
	s_cmp_eq_u32 s61, 4
	s_cbranch_scc1 L_k4
	s_cmp_eq_u32 s61, 2
	s_cbranch_scc1 L_k2
	s_cmp_eq_u32 s61, 1
	s_cbranch_scc1 L_k1
	s_cmp_eq_u32 s61, 3
	s_cbranch_scc1 L_k3
	s_cmp_eq_u32 s61, 0
	s_cbranch_scc1 L_k0
	s_branch L_kT
L_kX_sw:
	s_call_b64 s[42:43], L_max
	s_cmp_eq_u32 s61, 4
	s_cbranch_scc1 L_v4
	s_cmp_eq_u32 s61, 2
	s_cbranch_scc1 L_v2
	s_cmp_eq_u32 s61, 1
	s_cbranch_scc1 L_v1
	s_cmp_eq_u32 s61, 3
	s_cbranch_scc1 L_v3
	s_cmp_eq_u32 s61, 0
	s_cbranch_scc1 L_v0
	s_branch L_vT
.p2align 4
L_v0:
	ds_read_b128 v[248:251], v2
	v_add_u32 v2, 64, v2
	s_waitcnt vmcnt(5)
	s_waitcnt lgkmcnt(0)
	v_lshlrev_b32 v3, 16, v248
	v_fmamk_f32 v3, v3, 0x3fb8aa3b, v7
	v_exp_f32 v3, v3
	s_nop 0
	v_cvt_pk_bf16_f32 v4, v3, 0
	v_cvt_pk_bf16_f32 v5, 0, v3
	v_dot2c_f32_bf16 v16, v24, v4
	v_dot2c_f32_bf16 v17, v24, v5
	v_dot2c_f32_bf16 v18, v25, v4
	v_dot2c_f32_bf16 v19, v25, v5
	v_dot2c_f32_bf16 v20, v26, v4
	v_dot2c_f32_bf16 v21, v26, v5
	v_dot2c_f32_bf16 v22, v27, v4
	v_dot2c_f32_bf16 v23, v27, v5
	v_and_b32 v3, 0xffff0000, v248
	v_fmamk_f32 v3, v3, 0x3fb8aa3b, v7
	v_exp_f32 v3, v3
	s_nop 0
	v_cvt_pk_bf16_f32 v4, v3, 0
	v_cvt_pk_bf16_f32 v5, 0, v3
	s_waitcnt vmcnt(4)
	s_add_u32 s67, s67, 0x1000
	v_mov_b32 v3, s67
	ds_write_b32 v10, v3 offset:3072
	v_dot2c_f32_bf16 v16, v28, v4
	v_dot2c_f32_bf16 v17, v28, v5
	v_dot2c_f32_bf16 v18, v29, v4
	v_dot2c_f32_bf16 v19, v29, v5
	v_dot2c_f32_bf16 v20, v30, v4
	v_dot2c_f32_bf16 v21, v30, v5
	v_dot2c_f32_bf16 v22, v31, v4
	v_dot2c_f32_bf16 v23, v31, v5
	v_lshlrev_b32 v3, 16, v249
	v_fmamk_f32 v3, v3, 0x3fb8aa3b, v7
	v_exp_f32 v3, v3
	s_nop 0
	v_cvt_pk_bf16_f32 v4, v3, 0
	v_cvt_pk_bf16_f32 v5, 0, v3
	s_waitcnt vmcnt(3)
	v_dot2c_f32_bf16 v16, v32, v4
	v_dot2c_f32_bf16 v17, v32, v5
	v_dot2c_f32_bf16 v18, v33, v4
	v_dot2c_f32_bf16 v19, v33, v5
	v_dot2c_f32_bf16 v20, v34, v4
	v_dot2c_f32_bf16 v21, v34, v5
	v_dot2c_f32_bf16 v22, v35, v4
	v_dot2c_f32_bf16 v23, v35, v5
	v_and_b32 v3, 0xffff0000, v249
	v_fmamk_f32 v3, v3, 0x3fb8aa3b, v7
	v_exp_f32 v3, v3
	s_nop 0
	v_cvt_pk_bf16_f32 v4, v3, 0
	v_cvt_pk_bf16_f32 v5, 0, v3
	s_waitcnt vmcnt(2)
	buffer_load_dwordx4 v[48:51], v1, s[44:47], 0 offen nt
	v_xor_b32 v1, 0x800, v1
	s_add_u32 s67, s67, 0x1000
	v_mov_b32 v3, s67
	ds_write_b32 v10, v3 offset:3072
	v_dot2c_f32_bf16 v16, v36, v4
	v_dot2c_f32_bf16 v17, v36, v5
	v_dot2c_f32_bf16 v18, v37, v4
	v_dot2c_f32_bf16 v19, v37, v5
	v_dot2c_f32_bf16 v20, v38, v4
	v_dot2c_f32_bf16 v21, v38, v5
	v_dot2c_f32_bf16 v22, v39, v4
	v_dot2c_f32_bf16 v23, v39, v5
	v_lshlrev_b32 v3, 16, v250
	v_fmamk_f32 v3, v3, 0x3fb8aa3b, v7
	v_exp_f32 v3, v3
	s_nop 0
	v_cvt_pk_bf16_f32 v4, v3, 0
	v_cvt_pk_bf16_f32 v5, 0, v3
	s_waitcnt vmcnt(2)
	buffer_load_dwordx4 v[52:55], v1, s[44:47], 0 offen nt
	v_xor_b32 v1, 0x5800, v1
	v_add_u32 v1, 0x8000, v1
	v_dot2c_f32_bf16 v16, v40, v4
	v_dot2c_f32_bf16 v17, v40, v5
	v_dot2c_f32_bf16 v18, v41, v4
	v_dot2c_f32_bf16 v19, v41, v5
	v_dot2c_f32_bf16 v20, v42, v4
	v_dot2c_f32_bf16 v21, v42, v5
	v_dot2c_f32_bf16 v22, v43, v4
	v_dot2c_f32_bf16 v23, v43, v5
	v_and_b32 v3, 0xffff0000, v250
	v_fmamk_f32 v3, v3, 0x3fb8aa3b, v7
	v_exp_f32 v3, v3
	s_nop 0
	v_cvt_pk_bf16_f32 v4, v3, 0
	v_cvt_pk_bf16_f32 v5, 0, v3
	s_waitcnt vmcnt(2)
	buffer_load_dwordx4 v[24:27], v1, s[44:47], 0 offen nt
	v_xor_b32 v1, 0x800, v1
	buffer_load_dwordx4 v[28:31], v1, s[44:47], 0 offen nt
	v_xor_b32 v1, 0x1800, v1
	s_add_u32 s67, s67, 0x1000
	v_mov_b32 v3, s67
	ds_write_b32 v10, v3 offset:3072
	v_dot2c_f32_bf16 v16, v44, v4
	v_dot2c_f32_bf16 v17, v44, v5
	v_dot2c_f32_bf16 v18, v45, v4
	v_dot2c_f32_bf16 v19, v45, v5
	v_dot2c_f32_bf16 v20, v46, v4
	v_dot2c_f32_bf16 v21, v46, v5
	v_dot2c_f32_bf16 v22, v47, v4
	v_dot2c_f32_bf16 v23, v47, v5
	v_lshlrev_b32 v3, 16, v251
	v_fmamk_f32 v3, v3, 0x3fb8aa3b, v7
	v_exp_f32 v3, v3
	s_nop 0
	v_cvt_pk_bf16_f32 v4, v3, 0
	v_cvt_pk_bf16_f32 v5, 0, v3
	s_waitcnt vmcnt(3)
	buffer_load_dwordx4 v[32:35], v1, s[44:47], 0 offen nt
	v_xor_b32 v1, 0x800, v1
	buffer_load_dwordx4 v[36:39], v1, s[44:47], 0 offen nt
	v_xor_b32 v1, 0x5800, v1
	v_dot2c_f32_bf16 v16, v48, v4
	v_dot2c_f32_bf16 v17, v48, v5
	v_dot2c_f32_bf16 v18, v49, v4
	v_dot2c_f32_bf16 v19, v49, v5
	v_dot2c_f32_bf16 v20, v50, v4
	v_dot2c_f32_bf16 v21, v50, v5
	v_dot2c_f32_bf16 v22, v51, v4
	v_dot2c_f32_bf16 v23, v51, v5
	v_and_b32 v3, 0xffff0000, v251
	v_fmamk_f32 v3, v3, 0x3fb8aa3b, v7
	v_exp_f32 v3, v3
	s_nop 0
	v_cvt_pk_bf16_f32 v4, v3, 0
	v_cvt_pk_bf16_f32 v5, 0, v3
	s_waitcnt vmcnt(4)
	buffer_load_dwordx4 v[40:43], v1, s[44:47], 0 offen nt
	v_xor_b32 v1, 0x800, v1
	buffer_load_dwordx4 v[44:47], v1, s[44:47], 0 offen nt
	v_xor_b32 v1, 0x1800, v1
	s_add_u32 s67, s67, 0x1000
	v_mov_b32 v3, s67
	ds_write_b32 v10, v3 offset:3072
	ds_read_b32 v9, v10 offset:3088
	v_dot2c_f32_bf16 v16, v52, v4
	v_dot2c_f32_bf16 v17, v52, v5
	v_dot2c_f32_bf16 v18, v53, v4
	v_dot2c_f32_bf16 v19, v53, v5
	v_dot2c_f32_bf16 v20, v54, v4
	v_dot2c_f32_bf16 v21, v54, v5
	v_dot2c_f32_bf16 v22, v55, v4
	v_dot2c_f32_bf16 v23, v55, v5
	s_waitcnt lgkmcnt(0)
	v_readfirstlane_b32 s61, v9
	s_cmp_eq_u32 s60, 61
	s_cbranch_scc1 L_c_15
L_c_15_b:
	s_add_u32 s60, s60, 1
	s_cmp_eq_u32 s60, 118
	s_cbranch_scc1 L_sdone
	s_cmp_eq_u32 s61, 0
	s_cbranch_scc1 L_v0
	s_cmp_eq_u32 s61, 2
	s_cbranch_scc1 L_v2
	s_cmp_eq_u32 s61, 1
	s_cbranch_scc1 L_v1
	s_cmp_eq_u32 s61, 3
	s_cbranch_scc1 L_v3
	s_cmp_eq_u32 s61, 4
	s_cbranch_scc1 L_v4
	s_branch L_vT
.p2align 4
L_v1:
	ds_read_b128 v[248:251], v2
	v_add_u32 v2, 64, v2
	s_waitcnt vmcnt(5)
	s_waitcnt lgkmcnt(0)
	v_lshlrev_b32 v3, 16, v248
	v_fmamk_f32 v3, v3, 0x3fb8aa3b, v7
	v_exp_f32 v3, v3
	s_nop 0
	v_cvt_pk_bf16_f32 v4, v3, 0
	v_cvt_pk_bf16_f32 v5, 0, v3
	v_dot2c_f32_bf16 v16, v24, v4
	v_dot2c_f32_bf16 v17, v24, v5
	v_dot2c_f32_bf16 v18, v25, v4
	v_dot2c_f32_bf16 v19, v25, v5
	v_dot2c_f32_bf16 v20, v26, v4
	v_dot2c_f32_bf16 v21, v26, v5
	v_dot2c_f32_bf16 v22, v27, v4
	v_dot2c_f32_bf16 v23, v27, v5
	v_and_b32 v3, 0xffff0000, v248
	v_fmamk_f32 v3, v3, 0x3fb8aa3b, v7
	v_exp_f32 v3, v3
	s_nop 0
	v_cvt_pk_bf16_f32 v4, v3, 0
	v_cvt_pk_bf16_f32 v5, 0, v3
	s_waitcnt vmcnt(4)
	s_add_u32 s67, s67, 0x1000
	v_mov_b32 v3, s67
	ds_write_b32 v10, v3 offset:3072
	v_dot2c_f32_bf16 v16, v28, v4
	v_dot2c_f32_bf16 v17, v28, v5
	v_dot2c_f32_bf16 v18, v29, v4
	v_dot2c_f32_bf16 v19, v29, v5
	v_dot2c_f32_bf16 v20, v30, v4
	v_dot2c_f32_bf16 v21, v30, v5
	v_dot2c_f32_bf16 v22, v31, v4
	v_dot2c_f32_bf16 v23, v31, v5
	v_lshlrev_b32 v3, 16, v249
	v_fmamk_f32 v3, v3, 0x3fb8aa3b, v7
	v_exp_f32 v3, v3
	s_nop 0
	v_cvt_pk_bf16_f32 v4, v3, 0
	v_cvt_pk_bf16_f32 v5, 0, v3
	s_waitcnt vmcnt(3)
	buffer_load_dwordx4 v[48:51], v1, s[44:47], 0 offen nt
	v_xor_b32 v1, 0x800, v1
	v_dot2c_f32_bf16 v16, v32, v4
	v_dot2c_f32_bf16 v17, v32, v5
	v_dot2c_f32_bf16 v18, v33, v4
	v_dot2c_f32_bf16 v19, v33, v5
	v_dot2c_f32_bf16 v20, v34, v4
	v_dot2c_f32_bf16 v21, v34, v5
	v_dot2c_f32_bf16 v22, v35, v4
	v_dot2c_f32_bf16 v23, v35, v5
	v_and_b32 v3, 0xffff0000, v249
	v_fmamk_f32 v3, v3, 0x3fb8aa3b, v7
	v_exp_f32 v3, v3
	s_nop 0
	v_cvt_pk_bf16_f32 v4, v3, 0
	v_cvt_pk_bf16_f32 v5, 0, v3
	s_waitcnt vmcnt(3)
	buffer_load_dwordx4 v[52:55], v1, s[44:47], 0 offen nt
	v_xor_b32 v1, 0x5800, v1
	v_add_u32 v1, 0x8000, v1
	s_add_u32 s67, s67, 0x1000
	v_mov_b32 v3, s67
	ds_write_b32 v10, v3 offset:3072
	v_dot2c_f32_bf16 v16, v36, v4
	v_dot2c_f32_bf16 v17, v36, v5
	v_dot2c_f32_bf16 v18, v37, v4
	v_dot2c_f32_bf16 v19, v37, v5
	v_dot2c_f32_bf16 v20, v38, v4
	v_dot2c_f32_bf16 v21, v38, v5
	v_dot2c_f32_bf16 v22, v39, v4
	v_dot2c_f32_bf16 v23, v39, v5
	v_lshlrev_b32 v3, 16, v250
	v_fmamk_f32 v3, v3, 0x3fb8aa3b, v7
	v_exp_f32 v3, v3
	s_nop 0
	v_cvt_pk_bf16_f32 v4, v3, 0
	v_cvt_pk_bf16_f32 v5, 0, v3
	s_waitcnt vmcnt(3)
	buffer_load_dwordx4 v[24:27], v1, s[44:47], 0 offen nt
	v_xor_b32 v1, 0x800, v1
	v_dot2c_f32_bf16 v16, v40, v4
	v_dot2c_f32_bf16 v17, v40, v5
	v_dot2c_f32_bf16 v18, v41, v4
	v_dot2c_f32_bf16 v19, v41, v5
	v_dot2c_f32_bf16 v20, v42, v4
	v_dot2c_f32_bf16 v21, v42, v5
	v_dot2c_f32_bf16 v22, v43, v4
	v_dot2c_f32_bf16 v23, v43, v5
	v_and_b32 v3, 0xffff0000, v250
	v_fmamk_f32 v3, v3, 0x3fb8aa3b, v7
	v_exp_f32 v3, v3
	s_nop 0
	v_cvt_pk_bf16_f32 v4, v3, 0
	v_cvt_pk_bf16_f32 v5, 0, v3
	s_waitcnt vmcnt(3)
	buffer_load_dwordx4 v[28:31], v1, s[44:47], 0 offen nt
	v_xor_b32 v1, 0x1800, v1
	s_add_u32 s67, s67, 0x1000
	v_mov_b32 v3, s67
	ds_write_b32 v10, v3 offset:3072
	v_dot2c_f32_bf16 v16, v44, v4
	v_dot2c_f32_bf16 v17, v44, v5
	v_dot2c_f32_bf16 v18, v45, v4
	v_dot2c_f32_bf16 v19, v45, v5
	v_dot2c_f32_bf16 v20, v46, v4
	v_dot2c_f32_bf16 v21, v46, v5
	v_dot2c_f32_bf16 v22, v47, v4
	v_dot2c_f32_bf16 v23, v47, v5
	v_lshlrev_b32 v3, 16, v251
	v_fmamk_f32 v3, v3, 0x3fb8aa3b, v7
	v_exp_f32 v3, v3
	s_nop 0
	v_cvt_pk_bf16_f32 v4, v3, 0
	v_cvt_pk_bf16_f32 v5, 0, v3
	s_waitcnt vmcnt(3)
	buffer_load_dwordx4 v[32:35], v1, s[44:47], 0 offen nt
	v_xor_b32 v1, 0x800, v1
	buffer_load_dwordx4 v[36:39], v1, s[44:47], 0 offen nt
	v_xor_b32 v1, 0x5800, v1
	v_dot2c_f32_bf16 v16, v48, v4
	v_dot2c_f32_bf16 v17, v48, v5
	v_dot2c_f32_bf16 v18, v49, v4
	v_dot2c_f32_bf16 v19, v49, v5
	v_dot2c_f32_bf16 v20, v50, v4
	v_dot2c_f32_bf16 v21, v50, v5
	v_dot2c_f32_bf16 v22, v51, v4
	v_dot2c_f32_bf16 v23, v51, v5
	v_and_b32 v3, 0xffff0000, v251
	v_fmamk_f32 v3, v3, 0x3fb8aa3b, v7
	v_exp_f32 v3, v3
	s_nop 0
	v_cvt_pk_bf16_f32 v4, v3, 0
	v_cvt_pk_bf16_f32 v5, 0, v3
	s_waitcnt vmcnt(4)
	buffer_load_dwordx4 v[40:43], v1, s[44:47], 0 offen nt
	v_xor_b32 v1, 0x800, v1
	buffer_load_dwordx4 v[44:47], v1, s[44:47], 0 offen nt
	v_xor_b32 v1, 0x1800, v1
	s_add_u32 s67, s67, 0x1000
	v_mov_b32 v3, s67
	ds_write_b32 v10, v3 offset:3072
	ds_read_b32 v9, v10 offset:3088
	v_dot2c_f32_bf16 v16, v52, v4
	v_dot2c_f32_bf16 v17, v52, v5
	v_dot2c_f32_bf16 v18, v53, v4
	v_dot2c_f32_bf16 v19, v53, v5
	v_dot2c_f32_bf16 v20, v54, v4
	v_dot2c_f32_bf16 v21, v54, v5
	v_dot2c_f32_bf16 v22, v55, v4
	v_dot2c_f32_bf16 v23, v55, v5
	s_waitcnt lgkmcnt(0)
	v_readfirstlane_b32 s61, v9
	s_cmp_eq_u32 s60, 61
	s_cbranch_scc1 L_c_16
L_c_16_b:
	s_add_u32 s60, s60, 1
	s_cmp_eq_u32 s60, 118
	s_cbranch_scc1 L_sdone
	s_cmp_eq_u32 s61, 1
	s_cbranch_scc1 L_v1
	s_cmp_eq_u32 s61, 2
	s_cbranch_scc1 L_v2
	s_cmp_eq_u32 s61, 3
	s_cbranch_scc1 L_v3
	s_cmp_eq_u32 s61, 0
	s_cbranch_scc1 L_v0
	s_cmp_eq_u32 s61, 4
	s_cbranch_scc1 L_v4
	s_branch L_vT
.p2align 4
L_v2:
	ds_read_b128 v[248:251], v2
	v_add_u32 v2, 64, v2
	s_waitcnt vmcnt(5)
	s_waitcnt lgkmcnt(0)
	v_lshlrev_b32 v3, 16, v248
	v_fmamk_f32 v3, v3, 0x3fb8aa3b, v7
	v_exp_f32 v3, v3
	s_nop 0
	v_cvt_pk_bf16_f32 v4, v3, 0
	v_cvt_pk_bf16_f32 v5, 0, v3
	v_dot2c_f32_bf16 v16, v24, v4
	v_dot2c_f32_bf16 v17, v24, v5
	v_dot2c_f32_bf16 v18, v25, v4
	v_dot2c_f32_bf16 v19, v25, v5
	v_dot2c_f32_bf16 v20, v26, v4
	v_dot2c_f32_bf16 v21, v26, v5
	v_dot2c_f32_bf16 v22, v27, v4
	v_dot2c_f32_bf16 v23, v27, v5
	v_and_b32 v3, 0xffff0000, v248
	v_fmamk_f32 v3, v3, 0x3fb8aa3b, v7
	v_exp_f32 v3, v3
	s_nop 0
	v_cvt_pk_bf16_f32 v4, v3, 0
	v_cvt_pk_bf16_f32 v5, 0, v3
	s_waitcnt vmcnt(4)
	buffer_load_dwordx4 v[48:51], v1, s[44:47], 0 offen nt
	v_xor_b32 v1, 0x800, v1
	s_add_u32 s67, s67, 0x1000
	v_mov_b32 v3, s67
	ds_write_b32 v10, v3 offset:3072
	v_dot2c_f32_bf16 v16, v28, v4
	v_dot2c_f32_bf16 v17, v28, v5
	v_dot2c_f32_bf16 v18, v29, v4
	v_dot2c_f32_bf16 v19, v29, v5
	v_dot2c_f32_bf16 v20, v30, v4
	v_dot2c_f32_bf16 v21, v30, v5
	v_dot2c_f32_bf16 v22, v31, v4
	v_dot2c_f32_bf16 v23, v31, v5
	v_lshlrev_b32 v3, 16, v249
	v_fmamk_f32 v3, v3, 0x3fb8aa3b, v7
	v_exp_f32 v3, v3
	s_nop 0
	v_cvt_pk_bf16_f32 v4, v3, 0
	v_cvt_pk_bf16_f32 v5, 0, v3
	s_waitcnt vmcnt(4)
	buffer_load_dwordx4 v[52:55], v1, s[44:47], 0 offen nt
	v_xor_b32 v1, 0x5800, v1
	v_add_u32 v1, 0x8000, v1
	v_dot2c_f32_bf16 v16, v32, v4
	v_dot2c_f32_bf16 v17, v32, v5
	v_dot2c_f32_bf16 v18, v33, v4
	v_dot2c_f32_bf16 v19, v33, v5
	v_dot2c_f32_bf16 v20, v34, v4
	v_dot2c_f32_bf16 v21, v34, v5
	v_dot2c_f32_bf16 v22, v35, v4
	v_dot2c_f32_bf16 v23, v35, v5
	v_and_b32 v3, 0xffff0000, v249
	v_fmamk_f32 v3, v3, 0x3fb8aa3b, v7
	v_exp_f32 v3, v3
	s_nop 0
	v_cvt_pk_bf16_f32 v4, v3, 0
	v_cvt_pk_bf16_f32 v5, 0, v3
	s_waitcnt vmcnt(4)
	buffer_load_dwordx4 v[24:27], v1, s[44:47], 0 offen nt
	v_xor_b32 v1, 0x800, v1
	s_add_u32 s67, s67, 0x1000
	v_mov_b32 v3, s67
	ds_write_b32 v10, v3 offset:3072
	v_dot2c_f32_bf16 v16, v36, v4
	v_dot2c_f32_bf16 v17, v36, v5
	v_dot2c_f32_bf16 v18, v37, v4
	v_dot2c_f32_bf16 v19, v37, v5
	v_dot2c_f32_bf16 v20, v38, v4
	v_dot2c_f32_bf16 v21, v38, v5
	v_dot2c_f32_bf16 v22, v39, v4
	v_dot2c_f32_bf16 v23, v39, v5
	v_lshlrev_b32 v3, 16, v250
	v_fmamk_f32 v3, v3, 0x3fb8aa3b, v7
	v_exp_f32 v3, v3
	s_nop 0
	v_cvt_pk_bf16_f32 v4, v3, 0
	v_cvt_pk_bf16_f32 v5, 0, v3
	s_waitcnt vmcnt(4)
	buffer_load_dwordx4 v[28:31], v1, s[44:47], 0 offen nt
	v_xor_b32 v1, 0x1800, v1
	v_dot2c_f32_bf16 v16, v40, v4
	v_dot2c_f32_bf16 v17, v40, v5
	v_dot2c_f32_bf16 v18, v41, v4
	v_dot2c_f32_bf16 v19, v41, v5
	v_dot2c_f32_bf16 v20, v42, v4
	v_dot2c_f32_bf16 v21, v42, v5
	v_dot2c_f32_bf16 v22, v43, v4
	v_dot2c_f32_bf16 v23, v43, v5
	v_and_b32 v3, 0xffff0000, v250
	v_fmamk_f32 v3, v3, 0x3fb8aa3b, v7
	v_exp_f32 v3, v3
	s_nop 0
	v_cvt_pk_bf16_f32 v4, v3, 0
	v_cvt_pk_bf16_f32 v5, 0, v3
	s_waitcnt vmcnt(4)
	buffer_load_dwordx4 v[32:35], v1, s[44:47], 0 offen nt
	v_xor_b32 v1, 0x800, v1
	s_add_u32 s67, s67, 0x1000
	v_mov_b32 v3, s67
	ds_write_b32 v10, v3 offset:3072
	v_dot2c_f32_bf16 v16, v44, v4
	v_dot2c_f32_bf16 v17, v44, v5
	v_dot2c_f32_bf16 v18, v45, v4
	v_dot2c_f32_bf16 v19, v45, v5
	v_dot2c_f32_bf16 v20, v46, v4
	v_dot2c_f32_bf16 v21, v46, v5
	v_dot2c_f32_bf16 v22, v47, v4
	v_dot2c_f32_bf16 v23, v47, v5
	v_lshlrev_b32 v3, 16, v251
	v_fmamk_f32 v3, v3, 0x3fb8aa3b, v7
	v_exp_f32 v3, v3
	s_nop 0
	v_cvt_pk_bf16_f32 v4, v3, 0
	v_cvt_pk_bf16_f32 v5, 0, v3
	s_waitcnt vmcnt(4)
	buffer_load_dwordx4 v[36:39], v1, s[44:47], 0 offen nt
	v_xor_b32 v1, 0x5800, v1
	v_dot2c_f32_bf16 v16, v48, v4
	v_dot2c_f32_bf16 v17, v48, v5
	v_dot2c_f32_bf16 v18, v49, v4
	v_dot2c_f32_bf16 v19, v49, v5
	v_dot2c_f32_bf16 v20, v50, v4
	v_dot2c_f32_bf16 v21, v50, v5
	v_dot2c_f32_bf16 v22, v51, v4
	v_dot2c_f32_bf16 v23, v51, v5
	v_and_b32 v3, 0xffff0000, v251
	v_fmamk_f32 v3, v3, 0x3fb8aa3b, v7
	v_exp_f32 v3, v3
	s_nop 0
	v_cvt_pk_bf16_f32 v4, v3, 0
	v_cvt_pk_bf16_f32 v5, 0, v3
	s_waitcnt vmcnt(4)
	buffer_load_dwordx4 v[40:43], v1, s[44:47], 0 offen nt
	v_xor_b32 v1, 0x800, v1
	buffer_load_dwordx4 v[44:47], v1, s[44:47], 0 offen nt
	v_xor_b32 v1, 0x1800, v1
	s_add_u32 s67, s67, 0x1000
	v_mov_b32 v3, s67
	ds_write_b32 v10, v3 offset:3072
	ds_read_b32 v9, v10 offset:3088
	v_dot2c_f32_bf16 v16, v52, v4
	v_dot2c_f32_bf16 v17, v52, v5
	v_dot2c_f32_bf16 v18, v53, v4
	v_dot2c_f32_bf16 v19, v53, v5
	v_dot2c_f32_bf16 v20, v54, v4
	v_dot2c_f32_bf16 v21, v54, v5
	v_dot2c_f32_bf16 v22, v55, v4
	v_dot2c_f32_bf16 v23, v55, v5
	s_waitcnt lgkmcnt(0)
	v_readfirstlane_b32 s61, v9
	s_cmp_eq_u32 s60, 61
	s_cbranch_scc1 L_c_17
L_c_17_b:
	s_add_u32 s60, s60, 1
	s_cmp_eq_u32 s60, 118
	s_cbranch_scc1 L_sdone
	s_cmp_eq_u32 s61, 2
	s_cbranch_scc1 L_v2
	s_cmp_eq_u32 s61, 1
	s_cbranch_scc1 L_v1
	s_cmp_eq_u32 s61, 3
	s_cbranch_scc1 L_v3
	s_cmp_eq_u32 s61, 0
	s_cbranch_scc1 L_v0
	s_cmp_eq_u32 s61, 4
	s_cbranch_scc1 L_v4
	s_branch L_vT
.p2align 4
L_v3:
	ds_read_b128 v[248:251], v2
	v_add_u32 v2, 64, v2
	s_waitcnt vmcnt(5)
	buffer_load_dwordx4 v[48:51], v1, s[44:47], 0 offen nt
	v_xor_b32 v1, 0x800, v1
	s_waitcnt lgkmcnt(0)
	v_lshlrev_b32 v3, 16, v248
	v_fmamk_f32 v3, v3, 0x3fb8aa3b, v7
	v_exp_f32 v3, v3
	s_nop 0
	v_cvt_pk_bf16_f32 v4, v3, 0
	v_cvt_pk_bf16_f32 v5, 0, v3
	v_dot2c_f32_bf16 v16, v24, v4
	v_dot2c_f32_bf16 v17, v24, v5
	v_dot2c_f32_bf16 v18, v25, v4
	v_dot2c_f32_bf16 v19, v25, v5
	v_dot2c_f32_bf16 v20, v26, v4
	v_dot2c_f32_bf16 v21, v26, v5
	v_dot2c_f32_bf16 v22, v27, v4
	v_dot2c_f32_bf16 v23, v27, v5
	v_and_b32 v3, 0xffff0000, v248
	v_fmamk_f32 v3, v3, 0x3fb8aa3b, v7
	v_exp_f32 v3, v3
	s_nop 0
	v_cvt_pk_bf16_f32 v4, v3, 0
	v_cvt_pk_bf16_f32 v5, 0, v3
	s_waitcnt vmcnt(5)
	buffer_load_dwordx4 v[52:55], v1, s[44:47], 0 offen nt
	v_xor_b32 v1, 0x5800, v1
	v_add_u32 v1, 0x8000, v1
	s_add_u32 s67, s67, 0x1000
	v_mov_b32 v3, s67
	ds_write_b32 v10, v3 offset:3072
	v_dot2c_f32_bf16 v16, v28, v4
	v_dot2c_f32_bf16 v17, v28, v5
	v_dot2c_f32_bf16 v18, v29, v4
	v_dot2c_f32_bf16 v19, v29, v5
	v_dot2c_f32_bf16 v20, v30, v4
	v_dot2c_f32_bf16 v21, v30, v5
	v_dot2c_f32_bf16 v22, v31, v4
	v_dot2c_f32_bf16 v23, v31, v5
	v_lshlrev_b32 v3, 16, v249
	v_fmamk_f32 v3, v3, 0x3fb8aa3b, v7
	v_exp_f32 v3, v3
	s_nop 0
	v_cvt_pk_bf16_f32 v4, v3, 0
	v_cvt_pk_bf16_f32 v5, 0, v3
	s_waitcnt vmcnt(5)
	buffer_load_dwordx4 v[24:27], v1, s[44:47], 0 offen nt
	v_xor_b32 v1, 0x800, v1
	v_dot2c_f32_bf16 v16, v32, v4
	v_dot2c_f32_bf16 v17, v32, v5
	v_dot2c_f32_bf16 v18, v33, v4
	v_dot2c_f32_bf16 v19, v33, v5
	v_dot2c_f32_bf16 v20, v34, v4
	v_dot2c_f32_bf16 v21, v34, v5
	v_dot2c_f32_bf16 v22, v35, v4
	v_dot2c_f32_bf16 v23, v35, v5
	v_and_b32 v3, 0xffff0000, v249
	v_fmamk_f32 v3, v3, 0x3fb8aa3b, v7
	v_exp_f32 v3, v3
	s_nop 0
	v_cvt_pk_bf16_f32 v4, v3, 0
	v_cvt_pk_bf16_f32 v5, 0, v3
	s_waitcnt vmcnt(5)
	buffer_load_dwordx4 v[28:31], v1, s[44:47], 0 offen nt
	v_xor_b32 v1, 0x1800, v1
	s_add_u32 s67, s67, 0x1000
	v_mov_b32 v3, s67
	ds_write_b32 v10, v3 offset:3072
	v_dot2c_f32_bf16 v16, v36, v4
	v_dot2c_f32_bf16 v17, v36, v5
	v_dot2c_f32_bf16 v18, v37, v4
	v_dot2c_f32_bf16 v19, v37, v5
	v_dot2c_f32_bf16 v20, v38, v4
	v_dot2c_f32_bf16 v21, v38, v5
	v_dot2c_f32_bf16 v22, v39, v4
	v_dot2c_f32_bf16 v23, v39, v5
	v_lshlrev_b32 v3, 16, v250
	v_fmamk_f32 v3, v3, 0x3fb8aa3b, v7
	v_exp_f32 v3, v3
	s_nop 0
	v_cvt_pk_bf16_f32 v4, v3, 0
	v_cvt_pk_bf16_f32 v5, 0, v3
	s_waitcnt vmcnt(5)
	buffer_load_dwordx4 v[32:35], v1, s[44:47], 0 offen nt
	v_xor_b32 v1, 0x800, v1
	v_dot2c_f32_bf16 v16, v40, v4
	v_dot2c_f32_bf16 v17, v40, v5
	v_dot2c_f32_bf16 v18, v41, v4
	v_dot2c_f32_bf16 v19, v41, v5
	v_dot2c_f32_bf16 v20, v42, v4
	v_dot2c_f32_bf16 v21, v42, v5
	v_dot2c_f32_bf16 v22, v43, v4
	v_dot2c_f32_bf16 v23, v43, v5
	v_and_b32 v3, 0xffff0000, v250
	v_fmamk_f32 v3, v3, 0x3fb8aa3b, v7
	v_exp_f32 v3, v3
	s_nop 0
	v_cvt_pk_bf16_f32 v4, v3, 0
	v_cvt_pk_bf16_f32 v5, 0, v3
	s_waitcnt vmcnt(5)
	buffer_load_dwordx4 v[36:39], v1, s[44:47], 0 offen nt
	v_xor_b32 v1, 0x5800, v1
	s_add_u32 s67, s67, 0x1000
	v_mov_b32 v3, s67
	ds_write_b32 v10, v3 offset:3072
	v_dot2c_f32_bf16 v16, v44, v4
	v_dot2c_f32_bf16 v17, v44, v5
	v_dot2c_f32_bf16 v18, v45, v4
	v_dot2c_f32_bf16 v19, v45, v5
	v_dot2c_f32_bf16 v20, v46, v4
	v_dot2c_f32_bf16 v21, v46, v5
	v_dot2c_f32_bf16 v22, v47, v4
	v_dot2c_f32_bf16 v23, v47, v5
	v_lshlrev_b32 v3, 16, v251
	v_fmamk_f32 v3, v3, 0x3fb8aa3b, v7
	v_exp_f32 v3, v3
	s_nop 0
	v_cvt_pk_bf16_f32 v4, v3, 0
	v_cvt_pk_bf16_f32 v5, 0, v3
	s_waitcnt vmcnt(5)
	buffer_load_dwordx4 v[40:43], v1, s[44:47], 0 offen nt
	v_xor_b32 v1, 0x800, v1
	v_dot2c_f32_bf16 v16, v48, v4
	v_dot2c_f32_bf16 v17, v48, v5
	v_dot2c_f32_bf16 v18, v49, v4
	v_dot2c_f32_bf16 v19, v49, v5
	v_dot2c_f32_bf16 v20, v50, v4
	v_dot2c_f32_bf16 v21, v50, v5
	v_dot2c_f32_bf16 v22, v51, v4
	v_dot2c_f32_bf16 v23, v51, v5
	v_and_b32 v3, 0xffff0000, v251
	v_fmamk_f32 v3, v3, 0x3fb8aa3b, v7
	v_exp_f32 v3, v3
	s_nop 0
	v_cvt_pk_bf16_f32 v4, v3, 0
	v_cvt_pk_bf16_f32 v5, 0, v3
	s_waitcnt vmcnt(5)
	buffer_load_dwordx4 v[44:47], v1, s[44:47], 0 offen nt
	v_xor_b32 v1, 0x1800, v1
	s_add_u32 s67, s67, 0x1000
	v_mov_b32 v3, s67
	ds_write_b32 v10, v3 offset:3072
	ds_read_b32 v9, v10 offset:3088
	v_dot2c_f32_bf16 v16, v52, v4
	v_dot2c_f32_bf16 v17, v52, v5
	v_dot2c_f32_bf16 v18, v53, v4
	v_dot2c_f32_bf16 v19, v53, v5
	v_dot2c_f32_bf16 v20, v54, v4
	v_dot2c_f32_bf16 v21, v54, v5
	v_dot2c_f32_bf16 v22, v55, v4
	v_dot2c_f32_bf16 v23, v55, v5
	s_waitcnt lgkmcnt(0)
	v_readfirstlane_b32 s61, v9
	s_cmp_eq_u32 s60, 61
	s_cbranch_scc1 L_c_18
L_c_18_b:
	s_add_u32 s60, s60, 1
	s_cmp_eq_u32 s60, 118
	s_cbranch_scc1 L_sdone
	s_cmp_eq_u32 s61, 3
	s_cbranch_scc1 L_v3
	s_cmp_eq_u32 s61, 2
	s_cbranch_scc1 L_v2
	s_cmp_eq_u32 s61, 1
	s_cbranch_scc1 L_v1
	s_cmp_eq_u32 s61, 0
	s_cbranch_scc1 L_v0
	s_cmp_eq_u32 s61, 4
	s_cbranch_scc1 L_v4
	s_branch L_vT
.p2align 4
L_v4:
	ds_read_b128 v[248:251], v2
	v_add_u32 v2, 64, v2
	s_waitcnt vmcnt(5)
	buffer_load_dwordx4 v[48:51], v1, s[44:47], 0 offen nt
	v_xor_b32 v1, 0x800, v1
	buffer_load_dwordx4 v[52:55], v1, s[44:47], 0 offen nt
	v_xor_b32 v1, 0x5800, v1
	v_add_u32 v1, 0x8000, v1
	s_waitcnt lgkmcnt(0)
	v_lshlrev_b32 v3, 16, v248
	v_fmamk_f32 v3, v3, 0x3fb8aa3b, v7
	v_exp_f32 v3, v3
	s_nop 0
	v_cvt_pk_bf16_f32 v4, v3, 0
	v_cvt_pk_bf16_f32 v5, 0, v3
	v_dot2c_f32_bf16 v16, v24, v4
	v_dot2c_f32_bf16 v17, v24, v5
	v_dot2c_f32_bf16 v18, v25, v4
	v_dot2c_f32_bf16 v19, v25, v5
	v_dot2c_f32_bf16 v20, v26, v4
	v_dot2c_f32_bf16 v21, v26, v5
	v_dot2c_f32_bf16 v22, v27, v4
	v_dot2c_f32_bf16 v23, v27, v5
	v_and_b32 v3, 0xffff0000, v248
	v_fmamk_f32 v3, v3, 0x3fb8aa3b, v7
	v_exp_f32 v3, v3
	s_nop 0
	v_cvt_pk_bf16_f32 v4, v3, 0
	v_cvt_pk_bf16_f32 v5, 0, v3
	s_waitcnt vmcnt(6)
	buffer_load_dwordx4 v[24:27], v1, s[44:47], 0 offen nt
	v_xor_b32 v1, 0x800, v1
	s_add_u32 s67, s67, 0x1000
	v_mov_b32 v3, s67
	ds_write_b32 v10, v3 offset:3072
	v_dot2c_f32_bf16 v16, v28, v4
	v_dot2c_f32_bf16 v17, v28, v5
	v_dot2c_f32_bf16 v18, v29, v4
	v_dot2c_f32_bf16 v19, v29, v5
	v_dot2c_f32_bf16 v20, v30, v4
	v_dot2c_f32_bf16 v21, v30, v5
	v_dot2c_f32_bf16 v22, v31, v4
	v_dot2c_f32_bf16 v23, v31, v5
	v_lshlrev_b32 v3, 16, v249
	v_fmamk_f32 v3, v3, 0x3fb8aa3b, v7
	v_exp_f32 v3, v3
	s_nop 0
	v_cvt_pk_bf16_f32 v4, v3, 0
	v_cvt_pk_bf16_f32 v5, 0, v3
	s_waitcnt vmcnt(6)
	buffer_load_dwordx4 v[28:31], v1, s[44:47], 0 offen nt
	v_xor_b32 v1, 0x1800, v1
	v_dot2c_f32_bf16 v16, v32, v4
	v_dot2c_f32_bf16 v17, v32, v5
	v_dot2c_f32_bf16 v18, v33, v4
	v_dot2c_f32_bf16 v19, v33, v5
	v_dot2c_f32_bf16 v20, v34, v4
	v_dot2c_f32_bf16 v21, v34, v5
	v_dot2c_f32_bf16 v22, v35, v4
	v_dot2c_f32_bf16 v23, v35, v5
	v_and_b32 v3, 0xffff0000, v249
	v_fmamk_f32 v3, v3, 0x3fb8aa3b, v7
	v_exp_f32 v3, v3
	s_nop 0
	v_cvt_pk_bf16_f32 v4, v3, 0
	v_cvt_pk_bf16_f32 v5, 0, v3
	s_waitcnt vmcnt(6)
	buffer_load_dwordx4 v[32:35], v1, s[44:47], 0 offen nt
	v_xor_b32 v1, 0x800, v1
	s_add_u32 s67, s67, 0x1000
	v_mov_b32 v3, s67
	ds_write_b32 v10, v3 offset:3072
	v_dot2c_f32_bf16 v16, v36, v4
	v_dot2c_f32_bf16 v17, v36, v5
	v_dot2c_f32_bf16 v18, v37, v4
	v_dot2c_f32_bf16 v19, v37, v5
	v_dot2c_f32_bf16 v20, v38, v4
	v_dot2c_f32_bf16 v21, v38, v5
	v_dot2c_f32_bf16 v22, v39, v4
	v_dot2c_f32_bf16 v23, v39, v5
	v_lshlrev_b32 v3, 16, v250
	v_fmamk_f32 v3, v3, 0x3fb8aa3b, v7
	v_exp_f32 v3, v3
	s_nop 0
	v_cvt_pk_bf16_f32 v4, v3, 0
	v_cvt_pk_bf16_f32 v5, 0, v3
	s_waitcnt vmcnt(6)
	buffer_load_dwordx4 v[36:39], v1, s[44:47], 0 offen nt
	v_xor_b32 v1, 0x5800, v1
	v_dot2c_f32_bf16 v16, v40, v4
	v_dot2c_f32_bf16 v17, v40, v5
	v_dot2c_f32_bf16 v18, v41, v4
	v_dot2c_f32_bf16 v19, v41, v5
	v_dot2c_f32_bf16 v20, v42, v4
	v_dot2c_f32_bf16 v21, v42, v5
	v_dot2c_f32_bf16 v22, v43, v4
	v_dot2c_f32_bf16 v23, v43, v5
	v_and_b32 v3, 0xffff0000, v250
	v_fmamk_f32 v3, v3, 0x3fb8aa3b, v7
	v_exp_f32 v3, v3
	s_nop 0
	v_cvt_pk_bf16_f32 v4, v3, 0
	v_cvt_pk_bf16_f32 v5, 0, v3
	s_waitcnt vmcnt(6)
	buffer_load_dwordx4 v[40:43], v1, s[44:47], 0 offen nt
	v_xor_b32 v1, 0x800, v1
	s_add_u32 s67, s67, 0x1000
	v_mov_b32 v3, s67
	ds_write_b32 v10, v3 offset:3072
	v_dot2c_f32_bf16 v16, v44, v4
	v_dot2c_f32_bf16 v17, v44, v5
	v_dot2c_f32_bf16 v18, v45, v4
	v_dot2c_f32_bf16 v19, v45, v5
	v_dot2c_f32_bf16 v20, v46, v4
	v_dot2c_f32_bf16 v21, v46, v5
	v_dot2c_f32_bf16 v22, v47, v4
	v_dot2c_f32_bf16 v23, v47, v5
	v_lshlrev_b32 v3, 16, v251
	v_fmamk_f32 v3, v3, 0x3fb8aa3b, v7
	v_exp_f32 v3, v3
	s_nop 0
	v_cvt_pk_bf16_f32 v4, v3, 0
	v_cvt_pk_bf16_f32 v5, 0, v3
	s_waitcnt vmcnt(6)
	buffer_load_dwordx4 v[44:47], v1, s[44:47], 0 offen nt
	v_xor_b32 v1, 0x1800, v1
	v_dot2c_f32_bf16 v16, v48, v4
	v_dot2c_f32_bf16 v17, v48, v5
	v_dot2c_f32_bf16 v18, v49, v4
	v_dot2c_f32_bf16 v19, v49, v5
	v_dot2c_f32_bf16 v20, v50, v4
	v_dot2c_f32_bf16 v21, v50, v5
	v_dot2c_f32_bf16 v22, v51, v4
	v_dot2c_f32_bf16 v23, v51, v5
	v_and_b32 v3, 0xffff0000, v251
	v_fmamk_f32 v3, v3, 0x3fb8aa3b, v7
	v_exp_f32 v3, v3
	s_nop 0
	v_cvt_pk_bf16_f32 v4, v3, 0
	v_cvt_pk_bf16_f32 v5, 0, v3
	s_waitcnt vmcnt(6)
	s_add_u32 s67, s67, 0x1000
	v_mov_b32 v3, s67
	ds_write_b32 v10, v3 offset:3072
	ds_read_b32 v9, v10 offset:3088
	v_dot2c_f32_bf16 v16, v52, v4
	v_dot2c_f32_bf16 v17, v52, v5
	v_dot2c_f32_bf16 v18, v53, v4
	v_dot2c_f32_bf16 v19, v53, v5
	v_dot2c_f32_bf16 v20, v54, v4
	v_dot2c_f32_bf16 v21, v54, v5
	v_dot2c_f32_bf16 v22, v55, v4
	v_dot2c_f32_bf16 v23, v55, v5
	s_waitcnt lgkmcnt(0)
	v_readfirstlane_b32 s61, v9
	s_cmp_eq_u32 s60, 61
	s_cbranch_scc1 L_c_19
L_c_19_b:
	s_add_u32 s60, s60, 1
	s_cmp_eq_u32 s60, 118
	s_cbranch_scc1 L_sdone
	s_cmp_eq_u32 s61, 4
	s_cbranch_scc1 L_v4
	s_cmp_eq_u32 s61, 2
	s_cbranch_scc1 L_v2
	s_cmp_eq_u32 s61, 1
	s_cbranch_scc1 L_v1
	s_cmp_eq_u32 s61, 3
	s_cbranch_scc1 L_v3
	s_cmp_eq_u32 s61, 0
	s_cbranch_scc1 L_v0
	s_branch L_vT
L_vT:
	s_bitcmp1_b32 s60, 0
	s_cbranch_scc1 L_v4
.p2align 4
L_vE:
	ds_read_b128 v[248:251], v2
	v_add_u32 v2, 64, v2
	s_waitcnt vmcnt(5)
	buffer_load_dwordx4 v[48:51], v1, s[44:47], 0 offen nt
	v_xor_b32 v1, 0x800, v1
	buffer_load_dwordx4 v[52:55], v1, s[44:47], 0 offen nt
	v_xor_b32 v1, 0x5800, v1
	v_add_u32 v1, 0x8000, v1
	s_waitcnt lgkmcnt(0)
	v_lshlrev_b32 v3, 16, v248
	v_fmamk_f32 v3, v3, 0x3fb8aa3b, v7
	v_exp_f32 v3, v3
	s_nop 0
	v_cvt_pk_bf16_f32 v4, v3, 0
	v_cvt_pk_bf16_f32 v5, 0, v3
	v_dot2c_f32_bf16 v16, v24, v4
	v_dot2c_f32_bf16 v17, v24, v5
	v_dot2c_f32_bf16 v18, v25, v4
	v_dot2c_f32_bf16 v19, v25, v5
	v_dot2c_f32_bf16 v20, v26, v4
	v_dot2c_f32_bf16 v21, v26, v5
	v_dot2c_f32_bf16 v22, v27, v4
	v_dot2c_f32_bf16 v23, v27, v5
	v_and_b32 v3, 0xffff0000, v248
	v_fmamk_f32 v3, v3, 0x3fb8aa3b, v7
	v_exp_f32 v3, v3
	s_nop 0
	v_cvt_pk_bf16_f32 v4, v3, 0
	v_cvt_pk_bf16_f32 v5, 0, v3
	s_waitcnt vmcnt(6)
	buffer_load_dwordx4 v[56:59], v1, s[44:47], 0 offen nt
	v_xor_b32 v1, 0x800, v1
	buffer_load_dwordx4 v[60:63], v1, s[44:47], 0 offen nt
	v_xor_b32 v1, 0x1800, v1
	s_add_u32 s67, s67, 0x1000
	v_mov_b32 v3, s67
	ds_write_b32 v10, v3 offset:3072
	v_dot2c_f32_bf16 v16, v28, v4
	v_dot2c_f32_bf16 v17, v28, v5
	v_dot2c_f32_bf16 v18, v29, v4
	v_dot2c_f32_bf16 v19, v29, v5
	v_dot2c_f32_bf16 v20, v30, v4
	v_dot2c_f32_bf16 v21, v30, v5
	v_dot2c_f32_bf16 v22, v31, v4
	v_dot2c_f32_bf16 v23, v31, v5
	v_lshlrev_b32 v3, 16, v249
	v_fmamk_f32 v3, v3, 0x3fb8aa3b, v7
	v_exp_f32 v3, v3
	s_nop 0
	v_cvt_pk_bf16_f32 v4, v3, 0
	v_cvt_pk_bf16_f32 v5, 0, v3
	s_waitcnt vmcnt(7)
	buffer_load_dwordx4 v[64:67], v1, s[44:47], 0 offen nt
	v_xor_b32 v1, 0x800, v1
	buffer_load_dwordx4 v[68:71], v1, s[44:47], 0 offen nt
	v_xor_b32 v1, 0x5800, v1
	v_dot2c_f32_bf16 v16, v32, v4
	v_dot2c_f32_bf16 v17, v32, v5
	v_dot2c_f32_bf16 v18, v33, v4
	v_dot2c_f32_bf16 v19, v33, v5
	v_dot2c_f32_bf16 v20, v34, v4
	v_dot2c_f32_bf16 v21, v34, v5
	v_dot2c_f32_bf16 v22, v35, v4
	v_dot2c_f32_bf16 v23, v35, v5
	v_and_b32 v3, 0xffff0000, v249
	v_fmamk_f32 v3, v3, 0x3fb8aa3b, v7
	v_exp_f32 v3, v3
	s_nop 0
	v_cvt_pk_bf16_f32 v4, v3, 0
	v_cvt_pk_bf16_f32 v5, 0, v3
	s_waitcnt vmcnt(8)
	buffer_load_dwordx4 v[72:75], v1, s[44:47], 0 offen nt
	v_xor_b32 v1, 0x800, v1
	s_add_u32 s67, s67, 0x1000
	v_mov_b32 v3, s67
	ds_write_b32 v10, v3 offset:3072
	v_dot2c_f32_bf16 v16, v36, v4
	v_dot2c_f32_bf16 v17, v36, v5
	v_dot2c_f32_bf16 v18, v37, v4
	v_dot2c_f32_bf16 v19, v37, v5
	v_dot2c_f32_bf16 v20, v38, v4
	v_dot2c_f32_bf16 v21, v38, v5
	v_dot2c_f32_bf16 v22, v39, v4
	v_dot2c_f32_bf16 v23, v39, v5
	v_lshlrev_b32 v3, 16, v250
	v_fmamk_f32 v3, v3, 0x3fb8aa3b, v7
	v_exp_f32 v3, v3
	s_nop 0
	v_cvt_pk_bf16_f32 v4, v3, 0
	v_cvt_pk_bf16_f32 v5, 0, v3
	s_waitcnt vmcnt(8)
	buffer_load_dwordx4 v[76:79], v1, s[44:47], 0 offen nt
	v_xor_b32 v1, 0x1800, v1
	v_dot2c_f32_bf16 v16, v40, v4
	v_dot2c_f32_bf16 v17, v40, v5
	v_dot2c_f32_bf16 v18, v41, v4
	v_dot2c_f32_bf16 v19, v41, v5
	v_dot2c_f32_bf16 v20, v42, v4
	v_dot2c_f32_bf16 v21, v42, v5
	v_dot2c_f32_bf16 v22, v43, v4
	v_dot2c_f32_bf16 v23, v43, v5
	v_and_b32 v3, 0xffff0000, v250
	v_fmamk_f32 v3, v3, 0x3fb8aa3b, v7
	v_exp_f32 v3, v3
	s_nop 0
	v_cvt_pk_bf16_f32 v4, v3, 0
	v_cvt_pk_bf16_f32 v5, 0, v3
	s_waitcnt vmcnt(8)
	buffer_load_dwordx4 v[80:83], v1, s[44:47], 0 offen nt
	v_xor_b32 v1, 0x800, v1
	s_add_u32 s67, s67, 0x1000
	v_mov_b32 v3, s67
	ds_write_b32 v10, v3 offset:3072
	v_dot2c_f32_bf16 v16, v44, v4
	v_dot2c_f32_bf16 v17, v44, v5
	v_dot2c_f32_bf16 v18, v45, v4
	v_dot2c_f32_bf16 v19, v45, v5
	v_dot2c_f32_bf16 v20, v46, v4
	v_dot2c_f32_bf16 v21, v46, v5
	v_dot2c_f32_bf16 v22, v47, v4
	v_dot2c_f32_bf16 v23, v47, v5
	v_lshlrev_b32 v3, 16, v251
	v_fmamk_f32 v3, v3, 0x3fb8aa3b, v7
	v_exp_f32 v3, v3
	s_nop 0
	v_cvt_pk_bf16_f32 v4, v3, 0
	v_cvt_pk_bf16_f32 v5, 0, v3
	s_waitcnt vmcnt(8)
	buffer_load_dwordx4 v[84:87], v1, s[44:47], 0 offen nt
	v_xor_b32 v1, 0x5800, v1
	v_add_u32 v1, 0x8000, v1
	v_dot2c_f32_bf16 v16, v48, v4
	v_dot2c_f32_bf16 v17, v48, v5
	v_dot2c_f32_bf16 v18, v49, v4
	v_dot2c_f32_bf16 v19, v49, v5
	v_dot2c_f32_bf16 v20, v50, v4
	v_dot2c_f32_bf16 v21, v50, v5
	v_dot2c_f32_bf16 v22, v51, v4
	v_dot2c_f32_bf16 v23, v51, v5
	v_and_b32 v3, 0xffff0000, v251
	v_fmamk_f32 v3, v3, 0x3fb8aa3b, v7
	v_exp_f32 v3, v3
	s_nop 0
	v_cvt_pk_bf16_f32 v4, v3, 0
	v_cvt_pk_bf16_f32 v5, 0, v3
	s_waitcnt vmcnt(8)
	buffer_load_dwordx4 v[24:27], v1, s[44:47], 0 offen nt
	v_xor_b32 v1, 0x800, v1
	s_add_u32 s67, s67, 0x1000
	v_mov_b32 v3, s67
	ds_write_b32 v10, v3 offset:3072
	ds_read_b32 v9, v10 offset:3088
	v_dot2c_f32_bf16 v16, v52, v4
	v_dot2c_f32_bf16 v17, v52, v5
	v_dot2c_f32_bf16 v18, v53, v4
	v_dot2c_f32_bf16 v19, v53, v5
	v_dot2c_f32_bf16 v20, v54, v4
	v_dot2c_f32_bf16 v21, v54, v5
	v_dot2c_f32_bf16 v22, v55, v4
	v_dot2c_f32_bf16 v23, v55, v5
	s_waitcnt lgkmcnt(0)
	v_readfirstlane_b32 s61, v9
	s_cmp_eq_u32 s60, 61
	s_cbranch_scc1 L_c_20
L_c_20_b:
	s_add_u32 s60, s60, 1
	s_cmp_eq_u32 s60, 118
	s_cbranch_scc1 L_sdone
	s_cmp_eq_u32 s61, 5
	s_cbranch_scc1 L_vB
	s_branch L_vX
.p2align 4
L_vA:
	ds_read_b128 v[248:251], v2
	v_add_u32 v2, 64, v2
	s_waitcnt vmcnt(8)
	buffer_load_dwordx4 v[60:63], v1, s[44:47], 0 offen nt
	v_xor_b32 v1, 0x1800, v1
	s_waitcnt lgkmcnt(0)
	v_lshlrev_b32 v3, 16, v248
	v_fmamk_f32 v3, v3, 0x3fb8aa3b, v7
	v_exp_f32 v3, v3
	s_nop 0
	v_cvt_pk_bf16_f32 v4, v3, 0
	v_cvt_pk_bf16_f32 v5, 0, v3
	v_dot2c_f32_bf16 v16, v24, v4
	v_dot2c_f32_bf16 v17, v24, v5
	v_dot2c_f32_bf16 v18, v25, v4
	v_dot2c_f32_bf16 v19, v25, v5
	v_dot2c_f32_bf16 v20, v26, v4
	v_dot2c_f32_bf16 v21, v26, v5
	v_dot2c_f32_bf16 v22, v27, v4
	v_dot2c_f32_bf16 v23, v27, v5
	v_and_b32 v3, 0xffff0000, v248
	v_fmamk_f32 v3, v3, 0x3fb8aa3b, v7
	v_exp_f32 v3, v3
	s_nop 0
	v_cvt_pk_bf16_f32 v4, v3, 0
	v_cvt_pk_bf16_f32 v5, 0, v3
	s_waitcnt vmcnt(8)
	buffer_load_dwordx4 v[64:67], v1, s[44:47], 0 offen nt
	v_xor_b32 v1, 0x800, v1
	s_add_u32 s67, s67, 0x1000
	v_mov_b32 v3, s67
	ds_write_b32 v10, v3 offset:3072
	v_dot2c_f32_bf16 v16, v28, v4
	v_dot2c_f32_bf16 v17, v28, v5
	v_dot2c_f32_bf16 v18, v29, v4
	v_dot2c_f32_bf16 v19, v29, v5
	v_dot2c_f32_bf16 v20, v30, v4
	v_dot2c_f32_bf16 v21, v30, v5
	v_dot2c_f32_bf16 v22, v31, v4
	v_dot2c_f32_bf16 v23, v31, v5
	v_lshlrev_b32 v3, 16, v249
	v_fmamk_f32 v3, v3, 0x3fb8aa3b, v7
	v_exp_f32 v3, v3
	s_nop 0
	v_cvt_pk_bf16_f32 v4, v3, 0
	v_cvt_pk_bf16_f32 v5, 0, v3
	s_waitcnt vmcnt(8)
	buffer_load_dwordx4 v[68:71], v1, s[44:47], 0 offen nt
	v_xor_b32 v1, 0x5800, v1
	v_dot2c_f32_bf16 v16, v32, v4
	v_dot2c_f32_bf16 v17, v32, v5
	v_dot2c_f32_bf16 v18, v33, v4
	v_dot2c_f32_bf16 v19, v33, v5
	v_dot2c_f32_bf16 v20, v34, v4
	v_dot2c_f32_bf16 v21, v34, v5
	v_dot2c_f32_bf16 v22, v35, v4
	v_dot2c_f32_bf16 v23, v35, v5
	v_and_b32 v3, 0xffff0000, v249
	v_fmamk_f32 v3, v3, 0x3fb8aa3b, v7
	v_exp_f32 v3, v3
	s_nop 0
	v_cvt_pk_bf16_f32 v4, v3, 0
	v_cvt_pk_bf16_f32 v5, 0, v3
	s_waitcnt vmcnt(8)
	buffer_load_dwordx4 v[72:75], v1, s[44:47], 0 offen nt
	v_xor_b32 v1, 0x800, v1
	s_add_u32 s67, s67, 0x1000
	v_mov_b32 v3, s67
	ds_write_b32 v10, v3 offset:3072
	v_dot2c_f32_bf16 v16, v36, v4
	v_dot2c_f32_bf16 v17, v36, v5
	v_dot2c_f32_bf16 v18, v37, v4
	v_dot2c_f32_bf16 v19, v37, v5
	v_dot2c_f32_bf16 v20, v38, v4
	v_dot2c_f32_bf16 v21, v38, v5
	v_dot2c_f32_bf16 v22, v39, v4
	v_dot2c_f32_bf16 v23, v39, v5
	v_lshlrev_b32 v3, 16, v250
	v_fmamk_f32 v3, v3, 0x3fb8aa3b, v7
	v_exp_f32 v3, v3
	s_nop 0
	v_cvt_pk_bf16_f32 v4, v3, 0
	v_cvt_pk_bf16_f32 v5, 0, v3
	s_waitcnt vmcnt(8)
	buffer_load_dwordx4 v[76:79], v1, s[44:47], 0 offen nt
	v_xor_b32 v1, 0x1800, v1
	v_dot2c_f32_bf16 v16, v40, v4
	v_dot2c_f32_bf16 v17, v40, v5
	v_dot2c_f32_bf16 v18, v41, v4
	v_dot2c_f32_bf16 v19, v41, v5
	v_dot2c_f32_bf16 v20, v42, v4
	v_dot2c_f32_bf16 v21, v42, v5
	v_dot2c_f32_bf16 v22, v43, v4
	v_dot2c_f32_bf16 v23, v43, v5
	v_and_b32 v3, 0xffff0000, v250
	v_fmamk_f32 v3, v3, 0x3fb8aa3b, v7
	v_exp_f32 v3, v3
	s_nop 0
	v_cvt_pk_bf16_f32 v4, v3, 0
	v_cvt_pk_bf16_f32 v5, 0, v3
	s_waitcnt vmcnt(8)
	buffer_load_dwordx4 v[80:83], v1, s[44:47], 0 offen nt
	v_xor_b32 v1, 0x800, v1
	s_add_u32 s67, s67, 0x1000
	v_mov_b32 v3, s67
	ds_write_b32 v10, v3 offset:3072
	v_dot2c_f32_bf16 v16, v44, v4
	v_dot2c_f32_bf16 v17, v44, v5
	v_dot2c_f32_bf16 v18, v45, v4
	v_dot2c_f32_bf16 v19, v45, v5
	v_dot2c_f32_bf16 v20, v46, v4
	v_dot2c_f32_bf16 v21, v46, v5
	v_dot2c_f32_bf16 v22, v47, v4
	v_dot2c_f32_bf16 v23, v47, v5
	v_lshlrev_b32 v3, 16, v251
	v_fmamk_f32 v3, v3, 0x3fb8aa3b, v7
	v_exp_f32 v3, v3
	s_nop 0
	v_cvt_pk_bf16_f32 v4, v3, 0
	v_cvt_pk_bf16_f32 v5, 0, v3
	s_waitcnt vmcnt(8)
	buffer_load_dwordx4 v[84:87], v1, s[44:47], 0 offen nt
	v_xor_b32 v1, 0x5800, v1
	v_add_u32 v1, 0x8000, v1
	v_dot2c_f32_bf16 v16, v48, v4
	v_dot2c_f32_bf16 v17, v48, v5
	v_dot2c_f32_bf16 v18, v49, v4
	v_dot2c_f32_bf16 v19, v49, v5
	v_dot2c_f32_bf16 v20, v50, v4
	v_dot2c_f32_bf16 v21, v50, v5
	v_dot2c_f32_bf16 v22, v51, v4
	v_dot2c_f32_bf16 v23, v51, v5
	v_and_b32 v3, 0xffff0000, v251
	v_fmamk_f32 v3, v3, 0x3fb8aa3b, v7
	v_exp_f32 v3, v3
	s_nop 0
	v_cvt_pk_bf16_f32 v4, v3, 0
	v_cvt_pk_bf16_f32 v5, 0, v3
	s_waitcnt vmcnt(8)
	buffer_load_dwordx4 v[24:27], v1, s[44:47], 0 offen nt
	v_xor_b32 v1, 0x800, v1
	s_add_u32 s67, s67, 0x1000
	v_mov_b32 v3, s67
	ds_write_b32 v10, v3 offset:3072
	ds_read_b32 v9, v10 offset:3088
	v_dot2c_f32_bf16 v16, v52, v4
	v_dot2c_f32_bf16 v17, v52, v5
	v_dot2c_f32_bf16 v18, v53, v4
	v_dot2c_f32_bf16 v19, v53, v5
	v_dot2c_f32_bf16 v20, v54, v4
	v_dot2c_f32_bf16 v21, v54, v5
	v_dot2c_f32_bf16 v22, v55, v4
	v_dot2c_f32_bf16 v23, v55, v5
	s_waitcnt lgkmcnt(0)
	v_readfirstlane_b32 s61, v9
	s_cmp_eq_u32 s60, 61
	s_cbranch_scc1 L_c_21
L_c_21_b:
	s_add_u32 s60, s60, 1
	s_cmp_eq_u32 s60, 118
	s_cbranch_scc1 L_sdone
	s_cmp_eq_u32 s61, 5
	s_cbranch_scc1 L_vB
	s_branch L_vX
.p2align 4
L_vB:
	ds_read_b128 v[248:251], v2
	v_add_u32 v2, 64, v2
	s_waitcnt vmcnt(8)
	buffer_load_dwordx4 v[28:31], v1, s[44:47], 0 offen nt
	v_xor_b32 v1, 0x1800, v1
	s_waitcnt lgkmcnt(0)
	v_lshlrev_b32 v3, 16, v248
	v_fmamk_f32 v3, v3, 0x3fb8aa3b, v7
	v_exp_f32 v3, v3
	s_nop 0
	v_cvt_pk_bf16_f32 v4, v3, 0
	v_cvt_pk_bf16_f32 v5, 0, v3
	v_dot2c_f32_bf16 v16, v56, v4
	v_dot2c_f32_bf16 v17, v56, v5
	v_dot2c_f32_bf16 v18, v57, v4
	v_dot2c_f32_bf16 v19, v57, v5
	v_dot2c_f32_bf16 v20, v58, v4
	v_dot2c_f32_bf16 v21, v58, v5
	v_dot2c_f32_bf16 v22, v59, v4
	v_dot2c_f32_bf16 v23, v59, v5
	v_and_b32 v3, 0xffff0000, v248
	v_fmamk_f32 v3, v3, 0x3fb8aa3b, v7
	v_exp_f32 v3, v3
	s_nop 0
	v_cvt_pk_bf16_f32 v4, v3, 0
	v_cvt_pk_bf16_f32 v5, 0, v3
	s_waitcnt vmcnt(8)
	buffer_load_dwordx4 v[32:35], v1, s[44:47], 0 offen nt
	v_xor_b32 v1, 0x800, v1
	s_add_u32 s67, s67, 0x1000
	v_mov_b32 v3, s67
	ds_write_b32 v10, v3 offset:3072
	v_dot2c_f32_bf16 v16, v60, v4
	v_dot2c_f32_bf16 v17, v60, v5
	v_dot2c_f32_bf16 v18, v61, v4
	v_dot2c_f32_bf16 v19, v61, v5
	v_dot2c_f32_bf16 v20, v62, v4
	v_dot2c_f32_bf16 v21, v62, v5
	v_dot2c_f32_bf16 v22, v63, v4
	v_dot2c_f32_bf16 v23, v63, v5
	v_lshlrev_b32 v3, 16, v249
	v_fmamk_f32 v3, v3, 0x3fb8aa3b, v7
	v_exp_f32 v3, v3
	s_nop 0
	v_cvt_pk_bf16_f32 v4, v3, 0
	v_cvt_pk_bf16_f32 v5, 0, v3
	s_waitcnt vmcnt(8)
	buffer_load_dwordx4 v[36:39], v1, s[44:47], 0 offen nt
	v_xor_b32 v1, 0x5800, v1
	v_dot2c_f32_bf16 v16, v64, v4
	v_dot2c_f32_bf16 v17, v64, v5
	v_dot2c_f32_bf16 v18, v65, v4
	v_dot2c_f32_bf16 v19, v65, v5
	v_dot2c_f32_bf16 v20, v66, v4
	v_dot2c_f32_bf16 v21, v66, v5
	v_dot2c_f32_bf16 v22, v67, v4
	v_dot2c_f32_bf16 v23, v67, v5
	v_and_b32 v3, 0xffff0000, v249
	v_fmamk_f32 v3, v3, 0x3fb8aa3b, v7
	v_exp_f32 v3, v3
	s_nop 0
	v_cvt_pk_bf16_f32 v4, v3, 0
	v_cvt_pk_bf16_f32 v5, 0, v3
	s_waitcnt vmcnt(8)
	buffer_load_dwordx4 v[40:43], v1, s[44:47], 0 offen nt
	v_xor_b32 v1, 0x800, v1
	s_add_u32 s67, s67, 0x1000
	v_mov_b32 v3, s67
	ds_write_b32 v10, v3 offset:3072
	v_dot2c_f32_bf16 v16, v68, v4
	v_dot2c_f32_bf16 v17, v68, v5
	v_dot2c_f32_bf16 v18, v69, v4
	v_dot2c_f32_bf16 v19, v69, v5
	v_dot2c_f32_bf16 v20, v70, v4
	v_dot2c_f32_bf16 v21, v70, v5
	v_dot2c_f32_bf16 v22, v71, v4
	v_dot2c_f32_bf16 v23, v71, v5
	v_lshlrev_b32 v3, 16, v250
	v_fmamk_f32 v3, v3, 0x3fb8aa3b, v7
	v_exp_f32 v3, v3
	s_nop 0
	v_cvt_pk_bf16_f32 v4, v3, 0
	v_cvt_pk_bf16_f32 v5, 0, v3
	s_waitcnt vmcnt(8)
	buffer_load_dwordx4 v[44:47], v1, s[44:47], 0 offen nt
	v_xor_b32 v1, 0x1800, v1
	v_dot2c_f32_bf16 v16, v72, v4
	v_dot2c_f32_bf16 v17, v72, v5
	v_dot2c_f32_bf16 v18, v73, v4
	v_dot2c_f32_bf16 v19, v73, v5
	v_dot2c_f32_bf16 v20, v74, v4
	v_dot2c_f32_bf16 v21, v74, v5
	v_dot2c_f32_bf16 v22, v75, v4
	v_dot2c_f32_bf16 v23, v75, v5
	v_and_b32 v3, 0xffff0000, v250
	v_fmamk_f32 v3, v3, 0x3fb8aa3b, v7
	v_exp_f32 v3, v3
	s_nop 0
	v_cvt_pk_bf16_f32 v4, v3, 0
	v_cvt_pk_bf16_f32 v5, 0, v3
	s_waitcnt vmcnt(8)
	buffer_load_dwordx4 v[48:51], v1, s[44:47], 0 offen nt
	v_xor_b32 v1, 0x800, v1
	s_add_u32 s67, s67, 0x1000
	v_mov_b32 v3, s67
	ds_write_b32 v10, v3 offset:3072
	v_dot2c_f32_bf16 v16, v76, v4
	v_dot2c_f32_bf16 v17, v76, v5
	v_dot2c_f32_bf16 v18, v77, v4
	v_dot2c_f32_bf16 v19, v77, v5
	v_dot2c_f32_bf16 v20, v78, v4
	v_dot2c_f32_bf16 v21, v78, v5
	v_dot2c_f32_bf16 v22, v79, v4
	v_dot2c_f32_bf16 v23, v79, v5
	v_lshlrev_b32 v3, 16, v251
	v_fmamk_f32 v3, v3, 0x3fb8aa3b, v7
	v_exp_f32 v3, v3
	s_nop 0
	v_cvt_pk_bf16_f32 v4, v3, 0
	v_cvt_pk_bf16_f32 v5, 0, v3
	s_waitcnt vmcnt(8)
	buffer_load_dwordx4 v[52:55], v1, s[44:47], 0 offen nt
	v_xor_b32 v1, 0x5800, v1
	v_add_u32 v1, 0x8000, v1
	v_dot2c_f32_bf16 v16, v80, v4
	v_dot2c_f32_bf16 v17, v80, v5
	v_dot2c_f32_bf16 v18, v81, v4
	v_dot2c_f32_bf16 v19, v81, v5
	v_dot2c_f32_bf16 v20, v82, v4
	v_dot2c_f32_bf16 v21, v82, v5
	v_dot2c_f32_bf16 v22, v83, v4
	v_dot2c_f32_bf16 v23, v83, v5
	v_and_b32 v3, 0xffff0000, v251
	v_fmamk_f32 v3, v3, 0x3fb8aa3b, v7
	v_exp_f32 v3, v3
	s_nop 0
	v_cvt_pk_bf16_f32 v4, v3, 0
	v_cvt_pk_bf16_f32 v5, 0, v3
	s_waitcnt vmcnt(8)
	buffer_load_dwordx4 v[56:59], v1, s[44:47], 0 offen nt
	v_xor_b32 v1, 0x800, v1
	s_add_u32 s67, s67, 0x1000
	v_mov_b32 v3, s67
	ds_write_b32 v10, v3 offset:3072
	ds_read_b32 v9, v10 offset:3088
	v_dot2c_f32_bf16 v16, v84, v4
	v_dot2c_f32_bf16 v17, v84, v5
	v_dot2c_f32_bf16 v18, v85, v4
	v_dot2c_f32_bf16 v19, v85, v5
	v_dot2c_f32_bf16 v20, v86, v4
	v_dot2c_f32_bf16 v21, v86, v5
	v_dot2c_f32_bf16 v22, v87, v4
	v_dot2c_f32_bf16 v23, v87, v5
	s_waitcnt lgkmcnt(0)
	v_readfirstlane_b32 s61, v9
	s_cmp_eq_u32 s60, 61
	s_cbranch_scc1 L_c_22
L_c_22_b:
	s_add_u32 s60, s60, 1
	s_cmp_eq_u32 s60, 118
	s_cbranch_scc1 L_sdone
	s_branch L_vA
.p2align 4
L_vX:
	ds_read_b128 v[248:251], v2
	v_add_u32 v2, 64, v2
	s_waitcnt vmcnt(8)
	buffer_load_dwordx4 v[28:31], v1, s[44:47], 0 offen nt
	v_xor_b32 v1, 0x1800, v1
	s_waitcnt lgkmcnt(0)
	v_lshlrev_b32 v3, 16, v248
	v_fmamk_f32 v3, v3, 0x3fb8aa3b, v7
	v_exp_f32 v3, v3
	s_nop 0
	v_cvt_pk_bf16_f32 v4, v3, 0
	v_cvt_pk_bf16_f32 v5, 0, v3
	v_dot2c_f32_bf16 v16, v56, v4
	v_dot2c_f32_bf16 v17, v56, v5
	v_dot2c_f32_bf16 v18, v57, v4
	v_dot2c_f32_bf16 v19, v57, v5
	v_dot2c_f32_bf16 v20, v58, v4
	v_dot2c_f32_bf16 v21, v58, v5
	v_dot2c_f32_bf16 v22, v59, v4
	v_dot2c_f32_bf16 v23, v59, v5
	v_and_b32 v3, 0xffff0000, v248
	v_fmamk_f32 v3, v3, 0x3fb8aa3b, v7
	v_exp_f32 v3, v3
	s_nop 0
	v_cvt_pk_bf16_f32 v4, v3, 0
	v_cvt_pk_bf16_f32 v5, 0, v3
	s_waitcnt vmcnt(8)
	buffer_load_dwordx4 v[32:35], v1, s[44:47], 0 offen nt
	v_xor_b32 v1, 0x800, v1
	s_add_u32 s67, s67, 0x1000
	v_mov_b32 v3, s67
	ds_write_b32 v10, v3 offset:3072
	v_dot2c_f32_bf16 v16, v60, v4
	v_dot2c_f32_bf16 v17, v60, v5
	v_dot2c_f32_bf16 v18, v61, v4
	v_dot2c_f32_bf16 v19, v61, v5
	v_dot2c_f32_bf16 v20, v62, v4
	v_dot2c_f32_bf16 v21, v62, v5
	v_dot2c_f32_bf16 v22, v63, v4
	v_dot2c_f32_bf16 v23, v63, v5
	v_lshlrev_b32 v3, 16, v249
	v_fmamk_f32 v3, v3, 0x3fb8aa3b, v7
	v_exp_f32 v3, v3
	s_nop 0
	v_cvt_pk_bf16_f32 v4, v3, 0
	v_cvt_pk_bf16_f32 v5, 0, v3
	s_waitcnt vmcnt(8)
	buffer_load_dwordx4 v[36:39], v1, s[44:47], 0 offen nt
	v_xor_b32 v1, 0x5800, v1
	v_dot2c_f32_bf16 v16, v64, v4
	v_dot2c_f32_bf16 v17, v64, v5
	v_dot2c_f32_bf16 v18, v65, v4
	v_dot2c_f32_bf16 v19, v65, v5
	v_dot2c_f32_bf16 v20, v66, v4
	v_dot2c_f32_bf16 v21, v66, v5
	v_dot2c_f32_bf16 v22, v67, v4
	v_dot2c_f32_bf16 v23, v67, v5
	v_and_b32 v3, 0xffff0000, v249
	v_fmamk_f32 v3, v3, 0x3fb8aa3b, v7
	v_exp_f32 v3, v3
	s_nop 0
	v_cvt_pk_bf16_f32 v4, v3, 0
	v_cvt_pk_bf16_f32 v5, 0, v3
	s_waitcnt vmcnt(8)
	buffer_load_dwordx4 v[40:43], v1, s[44:47], 0 offen nt
	v_xor_b32 v1, 0x800, v1
	s_add_u32 s67, s67, 0x1000
	v_mov_b32 v3, s67
	ds_write_b32 v10, v3 offset:3072
	v_dot2c_f32_bf16 v16, v68, v4
	v_dot2c_f32_bf16 v17, v68, v5
	v_dot2c_f32_bf16 v18, v69, v4
	v_dot2c_f32_bf16 v19, v69, v5
	v_dot2c_f32_bf16 v20, v70, v4
	v_dot2c_f32_bf16 v21, v70, v5
	v_dot2c_f32_bf16 v22, v71, v4
	v_dot2c_f32_bf16 v23, v71, v5
	v_lshlrev_b32 v3, 16, v250
	v_fmamk_f32 v3, v3, 0x3fb8aa3b, v7
	v_exp_f32 v3, v3
	s_nop 0
	v_cvt_pk_bf16_f32 v4, v3, 0
	v_cvt_pk_bf16_f32 v5, 0, v3
	s_waitcnt vmcnt(8)
	buffer_load_dwordx4 v[44:47], v1, s[44:47], 0 offen nt
	v_xor_b32 v1, 0x1800, v1
	v_dot2c_f32_bf16 v16, v72, v4
	v_dot2c_f32_bf16 v17, v72, v5
	v_dot2c_f32_bf16 v18, v73, v4
	v_dot2c_f32_bf16 v19, v73, v5
	v_dot2c_f32_bf16 v20, v74, v4
	v_dot2c_f32_bf16 v21, v74, v5
	v_dot2c_f32_bf16 v22, v75, v4
	v_dot2c_f32_bf16 v23, v75, v5
	v_and_b32 v3, 0xffff0000, v250
	v_fmamk_f32 v3, v3, 0x3fb8aa3b, v7
	v_exp_f32 v3, v3
	s_nop 0
	v_cvt_pk_bf16_f32 v4, v3, 0
	v_cvt_pk_bf16_f32 v5, 0, v3
	s_waitcnt vmcnt(8)
	s_add_u32 s67, s67, 0x1000
	v_mov_b32 v3, s67
	ds_write_b32 v10, v3 offset:3072
	v_dot2c_f32_bf16 v16, v76, v4
	v_dot2c_f32_bf16 v17, v76, v5
	v_dot2c_f32_bf16 v18, v77, v4
	v_dot2c_f32_bf16 v19, v77, v5
	v_dot2c_f32_bf16 v20, v78, v4
	v_dot2c_f32_bf16 v21, v78, v5
	v_dot2c_f32_bf16 v22, v79, v4
	v_dot2c_f32_bf16 v23, v79, v5
	v_lshlrev_b32 v3, 16, v251
	v_fmamk_f32 v3, v3, 0x3fb8aa3b, v7
	v_exp_f32 v3, v3
	s_nop 0
	v_cvt_pk_bf16_f32 v4, v3, 0
	v_cvt_pk_bf16_f32 v5, 0, v3
	s_waitcnt vmcnt(7)
	v_dot2c_f32_bf16 v16, v80, v4
	v_dot2c_f32_bf16 v17, v80, v5
	v_dot2c_f32_bf16 v18, v81, v4
	v_dot2c_f32_bf16 v19, v81, v5
	v_dot2c_f32_bf16 v20, v82, v4
	v_dot2c_f32_bf16 v21, v82, v5
	v_dot2c_f32_bf16 v22, v83, v4
	v_dot2c_f32_bf16 v23, v83, v5
	v_and_b32 v3, 0xffff0000, v251
	v_fmamk_f32 v3, v3, 0x3fb8aa3b, v7
	v_exp_f32 v3, v3
	s_nop 0
	v_cvt_pk_bf16_f32 v4, v3, 0
	v_cvt_pk_bf16_f32 v5, 0, v3
	s_waitcnt vmcnt(6)
	s_add_u32 s67, s67, 0x1000
	v_mov_b32 v3, s67
	ds_write_b32 v10, v3 offset:3072
	ds_read_b32 v9, v10 offset:3088
	v_dot2c_f32_bf16 v16, v84, v4
	v_dot2c_f32_bf16 v17, v84, v5
	v_dot2c_f32_bf16 v18, v85, v4
	v_dot2c_f32_bf16 v19, v85, v5
	v_dot2c_f32_bf16 v20, v86, v4
	v_dot2c_f32_bf16 v21, v86, v5
	v_dot2c_f32_bf16 v22, v87, v4
	v_dot2c_f32_bf16 v23, v87, v5
	s_waitcnt lgkmcnt(0)
	v_readfirstlane_b32 s61, v9
	s_cmp_eq_u32 s60, 61
	s_cbranch_scc1 L_c_23
L_c_23_b:
	s_add_u32 s60, s60, 1
	s_cmp_eq_u32 s60, 118
	s_cbranch_scc1 L_sdone
	s_cmp_eq_u32 s61, 4
	s_cbranch_scc1 L_v4
	s_cmp_eq_u32 s61, 2
	s_cbranch_scc1 L_v2
	s_cmp_eq_u32 s61, 1
	s_cbranch_scc1 L_v1
	s_cmp_eq_u32 s61, 3
	s_cbranch_scc1 L_v3
	s_cmp_eq_u32 s61, 0
	s_cbranch_scc1 L_v0
	s_branch L_vT
L_sdone:
	v_mbcnt_lo_u32_b32 v0, -1, 0
	v_mbcnt_hi_u32_b32 v0, -1, v0
	v_and_b32 v10, 15, v0
	v_lshlrev_b32 v10, 5, v10
	v_lshrrev_b32 v11, 4, v0
	v_permlane32_swap_b32 v16, v20
	v_permlane32_swap_b32 v17, v21
	v_permlane32_swap_b32 v18, v22
	v_permlane32_swap_b32 v19, v23
	v_add_f32 v16, v16, v20
	v_add_f32 v17, v17, v21
	v_add_f32 v18, v18, v22
	v_add_f32 v19, v19, v23
	v_lshl_add_u32 v10, v11, 3, v10
	s_lshl_b32 s61, s3, 9
	v_add_u32 v10, s61, v10
	v_permlane16_swap_b32 v16, v18
	v_permlane16_swap_b32 v17, v19
	v_add_f32 v16, v16, v18
	v_add_f32 v17, v17, v19
	ds_write_b64 v10, v[16:17] offset:256
	s_waitcnt lgkmcnt(0)
	s_barrier
L_exit:
	s_endpgm
L_c_1:
	s_call_b64 s[42:43], L_swap
	s_branch L_c_1_b
L_c_2:
	s_call_b64 s[42:43], L_extra
	s_branch L_c_2_b
L_c_3:
	s_call_b64 s[42:43], L_swap
	s_branch L_c_3_b
L_c_4:
	s_call_b64 s[42:43], L_extra
	s_branch L_c_4_b
L_c_5:
	s_call_b64 s[42:43], L_swap
	s_branch L_c_5_b
L_c_6:
	s_call_b64 s[42:43], L_extra
	s_branch L_c_6_b
L_c_7:
	s_call_b64 s[42:43], L_swap
	s_branch L_c_7_b
L_c_8:
	s_call_b64 s[42:43], L_extra
	s_branch L_c_8_b
L_c_9:
	s_call_b64 s[42:43], L_swap
	s_branch L_c_9_b
L_c_10:
	s_call_b64 s[42:43], L_extra
	s_branch L_c_10_b
L_c_11:
	s_call_b64 s[42:43], L_swap
	s_branch L_c_11_b
L_c_12:
	s_call_b64 s[42:43], L_swap
	s_branch L_c_12_b
L_c_13:
	s_call_b64 s[42:43], L_swap
	s_branch L_c_13_b
L_c_14:
	s_call_b64 s[42:43], L_swap
	s_branch L_c_14_b
L_c_15:
	s_call_b64 s[42:43], L_adopt
	s_branch L_c_15_b
L_c_16:
	s_call_b64 s[42:43], L_adopt
	s_branch L_c_16_b
L_c_17:
	s_call_b64 s[42:43], L_adopt
	s_branch L_c_17_b
L_c_18:
	s_call_b64 s[42:43], L_adopt
	s_branch L_c_18_b
L_c_19:
	s_call_b64 s[42:43], L_adopt
	s_branch L_c_19_b
L_c_20:
	s_call_b64 s[42:43], L_adopt
	s_branch L_c_20_b
L_c_21:
	s_call_b64 s[42:43], L_adopt
	s_branch L_c_21_b
L_c_22:
	s_call_b64 s[42:43], L_adopt
	s_branch L_c_22_b
L_c_23:
	s_call_b64 s[42:43], L_adopt
	s_branch L_c_23_b
L_swap:
	s_mov_b32 s44, s48
	s_mov_b32 s45, s49
	s_movk_i32 s62, 0x7fff
	v_subrev_u32 v1, 0x200000, v1
	s_setpc_b64 s[42:43]
L_extra:
	s_cmp_ge_u32 s60, 24
	s_cbranch_scc1 L_extra_l
	s_lshl_b32 s68, s60, 3
	s_set_gpr_idx_on s68, gpr_idx(SRC0)
	v_mov_b32 v48, v56
	v_mov_b32 v49, v57
	v_mov_b32 v50, v58
	v_mov_b32 v51, v59
	v_mov_b32 v52, v60
	v_mov_b32 v53, v61
	v_mov_b32 v54, v62
	v_mov_b32 v55, v63
	s_set_gpr_idx_off
	s_add_u32 s68, s60, 16
	s_branch L_extra_go
L_extra_l:
	ds_read_b128 v[52:55], v0 offset:1024
	v_add_u32 v0, 0x800, v0
	s_sub_u32 s68, s60, 24
L_extra_go:
	v_dot2_f32_bf16 v4, v48, v12, 0
	v_dot2_f32_bf16 v4, v49, v13, v4
	v_dot2_f32_bf16 v4, v50, v14, v4
	v_dot2_f32_bf16 v4, v51, v15, v4
	s_and_b32 s64, s68, 3
	s_lshr_b32 s68, s68, 2
	s_sub_u32 s68, s68, s60
	s_lshl_b32 s68, s68, 4
	s_add_u32 s68, s68, s64
	s_sub_u32 s68, s68, 176
	s_lshl_b32 s68, s68, 2
	s_waitcnt lgkmcnt(0)
	v_dot2_f32_bf16 v5, v52, v12, 0
	v_dot2_f32_bf16 v5, v53, v13, v5
	v_dot2_f32_bf16 v5, v54, v14, v5
	v_dot2_f32_bf16 v5, v55, v15, v5
	v_add_u32 v9, s68, v2
	v_add_f32_dpp v4, v4, v4 row_ror:8 row_mask:0xf bank_mask:0xf
	s_nop 0
	v_add_f32_dpp v5, v5, v5 row_ror:8 row_mask:0xf bank_mask:0xf
	v_add_f32_dpp v4, v4, v4 row_ror:4 row_mask:0xf bank_mask:0xf
	s_nop 0
	v_add_f32_dpp v5, v5, v5 row_ror:4 row_mask:0xf bank_mask:0xf
	v_add_f32_dpp v4, v4, v4 row_ror:2 row_mask:0xf bank_mask:0xf
	s_nop 0
	v_add_f32_dpp v5, v5, v5 row_ror:2 row_mask:0xf bank_mask:0xf
	v_add_f32_dpp v4, v4, v4 row_ror:1 row_mask:0xf bank_mask:0xf
	s_nop 0
	v_add_f32_dpp v5, v5, v5 row_ror:1 row_mask:0xf bank_mask:0xf
	v_cvt_pk_bf16_f32 v4, 0, v4
	v_cvt_pk_bf16_f32 v5, 0, v5
	v_mul_f32 v4, 0x3db504f3, v4
	v_mul_f32 v5, 0x3db504f3, v5
	v_max3_f32 v11, v11, v4, v5
	v_cvt_pk_bf16_f32 v3, v4, v5
	s_mov_b32 exec_lo, 0x10001
	s_mov_b32 exec_hi, 0x10001
	ds_write_b32 v9, v3
	s_mov_b64 exec, -1
	s_setpc_b64 s[42:43]
L_max:
	v_cvt_pk_bf16_f32 v4, 0, v11
	v_cvt_pk_bf16_f32 v5, 0, v11
	v_subrev_u32 v2, 0x1000, v2
	s_nop 0
	v_permlane32_swap_b32 v4, v5
	v_max_f32 v4, v4, v5
	v_mov_b32 v5, v4
	s_nop 1
	v_permlane16_swap_b32 v4, v5
	v_max_f32 v4, v4, v5
	v_mul_f32 v7, 0xbfb8aa3b, v4
	ds_write_b32 v10, v7 offset:2304
	s_setpc_b64 s[42:43]
L_adopt:
	s_mov_b32 s68, 0
L_adopt_w:
	ds_read_b32 v3, v8 offset:3116
	ds_read_b32 v9, v10 offset:2320
	ds_read_b32 v4, v8 offset:3124
	s_waitcnt lgkmcnt(0)
	v_cmp_eq_u32 vcc, 0, v3
	s_cbranch_vccz L_adopt_go
	s_add_u32 s68, s68, 1
	s_cmp_lt_u32 s68, 1048576
	s_cbranch_scc1 L_adopt_w
L_adopt_go:
	v_mov_b32 v7, v4
	v_mul_f32 v16, v16, v9
	v_mul_f32 v17, v17, v9
	v_mul_f32 v18, v18, v9
	v_mul_f32 v19, v19, v9
	v_mul_f32 v20, v20, v9
	v_mul_f32 v21, v21, v9
	v_mul_f32 v22, v22, v9
	v_mul_f32 v23, v23, v9
	s_setpc_b64 s[42:43]
L_helper:
	s_and_b32 s32, s2, 7
	s_lshr_b32 s33, s2, 3
	s_and_b32 s36, s33, 7
	s_mov_b32 s69, 0x05040100
	s_mov_b32 s70, 0x07060302
	v_and_b32 v11, 1, v0
	v_bfe_u32 v12, v0, 4, 1
	v_lshrrev_b32 v13, 5, v0
	v_mov_b32 v5, 0
	v_mov_b32 v6, 0
	s_lshr_b32 s60, s33, 3
	s_lshl_b32 s60, s60, 3
	s_add_u32 s60, s60, s32
	s_lshl_b32 s38, s60, 3
	s_add_u32 s38, s38, s36
	s_sub_u32 s60, s33, 8
	s_lshl_b32 s61, s32, 2
	s_add_u32 s39, s60, s61
	s_cmp_lt_u32 s60, 4
	s_cselect_b32 s39, s39, 64
	s_waitcnt lgkmcnt(0)
	s_mov_b32 s44, s30
	s_mov_b32 s45, s31
	s_mov_b32 s46, 1671168
	s_mov_b32 s47, 0x20000
	s_mov_b32 s48, s28
	s_mov_b32 s49, s29
	s_mov_b32 s50, 256
	s_mov_b32 s51, 0x20000
	s_cmp_eq_u32 s3, 5
	s_cbranch_scc1 L_taskB
	s_cmp_eq_u32 s3, 4
	s_cbranch_scc1 L_taskA
	s_cmp_eq_u32 s3, 6
	s_cbranch_scc1 L_mark
	s_cmp_lg_u32 s33, 9
	s_cbranch_scc1 L_bar1
	s_getpc_b64 s[60:61]
L_pc0:
	s_sub_u32 s60, s60, L_pc0 - adaLN_cond__mha_block_cached__glu_gated_bilinear__decode_kernel
	s_subb_u32 s61, s61, 0
	v_lshlrev_b32 v2, 7, v0
	v_mov_b32 v3, s61
	v_add_co_u32 v2, vcc, s60, v2
	s_nop 1
	v_addc_co_u32 v3, vcc, 0, v3, vcc
	v_mov_b32 v8, v0
L_w0:
	v_cmp_gt_u32 vcc, (L_fin - adaLN_cond__mha_block_cached__glu_gated_bilinear__decode_kernel)/128, v8
	s_and_b64 exec, exec, vcc
	s_cbranch_execz L_w0d
	global_load_dword v4, v[2:3], off
	v_add_co_u32 v2, vcc, 0x2000, v2
	s_nop 1
	v_addc_co_u32 v3, vcc, 0, v3, vcc
	v_add_u32 v8, 64, v8
	s_branch L_w0
L_w0d:
	s_mov_b64 exec, -1
	s_branch L_bar1
L_mark:
	v_mov_b32 v16, -1
	v_mov_b32 v17, -1
	v_mov_b32 v18, -1
	v_mov_b32 v19, -1
	s_mul_i32 s61, s2, 5120
	v_lshl_add_u32 v3, v0, 4, s61
	s_mov_b32 s60, 327680
	s_mov_b32 s61, 331776
	s_lshl_b32 s62, s2, 7
	s_add_u32 s62, s62, 1638400
	v_lshlrev_b32 v4, 4, v0
	s_mov_b64 exec, 0xff
	buffer_store_dwordx4 v[16:19], v4, s[44:47], s62 offen sc1
	s_mov_b64 exec, -1
	s_sub_u32 s62, s2, 58
	s_cmp_lt_u32 s62, 178
	s_cbranch_scc1 L_mark_nt
	buffer_store_dwordx4 v[16:19], v3, s[44:47], s60 offen offset:0 sc1
	buffer_store_dwordx4 v[16:19], v3, s[44:47], s60 offen offset:1024 sc1
	buffer_store_dwordx4 v[16:19], v3, s[44:47], s60 offen offset:2048 sc1
	buffer_store_dwordx4 v[16:19], v3, s[44:47], s60 offen offset:3072 sc1
	buffer_store_dwordx4 v[16:19], v3, s[44:47], s61 offen offset:0 sc1
	s_branch L_bar1
L_mark_nt:
	buffer_store_dwordx4 v[16:19], v3, s[44:47], s60 offen offset:0 sc1 nt
	buffer_store_dwordx4 v[16:19], v3, s[44:47], s60 offen offset:1024 sc1 nt
	buffer_store_dwordx4 v[16:19], v3, s[44:47], s60 offen offset:2048 sc1 nt
	buffer_store_dwordx4 v[16:19], v3, s[44:47], s60 offen offset:3072 sc1 nt
	buffer_store_dwordx4 v[16:19], v3, s[44:47], s61 offen offset:0 sc1 nt
	s_branch L_bar1
L_taskA:
	s_cmp_ge_u32 s2, 64
	s_cbranch_scc1 L_bar1
	s_and_b32 s62, s2, 15
	s_lshr_b32 s63, s2, 4
	v_mov_b32 v4, -1
	v_mov_b32 v5, -1
	v_mov_b32 v6, -1
	v_mov_b32 v7, -1
	s_lshl_b32 s61, s32, 3
	s_add_u32 s64, s61, s33
	s_lshr_b32 s61, s33, 1
	s_lshl_b32 s61, s61, 6
	s_or_b32 s65, s61, s32
	s_bfe_u32 s61, s65, 0x20001
	s_bfe_u32 s60, s65, 0x20006
	s_lshl_b32 s60, s60, 2
	s_or_b32 s61, s61, s60
	s_bfe_u32 s60, s65, 0x10000
	s_lshl_b32 s60, s60, 4
	s_or_b32 s61, s61, s60
	s_lshl_b32 s61, s61, 1
	s_and_b32 s60, s33, 1
	s_or_b32 s61, s61, s60
	s_lshl_b32 s61, s61, 12
	v_lshl_add_u32 v3, v0, 4, s61
	s_mov_b32 s60, 65536
	buffer_store_dwordx4 v[4:7], v3, s[44:47], s60 offen offset:0 sc1
	buffer_store_dwordx4 v[4:7], v3, s[44:47], s60 offen offset:1024 sc1
	buffer_store_dwordx4 v[4:7], v3, s[44:47], s60 offen offset:2048 sc1
	buffer_store_dwordx4 v[4:7], v3, s[44:47], s60 offen offset:3072 sc1
	s_lshl_b32 s61, s64, 4
	s_add_u32 s61, s61, 32768
	v_mov_b32 v3, 0
	s_mov_b64 exec, 1
	buffer_store_dwordx4 v[4:7], v3, s[44:47], s61 offen sc1
	s_mov_b64 exec, -1
	s_call_b64 s[42:43], L_modload
	s_barrier
	v_mov_b32 v106, 0
	v_mov_b32 v107, 0
	v_mov_b32 v108, 0
	v_mov_b32 v109, 0
	v_mov_b32 v110, 0
	v_mov_b32 v111, 0
	v_mov_b32 v112, 0
	v_mov_b32 v113, 0
	v_mov_b32 v114, 0
	v_mov_b32 v115, 0
	v_mov_b32 v116, 0
	v_mov_b32 v117, 0
	v_mov_b32 v118, 0
	v_mov_b32 v119, 0
	v_mov_b32 v120, 0
	v_mov_b32 v121, 0
	s_waitcnt vmcnt(16)
	v_lshlrev_b32 v128, 16, v16
	v_and_b32 v129, 0xffff0000, v16
	v_lshlrev_b32 v130, 16, v17
	v_and_b32 v131, 0xffff0000, v17
	v_lshlrev_b32 v132, 16, v18
	v_and_b32 v133, 0xffff0000, v18
	v_lshlrev_b32 v134, 16, v19
	v_and_b32 v135, 0xffff0000, v19
	v_lshlrev_b32 v136, 16, v20
	v_and_b32 v137, 0xffff0000, v20
	v_lshlrev_b32 v138, 16, v21
	v_and_b32 v139, 0xffff0000, v21
	v_lshlrev_b32 v140, 16, v22
	v_and_b32 v141, 0xffff0000, v22
	v_lshlrev_b32 v142, 16, v23
	v_and_b32 v143, 0xffff0000, v23
	v_mul_f32 v144, 0xbfb8aa3b, v128
	v_mul_f32 v145, 0xbfb8aa3b, v129
	v_mul_f32 v146, 0xbfb8aa3b, v130
	v_mul_f32 v147, 0xbfb8aa3b, v131
	v_mul_f32 v148, 0xbfb8aa3b, v132
	v_mul_f32 v149, 0xbfb8aa3b, v133
	v_mul_f32 v150, 0xbfb8aa3b, v134
	v_mul_f32 v151, 0xbfb8aa3b, v135
	v_mul_f32 v152, 0xbfb8aa3b, v136
	v_mul_f32 v153, 0xbfb8aa3b, v137
	v_mul_f32 v154, 0xbfb8aa3b, v138
	v_mul_f32 v155, 0xbfb8aa3b, v139
	v_mul_f32 v156, 0xbfb8aa3b, v140
	v_mul_f32 v157, 0xbfb8aa3b, v141
	v_mul_f32 v158, 0xbfb8aa3b, v142
	v_mul_f32 v159, 0xbfb8aa3b, v143
	v_exp_f32 v144, v144
	v_exp_f32 v145, v145
	v_exp_f32 v146, v146
	v_exp_f32 v147, v147
	v_exp_f32 v148, v148
	v_exp_f32 v149, v149
	v_exp_f32 v150, v150
	v_exp_f32 v151, v151
	v_exp_f32 v152, v152
	v_exp_f32 v153, v153
	v_exp_f32 v154, v154
	v_exp_f32 v155, v155
	v_exp_f32 v156, v156
	v_exp_f32 v157, v157
	v_exp_f32 v158, v158
	v_exp_f32 v159, v159
	v_add_f32 v144, 1.0, v144
	v_add_f32 v145, 1.0, v145
	v_add_f32 v146, 1.0, v146
	v_add_f32 v147, 1.0, v147
	v_add_f32 v148, 1.0, v148
	v_add_f32 v149, 1.0, v149
	v_add_f32 v150, 1.0, v150
	v_add_f32 v151, 1.0, v151
	v_add_f32 v152, 1.0, v152
	v_add_f32 v153, 1.0, v153
	v_add_f32 v154, 1.0, v154
	v_add_f32 v155, 1.0, v155
	v_add_f32 v156, 1.0, v156
	v_add_f32 v157, 1.0, v157
	v_add_f32 v158, 1.0, v158
	v_add_f32 v159, 1.0, v159
	v_rcp_f32 v144, v144
	v_rcp_f32 v145, v145
	v_rcp_f32 v146, v146
	v_rcp_f32 v147, v147
	v_rcp_f32 v148, v148
	v_rcp_f32 v149, v149
	v_rcp_f32 v150, v150
	v_rcp_f32 v151, v151
	v_rcp_f32 v152, v152
	v_rcp_f32 v153, v153
	v_rcp_f32 v154, v154
	v_rcp_f32 v155, v155
	v_rcp_f32 v156, v156
	v_rcp_f32 v157, v157
	v_rcp_f32 v158, v158
	v_rcp_f32 v159, v159
	v_pk_mul_f32 v[128:129], v[128:129], v[144:145]
	v_pk_mul_f32 v[130:131], v[130:131], v[146:147]
	v_pk_mul_f32 v[132:133], v[132:133], v[148:149]
	v_pk_mul_f32 v[134:135], v[134:135], v[150:151]
	v_pk_mul_f32 v[136:137], v[136:137], v[152:153]
	v_pk_mul_f32 v[138:139], v[138:139], v[154:155]
	v_pk_mul_f32 v[140:141], v[140:141], v[156:157]
	v_pk_mul_f32 v[142:143], v[142:143], v[158:159]
	v_cvt_pk_bf16_f32 v16, v128, v129
	v_cvt_pk_bf16_f32 v17, v130, v131
	v_cvt_pk_bf16_f32 v18, v132, v133
	v_cvt_pk_bf16_f32 v19, v134, v135
	v_cvt_pk_bf16_f32 v20, v136, v137
	v_cvt_pk_bf16_f32 v21, v138, v139
	v_cvt_pk_bf16_f32 v22, v140, v141
	v_cvt_pk_bf16_f32 v23, v142, v143
	v_mov_b32_dpp v24, v16 quad_perm:[0,0,2,2] row_mask:0xf bank_mask:0xf
	v_mov_b32_dpp v32, v16 quad_perm:[1,1,3,3] row_mask:0xf bank_mask:0xf
	v_mov_b32_dpp v25, v17 quad_perm:[0,0,2,2] row_mask:0xf bank_mask:0xf
	v_mov_b32_dpp v33, v17 quad_perm:[1,1,3,3] row_mask:0xf bank_mask:0xf
	v_mov_b32_dpp v26, v18 quad_perm:[0,0,2,2] row_mask:0xf bank_mask:0xf
	v_mov_b32_dpp v34, v18 quad_perm:[1,1,3,3] row_mask:0xf bank_mask:0xf
	v_mov_b32_dpp v27, v19 quad_perm:[0,0,2,2] row_mask:0xf bank_mask:0xf
	v_mov_b32_dpp v35, v19 quad_perm:[1,1,3,3] row_mask:0xf bank_mask:0xf
	v_mov_b32_dpp v28, v20 quad_perm:[0,0,2,2] row_mask:0xf bank_mask:0xf
	v_mov_b32_dpp v36, v20 quad_perm:[1,1,3,3] row_mask:0xf bank_mask:0xf
	v_mov_b32_dpp v29, v21 quad_perm:[0,0,2,2] row_mask:0xf bank_mask:0xf
	v_mov_b32_dpp v37, v21 quad_perm:[1,1,3,3] row_mask:0xf bank_mask:0xf
	v_mov_b32_dpp v30, v22 quad_perm:[0,0,2,2] row_mask:0xf bank_mask:0xf
	v_mov_b32_dpp v38, v22 quad_perm:[1,1,3,3] row_mask:0xf bank_mask:0xf
	v_mov_b32_dpp v31, v23 quad_perm:[0,0,2,2] row_mask:0xf bank_mask:0xf
	v_mov_b32_dpp v39, v23 quad_perm:[1,1,3,3] row_mask:0xf bank_mask:0xf
	s_waitcnt vmcnt(14)
	v_perm_b32 v104, v44, v40, s69
	v_perm_b32 v44, v44, v40, s70
	v_perm_b32 v40, v45, v41, s69
	v_perm_b32 v45, v45, v41, s70
	v_perm_b32 v41, v46, v42, s69
	v_perm_b32 v46, v46, v42, s70
	v_perm_b32 v42, v47, v43, s69
	v_perm_b32 v47, v47, v43, s70
	v_dot2c_f32_bf16 v106, v24, v104
	v_dot2c_f32_bf16 v114, v32, v104
	v_dot2c_f32_bf16 v107, v24, v44
	v_dot2c_f32_bf16 v115, v32, v44
	v_dot2c_f32_bf16 v108, v24, v40
	v_dot2c_f32_bf16 v116, v32, v40
	v_dot2c_f32_bf16 v109, v24, v45
	v_dot2c_f32_bf16 v117, v32, v45
	v_dot2c_f32_bf16 v110, v24, v41
	v_dot2c_f32_bf16 v118, v32, v41
	v_dot2c_f32_bf16 v111, v24, v46
	v_dot2c_f32_bf16 v119, v32, v46
	v_dot2c_f32_bf16 v112, v24, v42
	v_dot2c_f32_bf16 v120, v32, v42
	v_dot2c_f32_bf16 v113, v24, v47
	v_dot2c_f32_bf16 v121, v32, v47
	s_waitcnt vmcnt(12)
	v_perm_b32 v43, v52, v48, s69
	v_perm_b32 v52, v52, v48, s70
	v_perm_b32 v48, v53, v49, s69
	v_perm_b32 v53, v53, v49, s70
	v_perm_b32 v49, v54, v50, s69
	v_perm_b32 v54, v54, v50, s70
	v_perm_b32 v50, v55, v51, s69
	v_perm_b32 v55, v55, v51, s70
	v_dot2c_f32_bf16 v106, v25, v43
	v_dot2c_f32_bf16 v114, v33, v43
	v_dot2c_f32_bf16 v107, v25, v52
	v_dot2c_f32_bf16 v115, v33, v52
	v_dot2c_f32_bf16 v108, v25, v48
	v_dot2c_f32_bf16 v116, v33, v48
	v_dot2c_f32_bf16 v109, v25, v53
	v_dot2c_f32_bf16 v117, v33, v53
	v_dot2c_f32_bf16 v110, v25, v49
	v_dot2c_f32_bf16 v118, v33, v49
	v_dot2c_f32_bf16 v111, v25, v54
	v_dot2c_f32_bf16 v119, v33, v54
	v_dot2c_f32_bf16 v112, v25, v50
	v_dot2c_f32_bf16 v120, v33, v50
	v_dot2c_f32_bf16 v113, v25, v55
	v_dot2c_f32_bf16 v121, v33, v55
	s_waitcnt vmcnt(10)
	v_perm_b32 v51, v60, v56, s69
	v_perm_b32 v60, v60, v56, s70
	v_perm_b32 v56, v61, v57, s69
	v_perm_b32 v61, v61, v57, s70
	v_perm_b32 v57, v62, v58, s69
	v_perm_b32 v62, v62, v58, s70
	v_perm_b32 v58, v63, v59, s69
	v_perm_b32 v63, v63, v59, s70
	v_dot2c_f32_bf16 v106, v26, v51
	v_dot2c_f32_bf16 v114, v34, v51
	v_dot2c_f32_bf16 v107, v26, v60
	v_dot2c_f32_bf16 v115, v34, v60
	v_dot2c_f32_bf16 v108, v26, v56
	v_dot2c_f32_bf16 v116, v34, v56
	v_dot2c_f32_bf16 v109, v26, v61
	v_dot2c_f32_bf16 v117, v34, v61
	v_dot2c_f32_bf16 v110, v26, v57
	v_dot2c_f32_bf16 v118, v34, v57
	v_dot2c_f32_bf16 v111, v26, v62
	v_dot2c_f32_bf16 v119, v34, v62
	v_dot2c_f32_bf16 v112, v26, v58
	v_dot2c_f32_bf16 v120, v34, v58
	v_dot2c_f32_bf16 v113, v26, v63
	v_dot2c_f32_bf16 v121, v34, v63
	s_waitcnt vmcnt(8)
	v_perm_b32 v59, v68, v64, s69
	v_perm_b32 v68, v68, v64, s70
	v_perm_b32 v64, v69, v65, s69
	v_perm_b32 v69, v69, v65, s70
	v_perm_b32 v65, v70, v66, s69
	v_perm_b32 v70, v70, v66, s70
	v_perm_b32 v66, v71, v67, s69
	v_perm_b32 v71, v71, v67, s70
	v_dot2c_f32_bf16 v106, v27, v59
	v_dot2c_f32_bf16 v114, v35, v59
	v_dot2c_f32_bf16 v107, v27, v68
	v_dot2c_f32_bf16 v115, v35, v68
	v_dot2c_f32_bf16 v108, v27, v64
	v_dot2c_f32_bf16 v116, v35, v64
	v_dot2c_f32_bf16 v109, v27, v69
	v_dot2c_f32_bf16 v117, v35, v69
	v_dot2c_f32_bf16 v110, v27, v65
	v_dot2c_f32_bf16 v118, v35, v65
	v_dot2c_f32_bf16 v111, v27, v70
	v_dot2c_f32_bf16 v119, v35, v70
	v_dot2c_f32_bf16 v112, v27, v66
	v_dot2c_f32_bf16 v120, v35, v66
	v_dot2c_f32_bf16 v113, v27, v71
	v_dot2c_f32_bf16 v121, v35, v71
	s_waitcnt vmcnt(6)
	v_perm_b32 v67, v76, v72, s69
	v_perm_b32 v76, v76, v72, s70
	v_perm_b32 v72, v77, v73, s69
	v_perm_b32 v77, v77, v73, s70
	v_perm_b32 v73, v78, v74, s69
	v_perm_b32 v78, v78, v74, s70
	v_perm_b32 v74, v79, v75, s69
	v_perm_b32 v79, v79, v75, s70
	v_dot2c_f32_bf16 v106, v28, v67
	v_dot2c_f32_bf16 v114, v36, v67
	v_dot2c_f32_bf16 v107, v28, v76
	v_dot2c_f32_bf16 v115, v36, v76
	v_dot2c_f32_bf16 v108, v28, v72
	v_dot2c_f32_bf16 v116, v36, v72
	v_dot2c_f32_bf16 v109, v28, v77
	v_dot2c_f32_bf16 v117, v36, v77
	v_dot2c_f32_bf16 v110, v28, v73
	v_dot2c_f32_bf16 v118, v36, v73
	v_dot2c_f32_bf16 v111, v28, v78
	v_dot2c_f32_bf16 v119, v36, v78
	v_dot2c_f32_bf16 v112, v28, v74
	v_dot2c_f32_bf16 v120, v36, v74
	v_dot2c_f32_bf16 v113, v28, v79
	v_dot2c_f32_bf16 v121, v36, v79
	s_waitcnt vmcnt(4)
	v_perm_b32 v75, v84, v80, s69
	v_perm_b32 v84, v84, v80, s70
	v_perm_b32 v80, v85, v81, s69
	v_perm_b32 v85, v85, v81, s70
	v_perm_b32 v81, v86, v82, s69
	v_perm_b32 v86, v86, v82, s70
	v_perm_b32 v82, v87, v83, s69
	v_perm_b32 v87, v87, v83, s70
	v_dot2c_f32_bf16 v106, v29, v75
	v_dot2c_f32_bf16 v114, v37, v75
	v_dot2c_f32_bf16 v107, v29, v84
	v_dot2c_f32_bf16 v115, v37, v84
	v_dot2c_f32_bf16 v108, v29, v80
	v_dot2c_f32_bf16 v116, v37, v80
	v_dot2c_f32_bf16 v109, v29, v85
	v_dot2c_f32_bf16 v117, v37, v85
	v_dot2c_f32_bf16 v110, v29, v81
	v_dot2c_f32_bf16 v118, v37, v81
	v_dot2c_f32_bf16 v111, v29, v86
	v_dot2c_f32_bf16 v119, v37, v86
	v_dot2c_f32_bf16 v112, v29, v82
	v_dot2c_f32_bf16 v120, v37, v82
	v_dot2c_f32_bf16 v113, v29, v87
	v_dot2c_f32_bf16 v121, v37, v87
	s_waitcnt vmcnt(2)
	v_perm_b32 v83, v92, v88, s69
	v_perm_b32 v92, v92, v88, s70
	v_perm_b32 v88, v93, v89, s69
	v_perm_b32 v93, v93, v89, s70
	v_perm_b32 v89, v94, v90, s69
	v_perm_b32 v94, v94, v90, s70
	v_perm_b32 v90, v95, v91, s69
	v_perm_b32 v95, v95, v91, s70
	v_dot2c_f32_bf16 v106, v30, v83
	v_dot2c_f32_bf16 v114, v38, v83
	v_dot2c_f32_bf16 v107, v30, v92
	v_dot2c_f32_bf16 v115, v38, v92
	v_dot2c_f32_bf16 v108, v30, v88
	v_dot2c_f32_bf16 v116, v38, v88
	v_dot2c_f32_bf16 v109, v30, v93
	v_dot2c_f32_bf16 v117, v38, v93
	v_dot2c_f32_bf16 v110, v30, v89
	v_dot2c_f32_bf16 v118, v38, v89
	v_dot2c_f32_bf16 v111, v30, v94
	v_dot2c_f32_bf16 v119, v38, v94
	v_dot2c_f32_bf16 v112, v30, v90
	v_dot2c_f32_bf16 v120, v38, v90
	v_dot2c_f32_bf16 v113, v30, v95
	v_dot2c_f32_bf16 v121, v38, v95
	s_waitcnt vmcnt(0)
	v_perm_b32 v91, v100, v96, s69
	v_perm_b32 v100, v100, v96, s70
	v_perm_b32 v96, v101, v97, s69
	v_perm_b32 v101, v101, v97, s70
	v_perm_b32 v97, v102, v98, s69
	v_perm_b32 v102, v102, v98, s70
	v_perm_b32 v98, v103, v99, s69
	v_perm_b32 v103, v103, v99, s70
	v_dot2c_f32_bf16 v106, v31, v91
	v_dot2c_f32_bf16 v114, v39, v91
	v_dot2c_f32_bf16 v107, v31, v100
	v_dot2c_f32_bf16 v115, v39, v100
	v_dot2c_f32_bf16 v108, v31, v96
	v_dot2c_f32_bf16 v116, v39, v96
	v_dot2c_f32_bf16 v109, v31, v101
	v_dot2c_f32_bf16 v117, v39, v101
	v_dot2c_f32_bf16 v110, v31, v97
	v_dot2c_f32_bf16 v118, v39, v97
	v_dot2c_f32_bf16 v111, v31, v102
	v_dot2c_f32_bf16 v119, v39, v102
	v_dot2c_f32_bf16 v112, v31, v98
	v_dot2c_f32_bf16 v120, v39, v98
	v_dot2c_f32_bf16 v113, v31, v103
	v_dot2c_f32_bf16 v121, v39, v103
	v_permlane32_swap_b32 v106, v114
	v_permlane32_swap_b32 v107, v115
	v_permlane32_swap_b32 v108, v116
	v_permlane32_swap_b32 v109, v117
	v_permlane32_swap_b32 v110, v118
	v_permlane32_swap_b32 v111, v119
	v_permlane32_swap_b32 v112, v120
	v_permlane32_swap_b32 v113, v121
	v_add_f32 v106, v106, v114
	v_add_f32 v107, v107, v115
	v_add_f32 v108, v108, v116
	v_add_f32 v109, v109, v117
	v_add_f32 v110, v110, v118
	v_add_f32 v111, v111, v119
	v_add_f32 v112, v112, v120
	v_add_f32 v113, v113, v121
	v_permlane16_swap_b32 v106, v110
	v_permlane16_swap_b32 v107, v111
	v_permlane16_swap_b32 v108, v112
	v_permlane16_swap_b32 v109, v113
	v_add_f32 v106, v106, v110
	v_add_f32 v107, v107, v111
	v_add_f32 v108, v108, v112
	v_add_f32 v109, v109, v113
	v_add_f32_dpp v106, v106, v106 row_ror:8 row_mask:0xf bank_mask:0xf
	v_add_f32_dpp v107, v107, v107 row_ror:8 row_mask:0xf bank_mask:0xf
	v_add_f32_dpp v108, v108, v108 row_ror:8 row_mask:0xf bank_mask:0xf
	v_add_f32_dpp v109, v109, v109 row_ror:8 row_mask:0xf bank_mask:0xf
	v_and_b32 v1, 7, v0
	v_lshlrev_b32 v1, 5, v1
	v_lshl_add_u32 v1, v12, 4, v1
	v_lshl_add_u32 v1, v13, 8, v1
	s_lshl_b32 s60, s62, 2
	s_add_u32 s60, s60, s63
	s_lshl_b32 s60, s60, 9
	s_mov_b32 exec_lo, 0xff00ff
	s_mov_b32 exec_hi, 0xff00ff
	buffer_store_dwordx4 v[106:109], v1, s[44:47], s60 offen sc1
	s_mov_b64 exec, 1
	v_mov_b32 v15, 0
	v_mov_b32 v14, 1
	s_waitcnt vmcnt(0)
	buffer_atomic_add v14, v15, s[48:51], 0 offen sc0 sc1
	s_waitcnt vmcnt(0)
	v_cmp_ne_u32 vcc, 63, v14
	s_cbranch_vccnz L_arrived
	buffer_store_dword v14, v15, s[48:51], 0 offen offset:128 sc1
L_arrived:
	s_mov_b64 exec, -1
	s_branch L_waitq
L_modload:
	s_mov_b32 s56, s22
	s_mov_b32 s57, s23
	s_mov_b32 s58, 2048
	s_mov_b32 s59, 0x20000
	s_mov_b32 s52, s24
	s_mov_b32 s53, s25
	s_mov_b32 s54, 3145728
	s_mov_b32 s55, 0x20000
	v_lshrrev_b32 v10, 3, v0
	v_lshlrev_b32 v1, 5, v10
	v_lshl_add_u32 v1, v11, 10, v1
	s_lshl_b32 s60, s63, 8
	buffer_load_dwordx4 v[16:19], v1, s[56:59], s60 offen
	buffer_load_dwordx4 v[20:23], v1, s[56:59], s60 offen offset:16
	s_mov_b32 s60, 98304
	v_mul_lo_u32 v1, s60, v10
	v_and_b32 v2, 7, v0
	v_lshl_add_u32 v1, v2, 4, v1
	s_mul_i32 s60, s63, 786432
	s_lshl_b32 s61, s62, 7
	s_add_u32 s60, s60, s61
	buffer_load_dwordx4 v[40:43], v1, s[52:55], s60 offen nt
	s_add_u32 s60, s60, 6144
	buffer_load_dwordx4 v[44:47], v1, s[52:55], s60 offen nt
	s_add_u32 s60, s60, 6144
	buffer_load_dwordx4 v[48:51], v1, s[52:55], s60 offen nt
	s_add_u32 s60, s60, 6144
	buffer_load_dwordx4 v[52:55], v1, s[52:55], s60 offen nt
	s_add_u32 s60, s60, 6144
	buffer_load_dwordx4 v[56:59], v1, s[52:55], s60 offen nt
	s_add_u32 s60, s60, 6144
	buffer_load_dwordx4 v[60:63], v1, s[52:55], s60 offen nt
	s_add_u32 s60, s60, 6144
	buffer_load_dwordx4 v[64:67], v1, s[52:55], s60 offen nt
	s_add_u32 s60, s60, 6144
	buffer_load_dwordx4 v[68:71], v1, s[52:55], s60 offen nt
	s_add_u32 s60, s60, 6144
	buffer_load_dwordx4 v[72:75], v1, s[52:55], s60 offen nt
	s_add_u32 s60, s60, 6144
	buffer_load_dwordx4 v[76:79], v1, s[52:55], s60 offen nt
	s_add_u32 s60, s60, 6144
	buffer_load_dwordx4 v[80:83], v1, s[52:55], s60 offen nt
	s_add_u32 s60, s60, 6144
	buffer_load_dwordx4 v[84:87], v1, s[52:55], s60 offen nt
	s_add_u32 s60, s60, 6144
	buffer_load_dwordx4 v[88:91], v1, s[52:55], s60 offen nt
	s_add_u32 s60, s60, 6144
	buffer_load_dwordx4 v[92:95], v1, s[52:55], s60 offen nt
	s_add_u32 s60, s60, 6144
	buffer_load_dwordx4 v[96:99], v1, s[52:55], s60 offen nt
	s_add_u32 s60, s60, 6144
	buffer_load_dwordx4 v[100:103], v1, s[52:55], s60 offen nt
	s_setpc_b64 s[42:43]
L_taskB:
	s_mov_b32 s56, s4
	s_mov_b32 s57, s5
	s_mov_b32 s58, 2048
	s_mov_b32 s59, 0x20000
	s_mov_b32 s52, s10
	s_mov_b32 s53, s11
	s_mov_b32 s54, 4194304
	s_mov_b32 s55, 0x20000
	v_lshrrev_b32 v10, 1, v0
	v_lshlrev_b32 v1, 5, v10
	v_lshl_add_u32 v1, v11, 10, v1
	buffer_load_dwordx4 v[16:19], v1, s[56:59], 0 offen
	buffer_load_dwordx4 v[20:23], v1, s[56:59], 0 offen offset:16
	v_lshrrev_b32 v9, 4, v0
	v_and_b32 v8, 14, v0
	v_lshl_add_u32 v8, v9, 4, v8
	v_lshlrev_b32 v1, 1, v8
	v_lshl_add_u32 v1, v11, 10, v1
	s_lshl_b32 s60, s36, 7
	buffer_load_dword v7, v1, s[56:59], s60 offen
	s_barrier
	v_lshlrev_b32 v1, 17, v9
	v_and_b32 v10, 15, v0
	v_lshl_add_u32 v1, v10, 4, v1
	s_lshl_b32 s60, s36, 19
	s_lshl_b32 s61, s34, 8
	s_add_u32 s60, s60, s61
	s_waitcnt vmcnt(0)
	v_lshlrev_b32 v128, 16, v16
	v_and_b32 v129, 0xffff0000, v16
	v_lshlrev_b32 v130, 16, v17
	v_and_b32 v131, 0xffff0000, v17
	v_lshlrev_b32 v132, 16, v18
	v_and_b32 v133, 0xffff0000, v18
	v_lshlrev_b32 v134, 16, v19
	v_and_b32 v135, 0xffff0000, v19
	v_lshlrev_b32 v136, 16, v20
	v_and_b32 v137, 0xffff0000, v20
	v_lshlrev_b32 v138, 16, v21
	v_and_b32 v139, 0xffff0000, v21
	v_lshlrev_b32 v140, 16, v22
	v_and_b32 v141, 0xffff0000, v22
	v_lshlrev_b32 v142, 16, v23
	v_and_b32 v143, 0xffff0000, v23
	v_pk_add_f32 v[144:145], v[128:129], v[130:131]
	v_pk_add_f32 v[144:145], v[144:145], v[132:133]
	v_pk_add_f32 v[144:145], v[144:145], v[134:135]
	v_pk_add_f32 v[144:145], v[144:145], v[136:137]
	v_pk_add_f32 v[144:145], v[144:145], v[138:139]
	v_pk_add_f32 v[144:145], v[144:145], v[140:141]
	v_pk_add_f32 v[144:145], v[144:145], v[142:143]
	v_add_f32 v2, v144, v145
	s_nop 1
	v_add_f32_dpp v2, v2, v2 row_ror:2 row_mask:0xf bank_mask:0xf
	s_nop 1
	v_add_f32_dpp v2, v2, v2 row_ror:4 row_mask:0xf bank_mask:0xf
	s_nop 1
	v_add_f32_dpp v2, v2, v2 row_ror:8 row_mask:0xf bank_mask:0xf
	v_mov_b32 v3, v2
	s_nop 1
	v_permlane16_swap_b32 v3, v2
	v_add_f32 v2, v2, v3
	v_mov_b32 v3, v2
	s_nop 1
	v_permlane32_swap_b32 v3, v2
	v_add_f32 v2, v2, v3
	v_mul_f32 v2, 0xbb000000, v2
	v_pk_add_f32 v[144:145], v[128:129], v[2:3] op_sel_hi:[1,0]
	v_pk_add_f32 v[146:147], v[130:131], v[2:3] op_sel_hi:[1,0]
	v_pk_add_f32 v[148:149], v[132:133], v[2:3] op_sel_hi:[1,0]
	v_pk_add_f32 v[150:151], v[134:135], v[2:3] op_sel_hi:[1,0]
	v_pk_add_f32 v[152:153], v[136:137], v[2:3] op_sel_hi:[1,0]
	v_pk_add_f32 v[154:155], v[138:139], v[2:3] op_sel_hi:[1,0]
	v_pk_add_f32 v[156:157], v[140:141], v[2:3] op_sel_hi:[1,0]
	v_pk_add_f32 v[158:159], v[142:143], v[2:3] op_sel_hi:[1,0]
	v_pk_mul_f32 v[4:5], v[144:145], v[144:145]
	v_pk_fma_f32 v[4:5], v[146:147], v[146:147], v[4:5]
	v_pk_fma_f32 v[4:5], v[148:149], v[148:149], v[4:5]
	v_pk_fma_f32 v[4:5], v[150:151], v[150:151], v[4:5]
	v_pk_fma_f32 v[4:5], v[152:153], v[152:153], v[4:5]
	v_pk_fma_f32 v[4:5], v[154:155], v[154:155], v[4:5]
	v_pk_fma_f32 v[4:5], v[156:157], v[156:157], v[4:5]
	v_pk_fma_f32 v[4:5], v[158:159], v[158:159], v[4:5]
	v_add_f32 v4, v4, v5
	s_nop 1
	v_add_f32_dpp v4, v4, v4 row_ror:2 row_mask:0xf bank_mask:0xf
	s_nop 1
	v_add_f32_dpp v4, v4, v4 row_ror:4 row_mask:0xf bank_mask:0xf
	s_nop 1
	v_add_f32_dpp v4, v4, v4 row_ror:8 row_mask:0xf bank_mask:0xf
	v_mov_b32 v5, v4
	s_nop 1
	v_permlane16_swap_b32 v5, v4
	v_add_f32 v4, v4, v5
	v_mov_b32 v5, v4
	s_nop 1
	v_permlane32_swap_b32 v5, v4
	v_add_f32 v4, v4, v5
	v_mul_f32 v4, 0x3b000000, v4
	buffer_load_dwordx4 v[40:43], v1, s[52:55], s60 offen nt
	s_add_u32 s60, s60, 8192
	buffer_load_dwordx4 v[44:47], v1, s[52:55], s60 offen nt
	s_add_u32 s60, s60, 8192
	buffer_load_dwordx4 v[48:51], v1, s[52:55], s60 offen nt
	s_add_u32 s60, s60, 8192
	buffer_load_dwordx4 v[52:55], v1, s[52:55], s60 offen nt
	s_add_u32 s60, s60, 8192
	buffer_load_dwordx4 v[56:59], v1, s[52:55], s60 offen nt
	s_add_u32 s60, s60, 8192
	buffer_load_dwordx4 v[60:63], v1, s[52:55], s60 offen nt
	s_add_u32 s60, s60, 8192
	buffer_load_dwordx4 v[64:67], v1, s[52:55], s60 offen nt
	s_add_u32 s60, s60, 8192
	buffer_load_dwordx4 v[68:71], v1, s[52:55], s60 offen nt
	s_add_u32 s60, s60, 8192
	buffer_load_dwordx4 v[72:75], v1, s[52:55], s60 offen nt
	s_add_u32 s60, s60, 8192
	buffer_load_dwordx4 v[76:79], v1, s[52:55], s60 offen nt
	s_add_u32 s60, s60, 8192
	buffer_load_dwordx4 v[80:83], v1, s[52:55], s60 offen nt
	s_add_u32 s60, s60, 8192
	buffer_load_dwordx4 v[84:87], v1, s[52:55], s60 offen nt
	s_add_u32 s60, s60, 8192
	buffer_load_dwordx4 v[88:91], v1, s[52:55], s60 offen nt
	s_add_u32 s60, s60, 8192
	buffer_load_dwordx4 v[92:95], v1, s[52:55], s60 offen nt
	s_add_u32 s60, s60, 8192
	buffer_load_dwordx4 v[96:99], v1, s[52:55], s60 offen nt
	s_add_u32 s60, s60, 8192
	buffer_load_dwordx4 v[100:103], v1, s[52:55], s60 offen nt
	v_cvt_pk_bf16_f32 v4, 0, v4
	v_cvt_pk_bf16_f32 v2, 0, v2
	v_add_f32 v4, 0x3727c5ac, v4
	v_cvt_pk_bf16_f32 v4, 0, v4
	v_sqrt_f32 v4, v4
	s_nop 0
	v_cvt_pk_bf16_f32 v4, 0, v4
	v_rcp_f32 v4, v4
	v_lshlrev_b32 v128, 16, v7
	v_and_b32 v129, 0xffff0000, v7
	v_pk_add_f32 v[128:129], v[128:129], v[2:3] op_sel_hi:[1,0]
	v_cvt_pk_bf16_f32 v128, 0, v128
	v_cvt_pk_bf16_f32 v129, 0, v129
	v_pk_mul_f32 v[128:129], v[128:129], v[4:5] op_sel_hi:[1,0]
	v_cvt_pk_bf16_f32 v128, 0, v128
	v_cvt_pk_bf16_f32 v129, 0, v129
	v_mov_b32 v106, 0
	v_mov_b32 v107, 0
	v_mov_b32 v108, 0
	v_mov_b32 v109, 0
	v_mov_b32 v110, 0
	v_mov_b32 v111, 0
	v_mov_b32 v112, 0
	v_mov_b32 v113, 0
	v_mov_b32 v114, 0
	v_mov_b32 v115, 0
	v_mov_b32 v116, 0
	v_mov_b32 v117, 0
	v_mov_b32 v118, 0
	v_mov_b32 v119, 0
	v_mov_b32 v120, 0
	v_mov_b32 v121, 0
	v_lshlrev_b32 v6, 2, v8
	v_lshl_add_u32 v6, v11, 8, v6
	v_lshlrev_b32 v1, 5, v10
	v_lshl_add_u32 v1, v12, 4, v1
	v_lshl_add_u32 v1, v13, 12, v1
	s_lshl_b32 s62, s36, 11
	s_add_u32 s63, s62, 16384
	s_waitcnt vmcnt(0)
	v_perm_b32 v104, v44, v40, s69
	v_perm_b32 v44, v44, v40, s70
	v_perm_b32 v40, v45, v41, s69
	v_perm_b32 v45, v45, v41, s70
	v_perm_b32 v41, v46, v42, s69
	v_perm_b32 v46, v46, v42, s70
	v_perm_b32 v42, v47, v43, s69
	v_perm_b32 v47, v47, v43, s70
	v_perm_b32 v43, v52, v48, s69
	v_perm_b32 v52, v52, v48, s70
	v_perm_b32 v48, v53, v49, s69
	v_perm_b32 v53, v53, v49, s70
	v_perm_b32 v49, v54, v50, s69
	v_perm_b32 v54, v54, v50, s70
	v_perm_b32 v50, v55, v51, s69
	v_perm_b32 v55, v55, v51, s70
	v_perm_b32 v51, v60, v56, s69
	v_perm_b32 v60, v60, v56, s70
	v_perm_b32 v56, v61, v57, s69
	v_perm_b32 v61, v61, v57, s70
	v_perm_b32 v57, v62, v58, s69
	v_perm_b32 v62, v62, v58, s70
	v_perm_b32 v58, v63, v59, s69
	v_perm_b32 v63, v63, v59, s70
	v_perm_b32 v59, v68, v64, s69
	v_perm_b32 v68, v68, v64, s70
	v_perm_b32 v64, v69, v65, s69
	v_perm_b32 v69, v69, v65, s70
	v_perm_b32 v65, v70, v66, s69
	v_perm_b32 v70, v70, v66, s70
	v_perm_b32 v66, v71, v67, s69
	v_perm_b32 v71, v71, v67, s70
	v_perm_b32 v67, v76, v72, s69
	v_perm_b32 v76, v76, v72, s70
	v_perm_b32 v72, v77, v73, s69
	v_perm_b32 v77, v77, v73, s70
	v_perm_b32 v73, v78, v74, s69
	v_perm_b32 v78, v78, v74, s70
	v_perm_b32 v74, v79, v75, s69
	v_perm_b32 v79, v79, v75, s70
	v_perm_b32 v75, v84, v80, s69
	v_perm_b32 v84, v84, v80, s70
	v_perm_b32 v80, v85, v81, s69
	v_perm_b32 v85, v85, v81, s70
	v_perm_b32 v81, v86, v82, s69
	v_perm_b32 v86, v86, v82, s70
	v_perm_b32 v82, v87, v83, s69
	v_perm_b32 v87, v87, v83, s70
	v_perm_b32 v83, v92, v88, s69
	v_perm_b32 v92, v92, v88, s70
	v_perm_b32 v88, v93, v89, s69
	v_perm_b32 v93, v93, v89, s70
	v_perm_b32 v89, v94, v90, s69
	v_perm_b32 v94, v94, v90, s70
	v_perm_b32 v90, v95, v91, s69
	v_perm_b32 v95, v95, v91, s70
	v_perm_b32 v91, v100, v96, s69
	v_perm_b32 v100, v100, v96, s70
	v_perm_b32 v96, v101, v97, s69
	v_perm_b32 v101, v101, v97, s70
	v_perm_b32 v97, v102, v98, s69
	v_perm_b32 v102, v102, v98, s70
	v_perm_b32 v98, v103, v99, s69
	v_perm_b32 v103, v103, v99, s70
	s_mov_b32 s68, 0
	v_mov_b32 v15, 0
	s_mov_b64 exec, 1
L_go:
	buffer_load_dword v14, v15, s[48:51], 0 offen offset:128 sc1
	s_waitcnt vmcnt(0)
	v_cmp_eq_u32 vcc, 0, v14
	s_cbranch_vccz L_go_d
	s_sleep 8
	s_add_u32 s68, s68, 1
	s_cmp_lt_u32 s68, 131072
	s_cbranch_scc1 L_go
L_go_d:
	s_mov_b64 exec, -1
	buffer_load_dwordx2 v[130:131], v6, s[44:47], s63 offen offset:0 sc1
	buffer_load_dwordx2 v[132:133], v6, s[44:47], s63 offen offset:512 sc1
	buffer_load_dwordx2 v[134:135], v6, s[44:47], s63 offen offset:1024 sc1
	buffer_load_dwordx2 v[136:137], v6, s[44:47], s63 offen offset:1536 sc1
	buffer_load_dwordx2 v[138:139], v6, s[44:47], s62 offen offset:0 sc1
	buffer_load_dwordx2 v[140:141], v6, s[44:47], s62 offen offset:512 sc1
	buffer_load_dwordx2 v[142:143], v6, s[44:47], s62 offen offset:1024 sc1
	buffer_load_dwordx2 v[144:145], v6, s[44:47], s62 offen offset:1536 sc1
	s_lshl_b32 s60, s34, 13
	s_lshl_b32 s61, s36, 9
	s_add_u32 s61, s61, s60
	s_add_u32 s61, s61, 65536
	s_lshl_b32 s62, s35, 12
	s_add_u32 s60, s60, s62
	s_add_u32 s60, s60, 65536
	s_waitcnt vmcnt(4)
	v_pk_add_f32 v[130:131], v[130:131], v[132:133]
	v_pk_add_f32 v[134:135], v[134:135], v[136:137]
	v_pk_add_f32 v[130:131], v[130:131], v[134:135]
	v_cvt_pk_bf16_f32 v130, 0, v130
	v_cvt_pk_bf16_f32 v131, 0, v131
	v_add_f32 v130, 1.0, v130
	v_add_f32 v131, 1.0, v131
	v_cvt_pk_bf16_f32 v130, 0, v130
	v_cvt_pk_bf16_f32 v131, 0, v131
	v_pk_mul_f32 v[128:129], v[128:129], v[130:131]
	v_cvt_pk_bf16_f32 v128, 0, v128
	v_cvt_pk_bf16_f32 v129, 0, v129
	s_waitcnt vmcnt(0)
	v_pk_add_f32 v[138:139], v[138:139], v[140:141]
	v_pk_add_f32 v[142:143], v[142:143], v[144:145]
	v_pk_add_f32 v[138:139], v[138:139], v[142:143]
	v_cvt_pk_bf16_f32 v138, 0, v138
	v_cvt_pk_bf16_f32 v139, 0, v139
	v_pk_add_f32 v[128:129], v[128:129], v[138:139]
	v_cvt_pk_bf16_f32 v16, v128, v129
	s_nop 1
	v_mov_b32_dpp v24, v16 row_newbcast:0 row_mask:0xf bank_mask:0xf
	v_mov_b32_dpp v32, v16 row_newbcast:1 row_mask:0xf bank_mask:0xf
	v_mov_b32_dpp v25, v16 row_newbcast:2 row_mask:0xf bank_mask:0xf
	v_mov_b32_dpp v33, v16 row_newbcast:3 row_mask:0xf bank_mask:0xf
	v_mov_b32_dpp v26, v16 row_newbcast:4 row_mask:0xf bank_mask:0xf
	v_mov_b32_dpp v34, v16 row_newbcast:5 row_mask:0xf bank_mask:0xf
	v_mov_b32_dpp v27, v16 row_newbcast:6 row_mask:0xf bank_mask:0xf
	v_mov_b32_dpp v35, v16 row_newbcast:7 row_mask:0xf bank_mask:0xf
	v_mov_b32_dpp v28, v16 row_newbcast:8 row_mask:0xf bank_mask:0xf
	v_mov_b32_dpp v36, v16 row_newbcast:9 row_mask:0xf bank_mask:0xf
	v_mov_b32_dpp v29, v16 row_newbcast:10 row_mask:0xf bank_mask:0xf
	v_mov_b32_dpp v37, v16 row_newbcast:11 row_mask:0xf bank_mask:0xf
	v_mov_b32_dpp v30, v16 row_newbcast:12 row_mask:0xf bank_mask:0xf
	v_mov_b32_dpp v38, v16 row_newbcast:13 row_mask:0xf bank_mask:0xf
	v_mov_b32_dpp v31, v16 row_newbcast:14 row_mask:0xf bank_mask:0xf
	v_mov_b32_dpp v39, v16 row_newbcast:15 row_mask:0xf bank_mask:0xf
	v_dot2c_f32_bf16 v106, v24, v104
	v_dot2c_f32_bf16 v114, v32, v104
	v_dot2c_f32_bf16 v107, v24, v44
	v_dot2c_f32_bf16 v115, v32, v44
	v_dot2c_f32_bf16 v108, v24, v40
	v_dot2c_f32_bf16 v116, v32, v40
	v_dot2c_f32_bf16 v109, v24, v45
	v_dot2c_f32_bf16 v117, v32, v45
	v_dot2c_f32_bf16 v110, v24, v41
	v_dot2c_f32_bf16 v118, v32, v41
	v_dot2c_f32_bf16 v111, v24, v46
	v_dot2c_f32_bf16 v119, v32, v46
	v_dot2c_f32_bf16 v112, v24, v42
	v_dot2c_f32_bf16 v120, v32, v42
	v_dot2c_f32_bf16 v113, v24, v47
	v_dot2c_f32_bf16 v121, v32, v47
	v_dot2c_f32_bf16 v106, v25, v43
	v_dot2c_f32_bf16 v114, v33, v43
	v_dot2c_f32_bf16 v107, v25, v52
	v_dot2c_f32_bf16 v115, v33, v52
	v_dot2c_f32_bf16 v108, v25, v48
	v_dot2c_f32_bf16 v116, v33, v48
	v_dot2c_f32_bf16 v109, v25, v53
	v_dot2c_f32_bf16 v117, v33, v53
	v_dot2c_f32_bf16 v110, v25, v49
	v_dot2c_f32_bf16 v118, v33, v49
	v_dot2c_f32_bf16 v111, v25, v54
	v_dot2c_f32_bf16 v119, v33, v54
	v_dot2c_f32_bf16 v112, v25, v50
	v_dot2c_f32_bf16 v120, v33, v50
	v_dot2c_f32_bf16 v113, v25, v55
	v_dot2c_f32_bf16 v121, v33, v55
	v_dot2c_f32_bf16 v106, v26, v51
	v_dot2c_f32_bf16 v114, v34, v51
	v_dot2c_f32_bf16 v107, v26, v60
	v_dot2c_f32_bf16 v115, v34, v60
	v_dot2c_f32_bf16 v108, v26, v56
	v_dot2c_f32_bf16 v116, v34, v56
	v_dot2c_f32_bf16 v109, v26, v61
	v_dot2c_f32_bf16 v117, v34, v61
	v_dot2c_f32_bf16 v110, v26, v57
	v_dot2c_f32_bf16 v118, v34, v57
	v_dot2c_f32_bf16 v111, v26, v62
	v_dot2c_f32_bf16 v119, v34, v62
	v_dot2c_f32_bf16 v112, v26, v58
	v_dot2c_f32_bf16 v120, v34, v58
	v_dot2c_f32_bf16 v113, v26, v63
	v_dot2c_f32_bf16 v121, v34, v63
	v_dot2c_f32_bf16 v106, v27, v59
	v_dot2c_f32_bf16 v114, v35, v59
	v_dot2c_f32_bf16 v107, v27, v68
	v_dot2c_f32_bf16 v115, v35, v68
	v_dot2c_f32_bf16 v108, v27, v64
	v_dot2c_f32_bf16 v116, v35, v64
	v_dot2c_f32_bf16 v109, v27, v69
	v_dot2c_f32_bf16 v117, v35, v69
	v_dot2c_f32_bf16 v110, v27, v65
	v_dot2c_f32_bf16 v118, v35, v65
	v_dot2c_f32_bf16 v111, v27, v70
	v_dot2c_f32_bf16 v119, v35, v70
	v_dot2c_f32_bf16 v112, v27, v66
	v_dot2c_f32_bf16 v120, v35, v66
	v_dot2c_f32_bf16 v113, v27, v71
	v_dot2c_f32_bf16 v121, v35, v71
	v_dot2c_f32_bf16 v106, v28, v67
	v_dot2c_f32_bf16 v114, v36, v67
	v_dot2c_f32_bf16 v107, v28, v76
	v_dot2c_f32_bf16 v115, v36, v76
	v_dot2c_f32_bf16 v108, v28, v72
	v_dot2c_f32_bf16 v116, v36, v72
	v_dot2c_f32_bf16 v109, v28, v77
	v_dot2c_f32_bf16 v117, v36, v77
	v_dot2c_f32_bf16 v110, v28, v73
	v_dot2c_f32_bf16 v118, v36, v73
	v_dot2c_f32_bf16 v111, v28, v78
	v_dot2c_f32_bf16 v119, v36, v78
	v_dot2c_f32_bf16 v112, v28, v74
	v_dot2c_f32_bf16 v120, v36, v74
	v_dot2c_f32_bf16 v113, v28, v79
	v_dot2c_f32_bf16 v121, v36, v79
	v_dot2c_f32_bf16 v106, v29, v75
	v_dot2c_f32_bf16 v114, v37, v75
	v_dot2c_f32_bf16 v107, v29, v84
	v_dot2c_f32_bf16 v115, v37, v84
	v_dot2c_f32_bf16 v108, v29, v80
	v_dot2c_f32_bf16 v116, v37, v80
	v_dot2c_f32_bf16 v109, v29, v85
	v_dot2c_f32_bf16 v117, v37, v85
	v_dot2c_f32_bf16 v110, v29, v81
	v_dot2c_f32_bf16 v118, v37, v81
	v_dot2c_f32_bf16 v111, v29, v86
	v_dot2c_f32_bf16 v119, v37, v86
	v_dot2c_f32_bf16 v112, v29, v82
	v_dot2c_f32_bf16 v120, v37, v82
	v_dot2c_f32_bf16 v113, v29, v87
	v_dot2c_f32_bf16 v121, v37, v87
	v_dot2c_f32_bf16 v106, v30, v83
	v_dot2c_f32_bf16 v114, v38, v83
	v_dot2c_f32_bf16 v107, v30, v92
	v_dot2c_f32_bf16 v115, v38, v92
	v_dot2c_f32_bf16 v108, v30, v88
	v_dot2c_f32_bf16 v116, v38, v88
	v_dot2c_f32_bf16 v109, v30, v93
	v_dot2c_f32_bf16 v117, v38, v93
	v_dot2c_f32_bf16 v110, v30, v89
	v_dot2c_f32_bf16 v118, v38, v89
	v_dot2c_f32_bf16 v111, v30, v94
	v_dot2c_f32_bf16 v119, v38, v94
	v_dot2c_f32_bf16 v112, v30, v90
	v_dot2c_f32_bf16 v120, v38, v90
	v_dot2c_f32_bf16 v113, v30, v95
	v_dot2c_f32_bf16 v121, v38, v95
	v_dot2c_f32_bf16 v106, v31, v91
	v_dot2c_f32_bf16 v114, v39, v91
	v_dot2c_f32_bf16 v107, v31, v100
	v_dot2c_f32_bf16 v115, v39, v100
	v_dot2c_f32_bf16 v108, v31, v96
	v_dot2c_f32_bf16 v116, v39, v96
	v_dot2c_f32_bf16 v109, v31, v101
	v_dot2c_f32_bf16 v117, v39, v101
	v_dot2c_f32_bf16 v110, v31, v97
	v_dot2c_f32_bf16 v118, v39, v97
	v_dot2c_f32_bf16 v111, v31, v102
	v_dot2c_f32_bf16 v119, v39, v102
	v_dot2c_f32_bf16 v112, v31, v98
	v_dot2c_f32_bf16 v120, v39, v98
	v_dot2c_f32_bf16 v113, v31, v103
	v_dot2c_f32_bf16 v121, v39, v103
	v_permlane32_swap_b32 v106, v114
	v_permlane32_swap_b32 v107, v115
	v_permlane32_swap_b32 v108, v116
	v_permlane32_swap_b32 v109, v117
	v_permlane32_swap_b32 v110, v118
	v_permlane32_swap_b32 v111, v119
	v_permlane32_swap_b32 v112, v120
	v_permlane32_swap_b32 v113, v121
	v_add_f32 v106, v106, v114
	v_add_f32 v107, v107, v115
	v_add_f32 v108, v108, v116
	v_add_f32 v109, v109, v117
	v_add_f32 v110, v110, v118
	v_add_f32 v111, v111, v119
	v_add_f32 v112, v112, v120
	v_add_f32 v113, v113, v121
	v_permlane16_swap_b32 v106, v110
	v_permlane16_swap_b32 v107, v111
	v_permlane16_swap_b32 v108, v112
	v_permlane16_swap_b32 v109, v113
	v_add_f32 v106, v106, v110
	v_add_f32 v107, v107, v111
	v_add_f32 v108, v108, v112
	v_add_f32 v109, v109, v113
	buffer_store_dwordx4 v[106:109], v1, s[44:47], s61 offen sc1
	v_lshlrev_b32 v1, 4, v0
	v_and_b32 v2, 31, v0
	v_lshlrev_b32 v2, 3, v2
	v_lshl_add_u32 v2, v13, 2, v2
	s_waitcnt vmcnt(0)
	s_mov_b32 s68, 0
L_poll_24:
	buffer_load_dwordx4 v[128:131], v1, s[44:47], s60 offen offset:0 sc1
	buffer_load_dwordx4 v[132:135], v1, s[44:47], s60 offen offset:1024 sc1
	buffer_load_dwordx4 v[136:139], v1, s[44:47], s60 offen offset:2048 sc1
	buffer_load_dwordx4 v[140:143], v1, s[44:47], s60 offen offset:3072 sc1
	s_waitcnt vmcnt(0)
	v_max3_u32 v8, v128, v129, v130
	v_max3_u32 v8, v8, v131, v132
	v_max3_u32 v8, v8, v133, v134
	v_max3_u32 v8, v8, v135, v136
	v_max3_u32 v8, v8, v137, v138
	v_max3_u32 v8, v8, v139, v140
	v_max3_u32 v8, v8, v141, v142
	v_max_u32 v8, v8, v143
	v_cmpx_eq_u32 vcc, -1, v8
	s_cbranch_execz L_poll_24_d
	s_sleep 1
	s_add_u32 s68, s68, 1
	s_cmp_lt_u32 s68, 131072
	s_cbranch_scc1 L_poll_24
L_poll_24_d:
	s_mov_b64 exec, -1
	v_pk_add_f32 v[128:129], v[128:129], v[132:133]
	v_pk_add_f32 v[130:131], v[130:131], v[134:135]
	v_pk_add_f32 v[136:137], v[136:137], v[140:141]
	v_pk_add_f32 v[138:139], v[138:139], v[142:143]
	v_pk_add_f32 v[128:129], v[128:129], v[136:137]
	v_pk_add_f32 v[130:131], v[130:131], v[138:139]
	s_nop 1
	v_permlane32_swap_b32 v128, v130
	v_permlane32_swap_b32 v129, v131
	v_add_f32 v128, v128, v130
	v_add_f32 v129, v129, v131
	v_cvt_pk_bf16_f32 v3, v128, v129
	ds_write_b32 v2, v3 offset:0
	v_mov_b32 v14, 1
	v_mov_b32 v15, 0
	ds_write_b32 v15, v14 offset:3120
	s_cmp_lt_u32 s38, 224
	s_cbranch_scc1 L_norm
	s_sub_u32 s62, s38, 208
	s_mov_b32 s63, 0
	v_mov_b32 v106, 0
	v_mov_b32 v107, 0
	v_mov_b32 v108, 0
	v_mov_b32 v109, 0
	v_mov_b32 v110, 0
	v_mov_b32 v111, 0
	v_mov_b32 v112, 0
	v_mov_b32 v113, 0
	v_mov_b32 v114, 0
	v_mov_b32 v115, 0
	v_mov_b32 v116, 0
	v_mov_b32 v117, 0
	v_mov_b32 v118, 0
	v_mov_b32 v119, 0
	v_mov_b32 v120, 0
	v_mov_b32 v121, 0
L_bgA_loop:
	s_call_b64 s[42:43], L_modload
	s_waitcnt vmcnt(16)
	v_lshlrev_b32 v128, 16, v16
	v_and_b32 v129, 0xffff0000, v16
	v_lshlrev_b32 v130, 16, v17
	v_and_b32 v131, 0xffff0000, v17
	v_lshlrev_b32 v132, 16, v18
	v_and_b32 v133, 0xffff0000, v18
	v_lshlrev_b32 v134, 16, v19
	v_and_b32 v135, 0xffff0000, v19
	v_lshlrev_b32 v136, 16, v20
	v_and_b32 v137, 0xffff0000, v20
	v_lshlrev_b32 v138, 16, v21
	v_and_b32 v139, 0xffff0000, v21
	v_lshlrev_b32 v140, 16, v22
	v_and_b32 v141, 0xffff0000, v22
	v_lshlrev_b32 v142, 16, v23
	v_and_b32 v143, 0xffff0000, v23
	v_mul_f32 v144, 0xbfb8aa3b, v128
	v_mul_f32 v145, 0xbfb8aa3b, v129
	v_mul_f32 v146, 0xbfb8aa3b, v130
	v_mul_f32 v147, 0xbfb8aa3b, v131
	v_mul_f32 v148, 0xbfb8aa3b, v132
	v_mul_f32 v149, 0xbfb8aa3b, v133
	v_mul_f32 v150, 0xbfb8aa3b, v134
	v_mul_f32 v151, 0xbfb8aa3b, v135
	v_mul_f32 v152, 0xbfb8aa3b, v136
	v_mul_f32 v153, 0xbfb8aa3b, v137
	v_mul_f32 v154, 0xbfb8aa3b, v138
	v_mul_f32 v155, 0xbfb8aa3b, v139
	v_mul_f32 v156, 0xbfb8aa3b, v140
	v_mul_f32 v157, 0xbfb8aa3b, v141
	v_mul_f32 v158, 0xbfb8aa3b, v142
	v_mul_f32 v159, 0xbfb8aa3b, v143
	v_exp_f32 v144, v144
	v_exp_f32 v145, v145
	v_exp_f32 v146, v146
	v_exp_f32 v147, v147
	v_exp_f32 v148, v148
	v_exp_f32 v149, v149
	v_exp_f32 v150, v150
	v_exp_f32 v151, v151
	v_exp_f32 v152, v152
	v_exp_f32 v153, v153
	v_exp_f32 v154, v154
	v_exp_f32 v155, v155
	v_exp_f32 v156, v156
	v_exp_f32 v157, v157
	v_exp_f32 v158, v158
	v_exp_f32 v159, v159
	v_add_f32 v144, 1.0, v144
	v_add_f32 v145, 1.0, v145
	v_add_f32 v146, 1.0, v146
	v_add_f32 v147, 1.0, v147
	v_add_f32 v148, 1.0, v148
	v_add_f32 v149, 1.0, v149
	v_add_f32 v150, 1.0, v150
	v_add_f32 v151, 1.0, v151
	v_add_f32 v152, 1.0, v152
	v_add_f32 v153, 1.0, v153
	v_add_f32 v154, 1.0, v154
	v_add_f32 v155, 1.0, v155
	v_add_f32 v156, 1.0, v156
	v_add_f32 v157, 1.0, v157
	v_add_f32 v158, 1.0, v158
	v_add_f32 v159, 1.0, v159
	v_rcp_f32 v144, v144
	v_rcp_f32 v145, v145
	v_rcp_f32 v146, v146
	v_rcp_f32 v147, v147
	v_rcp_f32 v148, v148
	v_rcp_f32 v149, v149
	v_rcp_f32 v150, v150
	v_rcp_f32 v151, v151
	v_rcp_f32 v152, v152
	v_rcp_f32 v153, v153
	v_rcp_f32 v154, v154
	v_rcp_f32 v155, v155
	v_rcp_f32 v156, v156
	v_rcp_f32 v157, v157
	v_rcp_f32 v158, v158
	v_rcp_f32 v159, v159
	v_pk_mul_f32 v[128:129], v[128:129], v[144:145]
	v_pk_mul_f32 v[130:131], v[130:131], v[146:147]
	v_pk_mul_f32 v[132:133], v[132:133], v[148:149]
	v_pk_mul_f32 v[134:135], v[134:135], v[150:151]
	v_pk_mul_f32 v[136:137], v[136:137], v[152:153]
	v_pk_mul_f32 v[138:139], v[138:139], v[154:155]
	v_pk_mul_f32 v[140:141], v[140:141], v[156:157]
	v_pk_mul_f32 v[142:143], v[142:143], v[158:159]
	v_cvt_pk_bf16_f32 v16, v128, v129
	v_cvt_pk_bf16_f32 v17, v130, v131
	v_cvt_pk_bf16_f32 v18, v132, v133
	v_cvt_pk_bf16_f32 v19, v134, v135
	v_cvt_pk_bf16_f32 v20, v136, v137
	v_cvt_pk_bf16_f32 v21, v138, v139
	v_cvt_pk_bf16_f32 v22, v140, v141
	v_cvt_pk_bf16_f32 v23, v142, v143
	v_mov_b32_dpp v24, v16 quad_perm:[0,0,2,2] row_mask:0xf bank_mask:0xf
	v_mov_b32_dpp v32, v16 quad_perm:[1,1,3,3] row_mask:0xf bank_mask:0xf
	v_mov_b32_dpp v25, v17 quad_perm:[0,0,2,2] row_mask:0xf bank_mask:0xf
	v_mov_b32_dpp v33, v17 quad_perm:[1,1,3,3] row_mask:0xf bank_mask:0xf
	v_mov_b32_dpp v26, v18 quad_perm:[0,0,2,2] row_mask:0xf bank_mask:0xf
	v_mov_b32_dpp v34, v18 quad_perm:[1,1,3,3] row_mask:0xf bank_mask:0xf
	v_mov_b32_dpp v27, v19 quad_perm:[0,0,2,2] row_mask:0xf bank_mask:0xf
	v_mov_b32_dpp v35, v19 quad_perm:[1,1,3,3] row_mask:0xf bank_mask:0xf
	v_mov_b32_dpp v28, v20 quad_perm:[0,0,2,2] row_mask:0xf bank_mask:0xf
	v_mov_b32_dpp v36, v20 quad_perm:[1,1,3,3] row_mask:0xf bank_mask:0xf
	v_mov_b32_dpp v29, v21 quad_perm:[0,0,2,2] row_mask:0xf bank_mask:0xf
	v_mov_b32_dpp v37, v21 quad_perm:[1,1,3,3] row_mask:0xf bank_mask:0xf
	v_mov_b32_dpp v30, v22 quad_perm:[0,0,2,2] row_mask:0xf bank_mask:0xf
	v_mov_b32_dpp v38, v22 quad_perm:[1,1,3,3] row_mask:0xf bank_mask:0xf
	v_mov_b32_dpp v31, v23 quad_perm:[0,0,2,2] row_mask:0xf bank_mask:0xf
	v_mov_b32_dpp v39, v23 quad_perm:[1,1,3,3] row_mask:0xf bank_mask:0xf
	s_waitcnt vmcnt(14)
	v_perm_b32 v104, v44, v40, s69
	v_perm_b32 v44, v44, v40, s70
	v_perm_b32 v40, v45, v41, s69
	v_perm_b32 v45, v45, v41, s70
	v_perm_b32 v41, v46, v42, s69
	v_perm_b32 v46, v46, v42, s70
	v_perm_b32 v42, v47, v43, s69
	v_perm_b32 v47, v47, v43, s70
	v_dot2c_f32_bf16 v106, v24, v104
	v_dot2c_f32_bf16 v114, v32, v104
	v_dot2c_f32_bf16 v107, v24, v44
	v_dot2c_f32_bf16 v115, v32, v44
	v_dot2c_f32_bf16 v108, v24, v40
	v_dot2c_f32_bf16 v116, v32, v40
	v_dot2c_f32_bf16 v109, v24, v45
	v_dot2c_f32_bf16 v117, v32, v45
	v_dot2c_f32_bf16 v110, v24, v41
	v_dot2c_f32_bf16 v118, v32, v41
	v_dot2c_f32_bf16 v111, v24, v46
	v_dot2c_f32_bf16 v119, v32, v46
	v_dot2c_f32_bf16 v112, v24, v42
	v_dot2c_f32_bf16 v120, v32, v42
	v_dot2c_f32_bf16 v113, v24, v47
	v_dot2c_f32_bf16 v121, v32, v47
	s_waitcnt vmcnt(12)
	v_perm_b32 v43, v52, v48, s69
	v_perm_b32 v52, v52, v48, s70
	v_perm_b32 v48, v53, v49, s69
	v_perm_b32 v53, v53, v49, s70
	v_perm_b32 v49, v54, v50, s69
	v_perm_b32 v54, v54, v50, s70
	v_perm_b32 v50, v55, v51, s69
	v_perm_b32 v55, v55, v51, s70
	v_dot2c_f32_bf16 v106, v25, v43
	v_dot2c_f32_bf16 v114, v33, v43
	v_dot2c_f32_bf16 v107, v25, v52
	v_dot2c_f32_bf16 v115, v33, v52
	v_dot2c_f32_bf16 v108, v25, v48
	v_dot2c_f32_bf16 v116, v33, v48
	v_dot2c_f32_bf16 v109, v25, v53
	v_dot2c_f32_bf16 v117, v33, v53
	v_dot2c_f32_bf16 v110, v25, v49
	v_dot2c_f32_bf16 v118, v33, v49
	v_dot2c_f32_bf16 v111, v25, v54
	v_dot2c_f32_bf16 v119, v33, v54
	v_dot2c_f32_bf16 v112, v25, v50
	v_dot2c_f32_bf16 v120, v33, v50
	v_dot2c_f32_bf16 v113, v25, v55
	v_dot2c_f32_bf16 v121, v33, v55
	s_waitcnt vmcnt(10)
	v_perm_b32 v51, v60, v56, s69
	v_perm_b32 v60, v60, v56, s70
	v_perm_b32 v56, v61, v57, s69
	v_perm_b32 v61, v61, v57, s70
	v_perm_b32 v57, v62, v58, s69
	v_perm_b32 v62, v62, v58, s70
	v_perm_b32 v58, v63, v59, s69
	v_perm_b32 v63, v63, v59, s70
	v_dot2c_f32_bf16 v106, v26, v51
	v_dot2c_f32_bf16 v114, v34, v51
	v_dot2c_f32_bf16 v107, v26, v60
	v_dot2c_f32_bf16 v115, v34, v60
	v_dot2c_f32_bf16 v108, v26, v56
	v_dot2c_f32_bf16 v116, v34, v56
	v_dot2c_f32_bf16 v109, v26, v61
	v_dot2c_f32_bf16 v117, v34, v61
	v_dot2c_f32_bf16 v110, v26, v57
	v_dot2c_f32_bf16 v118, v34, v57
	v_dot2c_f32_bf16 v111, v26, v62
	v_dot2c_f32_bf16 v119, v34, v62
	v_dot2c_f32_bf16 v112, v26, v58
	v_dot2c_f32_bf16 v120, v34, v58
	v_dot2c_f32_bf16 v113, v26, v63
	v_dot2c_f32_bf16 v121, v34, v63
	s_waitcnt vmcnt(8)
	v_perm_b32 v59, v68, v64, s69
	v_perm_b32 v68, v68, v64, s70
	v_perm_b32 v64, v69, v65, s69
	v_perm_b32 v69, v69, v65, s70
	v_perm_b32 v65, v70, v66, s69
	v_perm_b32 v70, v70, v66, s70
	v_perm_b32 v66, v71, v67, s69
	v_perm_b32 v71, v71, v67, s70
	v_dot2c_f32_bf16 v106, v27, v59
	v_dot2c_f32_bf16 v114, v35, v59
	v_dot2c_f32_bf16 v107, v27, v68
	v_dot2c_f32_bf16 v115, v35, v68
	v_dot2c_f32_bf16 v108, v27, v64
	v_dot2c_f32_bf16 v116, v35, v64
	v_dot2c_f32_bf16 v109, v27, v69
	v_dot2c_f32_bf16 v117, v35, v69
	v_dot2c_f32_bf16 v110, v27, v65
	v_dot2c_f32_bf16 v118, v35, v65
	v_dot2c_f32_bf16 v111, v27, v70
	v_dot2c_f32_bf16 v119, v35, v70
	v_dot2c_f32_bf16 v112, v27, v66
	v_dot2c_f32_bf16 v120, v35, v66
	v_dot2c_f32_bf16 v113, v27, v71
	v_dot2c_f32_bf16 v121, v35, v71
	s_waitcnt vmcnt(6)
	v_perm_b32 v67, v76, v72, s69
	v_perm_b32 v76, v76, v72, s70
	v_perm_b32 v72, v77, v73, s69
	v_perm_b32 v77, v77, v73, s70
	v_perm_b32 v73, v78, v74, s69
	v_perm_b32 v78, v78, v74, s70
	v_perm_b32 v74, v79, v75, s69
	v_perm_b32 v79, v79, v75, s70
	v_dot2c_f32_bf16 v106, v28, v67
	v_dot2c_f32_bf16 v114, v36, v67
	v_dot2c_f32_bf16 v107, v28, v76
	v_dot2c_f32_bf16 v115, v36, v76
	v_dot2c_f32_bf16 v108, v28, v72
	v_dot2c_f32_bf16 v116, v36, v72
	v_dot2c_f32_bf16 v109, v28, v77
	v_dot2c_f32_bf16 v117, v36, v77
	v_dot2c_f32_bf16 v110, v28, v73
	v_dot2c_f32_bf16 v118, v36, v73
	v_dot2c_f32_bf16 v111, v28, v78
	v_dot2c_f32_bf16 v119, v36, v78
	v_dot2c_f32_bf16 v112, v28, v74
	v_dot2c_f32_bf16 v120, v36, v74
	v_dot2c_f32_bf16 v113, v28, v79
	v_dot2c_f32_bf16 v121, v36, v79
	s_waitcnt vmcnt(4)
	v_perm_b32 v75, v84, v80, s69
	v_perm_b32 v84, v84, v80, s70
	v_perm_b32 v80, v85, v81, s69
	v_perm_b32 v85, v85, v81, s70
	v_perm_b32 v81, v86, v82, s69
	v_perm_b32 v86, v86, v82, s70
	v_perm_b32 v82, v87, v83, s69
	v_perm_b32 v87, v87, v83, s70
	v_dot2c_f32_bf16 v106, v29, v75
	v_dot2c_f32_bf16 v114, v37, v75
	v_dot2c_f32_bf16 v107, v29, v84
	v_dot2c_f32_bf16 v115, v37, v84
	v_dot2c_f32_bf16 v108, v29, v80
	v_dot2c_f32_bf16 v116, v37, v80
	v_dot2c_f32_bf16 v109, v29, v85
	v_dot2c_f32_bf16 v117, v37, v85
	v_dot2c_f32_bf16 v110, v29, v81
	v_dot2c_f32_bf16 v118, v37, v81
	v_dot2c_f32_bf16 v111, v29, v86
	v_dot2c_f32_bf16 v119, v37, v86
	v_dot2c_f32_bf16 v112, v29, v82
	v_dot2c_f32_bf16 v120, v37, v82
	v_dot2c_f32_bf16 v113, v29, v87
	v_dot2c_f32_bf16 v121, v37, v87
	s_waitcnt vmcnt(2)
	v_perm_b32 v83, v92, v88, s69
	v_perm_b32 v92, v92, v88, s70
	v_perm_b32 v88, v93, v89, s69
	v_perm_b32 v93, v93, v89, s70
	v_perm_b32 v89, v94, v90, s69
	v_perm_b32 v94, v94, v90, s70
	v_perm_b32 v90, v95, v91, s69
	v_perm_b32 v95, v95, v91, s70
	v_dot2c_f32_bf16 v106, v30, v83
	v_dot2c_f32_bf16 v114, v38, v83
	v_dot2c_f32_bf16 v107, v30, v92
	v_dot2c_f32_bf16 v115, v38, v92
	v_dot2c_f32_bf16 v108, v30, v88
	v_dot2c_f32_bf16 v116, v38, v88
	v_dot2c_f32_bf16 v109, v30, v93
	v_dot2c_f32_bf16 v117, v38, v93
	v_dot2c_f32_bf16 v110, v30, v89
	v_dot2c_f32_bf16 v118, v38, v89
	v_dot2c_f32_bf16 v111, v30, v94
	v_dot2c_f32_bf16 v119, v38, v94
	v_dot2c_f32_bf16 v112, v30, v90
	v_dot2c_f32_bf16 v120, v38, v90
	v_dot2c_f32_bf16 v113, v30, v95
	v_dot2c_f32_bf16 v121, v38, v95
	s_waitcnt vmcnt(0)
	v_perm_b32 v91, v100, v96, s69
	v_perm_b32 v100, v100, v96, s70
	v_perm_b32 v96, v101, v97, s69
	v_perm_b32 v101, v101, v97, s70
	v_perm_b32 v97, v102, v98, s69
	v_perm_b32 v102, v102, v98, s70
	v_perm_b32 v98, v103, v99, s69
	v_perm_b32 v103, v103, v99, s70
	v_dot2c_f32_bf16 v106, v31, v91
	v_dot2c_f32_bf16 v114, v39, v91
	v_dot2c_f32_bf16 v107, v31, v100
	v_dot2c_f32_bf16 v115, v39, v100
	v_dot2c_f32_bf16 v108, v31, v96
	v_dot2c_f32_bf16 v116, v39, v96
	v_dot2c_f32_bf16 v109, v31, v101
	v_dot2c_f32_bf16 v117, v39, v101
	v_dot2c_f32_bf16 v110, v31, v97
	v_dot2c_f32_bf16 v118, v39, v97
	v_dot2c_f32_bf16 v111, v31, v102
	v_dot2c_f32_bf16 v119, v39, v102
	v_dot2c_f32_bf16 v112, v31, v98
	v_dot2c_f32_bf16 v120, v39, v98
	v_dot2c_f32_bf16 v113, v31, v103
	v_dot2c_f32_bf16 v121, v39, v103
	s_add_u32 s63, s63, 1
	s_cmp_lt_u32 s63, 4
	s_cbranch_scc1 L_bgA_loop
	v_permlane32_swap_b32 v106, v114
	v_permlane32_swap_b32 v107, v115
	v_permlane32_swap_b32 v108, v116
	v_permlane32_swap_b32 v109, v117
	v_permlane32_swap_b32 v110, v118
	v_permlane32_swap_b32 v111, v119
	v_permlane32_swap_b32 v112, v120
	v_permlane32_swap_b32 v113, v121
	v_add_f32 v106, v106, v114
	v_add_f32 v107, v107, v115
	v_add_f32 v108, v108, v116
	v_add_f32 v109, v109, v117
	v_add_f32 v110, v110, v118
	v_add_f32 v111, v111, v119
	v_add_f32 v112, v112, v120
	v_add_f32 v113, v113, v121
	v_permlane16_swap_b32 v106, v110
	v_permlane16_swap_b32 v107, v111
	v_permlane16_swap_b32 v108, v112
	v_permlane16_swap_b32 v109, v113
	v_add_f32 v106, v106, v110
	v_add_f32 v107, v107, v111
	v_add_f32 v108, v108, v112
	v_add_f32 v109, v109, v113
	v_add_f32_dpp v106, v106, v106 row_ror:8 row_mask:0xf bank_mask:0xf
	v_add_f32_dpp v107, v107, v107 row_ror:8 row_mask:0xf bank_mask:0xf
	v_add_f32_dpp v108, v108, v108 row_ror:8 row_mask:0xf bank_mask:0xf
	v_add_f32_dpp v109, v109, v109 row_ror:8 row_mask:0xf bank_mask:0xf
	s_lshr_b32 s61, s62, 3
	s_cmp_eq_u32 s61, 4
	s_cselect_b32 s63, 1.0, 0
	v_cvt_pk_bf16_f32 v106, 0, v106
	v_cvt_pk_bf16_f32 v107, 0, v107
	v_cvt_pk_bf16_f32 v108, 0, v108
	v_cvt_pk_bf16_f32 v109, 0, v109
	v_add_f32 v106, s63, v106
	v_add_f32 v107, s63, v107
	v_add_f32 v108, s63, v108
	v_add_f32 v109, s63, v109
	v_cvt_pk_bf16_f32 v106, 0, v106
	v_cvt_pk_bf16_f32 v107, 0, v107
	v_cvt_pk_bf16_f32 v108, 0, v108
	v_cvt_pk_bf16_f32 v109, 0, v109
	v_lshlrev_b32 v9, 4, v0
	s_mov_b32 s60, 32768
	s_mov_b32 s68, 0
L_poll_25:
	buffer_load_dwordx4 v[4:7], v9, s[44:47], s60 offen sc1
	s_waitcnt vmcnt(0)
	v_max3_u32 v8, v4, v5, v6
	v_max_u32 v8, v8, v7
	v_cmpx_eq_u32 vcc, -1, v8
	s_cbranch_execz L_poll_25_d
	s_sleep 16
	s_add_u32 s68, s68, 1
	s_cmp_lt_u32 s68, 131072
	s_cbranch_scc1 L_poll_25
L_poll_25_d:
	s_mov_b64 exec, -1
	v_and_b32 v1, 7, v0
	v_lshlrev_b32 v1, 5, v1
	v_lshl_add_u32 v1, v12, 4, v1
	v_lshl_add_u32 v1, v13, 13, v1
	s_lshl_b32 s60, s62, 8
	s_add_u32 s60, s60, 1540096
	s_mov_b32 exec_lo, 0xff00ff
	s_mov_b32 exec_hi, 0xff00ff
	buffer_store_dwordx4 v[106:109], v1, s[44:47], s60 offen sc1
	s_mov_b64 exec, -1
	s_waitcnt vmcnt(0)
L_norm:
	v_and_b32 v10, 3, v0
	v_lshlrev_b32 v10, 2, v10
	s_mov_b32 s68, 0
L_prog_26:
	ds_read_b32 v14, v10 offset:3072
	s_waitcnt lgkmcnt(0)
	v_lshrrev_b32 v14, 12, v14
	s_nop 1
	v_min_u32_dpp v14, v14, v14 quad_perm:[1,0,3,2] row_mask:0xf bank_mask:0xf
	s_nop 1
	v_min_u32_dpp v14, v14, v14 quad_perm:[2,3,0,1] row_mask:0xf bank_mask:0xf
	s_nop 0
	v_readfirstlane_b32 s64, v14
	s_cmp_ge_u32 s64, 259
	s_cbranch_scc1 L_prog_26_d
	s_sleep 4
	s_add_u32 s68, s68, 1
	s_cmp_lt_u32 s68, 131072
	s_cbranch_scc1 L_prog_26
L_prog_26_d:
	v_mov_b32 v15, 0
	v_lshlrev_b32 v1, 4, v0
	ds_read_b128 v[4:7], v15 offset:2304
	ds_read_b32 v20, v10 offset:2304
	ds_read_b32 v14, v15 offset:3112
	ds_read_b128 v[128:131], v1 offset:4096
	ds_read_b128 v[132:135], v1 offset:5120
	ds_read_b128 v[136:139], v1 offset:6144
	ds_read_b128 v[140:143], v1 offset:7168
	ds_read_b128 v[144:147], v1 offset:8192
	ds_read_b128 v[148:151], v1 offset:9216
	ds_read_b128 v[152:155], v1 offset:10240
	ds_read_b128 v[156:159], v1 offset:11264
	s_waitcnt lgkmcnt(0)
	ds_read_b128 v[160:163], v1 offset:12288
	ds_read_b128 v[164:167], v1 offset:13312
	ds_read_b128 v[168:171], v1 offset:14336
	ds_read_b128 v[172:175], v1 offset:15360
	ds_read_b128 v[176:179], v1 offset:16384
	ds_read_b128 v[180:183], v1 offset:17408
	ds_read_b128 v[184:187], v1 offset:18432
	ds_read_b128 v[188:191], v1 offset:19456
	v_min3_f32 v8, v4, v5, v6
	v_min_f32 v8, v8, v7
	v_mov_b32 v16, 0
	v_mov_b32 v17, 0
	v_mov_b32 v18, 0
	v_mov_b32 v19, 0
	v_lshlrev_b32 v24, 16, v128
	v_and_b32 v25, 0xffff0000, v128
	v_lshlrev_b32 v26, 16, v129
	v_and_b32 v27, 0xffff0000, v129
	v_lshlrev_b32 v28, 16, v130
	v_and_b32 v29, 0xffff0000, v130
	v_lshlrev_b32 v30, 16, v131
	v_and_b32 v31, 0xffff0000, v131
	v_fmamk_f32 v24, v24, 0x3fb8aa3b, v8
	v_fmamk_f32 v25, v25, 0x3fb8aa3b, v8
	v_fmamk_f32 v26, v26, 0x3fb8aa3b, v8
	v_fmamk_f32 v27, v27, 0x3fb8aa3b, v8
	v_fmamk_f32 v28, v28, 0x3fb8aa3b, v8
	v_fmamk_f32 v29, v29, 0x3fb8aa3b, v8
	v_fmamk_f32 v30, v30, 0x3fb8aa3b, v8
	v_fmamk_f32 v31, v31, 0x3fb8aa3b, v8
	v_exp_f32 v24, v24
	v_exp_f32 v25, v25
	v_exp_f32 v26, v26
	v_exp_f32 v27, v27
	v_exp_f32 v28, v28
	v_exp_f32 v29, v29
	v_exp_f32 v30, v30
	v_exp_f32 v31, v31
	v_pk_add_f32 v[16:17], v[16:17], v[24:25]
	v_pk_add_f32 v[18:19], v[18:19], v[26:27]
	v_pk_add_f32 v[16:17], v[16:17], v[28:29]
	v_pk_add_f32 v[18:19], v[18:19], v[30:31]
	v_lshlrev_b32 v24, 16, v132
	v_and_b32 v25, 0xffff0000, v132
	v_lshlrev_b32 v26, 16, v133
	v_and_b32 v27, 0xffff0000, v133
	v_lshlrev_b32 v28, 16, v134
	v_and_b32 v29, 0xffff0000, v134
	v_lshlrev_b32 v30, 16, v135
	v_and_b32 v31, 0xffff0000, v135
	v_fmamk_f32 v24, v24, 0x3fb8aa3b, v8
	v_fmamk_f32 v25, v25, 0x3fb8aa3b, v8
	v_fmamk_f32 v26, v26, 0x3fb8aa3b, v8
	v_fmamk_f32 v27, v27, 0x3fb8aa3b, v8
	v_fmamk_f32 v28, v28, 0x3fb8aa3b, v8
	v_fmamk_f32 v29, v29, 0x3fb8aa3b, v8
	v_fmamk_f32 v30, v30, 0x3fb8aa3b, v8
	v_fmamk_f32 v31, v31, 0x3fb8aa3b, v8
	v_exp_f32 v24, v24
	v_exp_f32 v25, v25
	v_exp_f32 v26, v26
	v_exp_f32 v27, v27
	v_exp_f32 v28, v28
	v_exp_f32 v29, v29
	v_exp_f32 v30, v30
	v_exp_f32 v31, v31
	v_pk_add_f32 v[16:17], v[16:17], v[24:25]
	v_pk_add_f32 v[18:19], v[18:19], v[26:27]
	v_pk_add_f32 v[16:17], v[16:17], v[28:29]
	v_pk_add_f32 v[18:19], v[18:19], v[30:31]
	v_lshlrev_b32 v24, 16, v136
	v_and_b32 v25, 0xffff0000, v136
	v_lshlrev_b32 v26, 16, v137
	v_and_b32 v27, 0xffff0000, v137
	v_lshlrev_b32 v28, 16, v138
	v_and_b32 v29, 0xffff0000, v138
	v_lshlrev_b32 v30, 16, v139
	v_and_b32 v31, 0xffff0000, v139
	v_fmamk_f32 v24, v24, 0x3fb8aa3b, v8
	v_fmamk_f32 v25, v25, 0x3fb8aa3b, v8
	v_fmamk_f32 v26, v26, 0x3fb8aa3b, v8
	v_fmamk_f32 v27, v27, 0x3fb8aa3b, v8
	v_fmamk_f32 v28, v28, 0x3fb8aa3b, v8
	v_fmamk_f32 v29, v29, 0x3fb8aa3b, v8
	v_fmamk_f32 v30, v30, 0x3fb8aa3b, v8
	v_fmamk_f32 v31, v31, 0x3fb8aa3b, v8
	v_exp_f32 v24, v24
	v_exp_f32 v25, v25
	v_exp_f32 v26, v26
	v_exp_f32 v27, v27
	v_exp_f32 v28, v28
	v_exp_f32 v29, v29
	v_exp_f32 v30, v30
	v_exp_f32 v31, v31
	v_pk_add_f32 v[16:17], v[16:17], v[24:25]
	v_pk_add_f32 v[18:19], v[18:19], v[26:27]
	v_pk_add_f32 v[16:17], v[16:17], v[28:29]
	v_pk_add_f32 v[18:19], v[18:19], v[30:31]
	v_lshlrev_b32 v24, 16, v140
	v_and_b32 v25, 0xffff0000, v140
	v_lshlrev_b32 v26, 16, v141
	v_and_b32 v27, 0xffff0000, v141
	v_lshlrev_b32 v28, 16, v142
	v_and_b32 v29, 0xffff0000, v142
	v_lshlrev_b32 v30, 16, v143
	v_and_b32 v31, 0xffff0000, v143
	v_fmamk_f32 v24, v24, 0x3fb8aa3b, v8
	v_fmamk_f32 v25, v25, 0x3fb8aa3b, v8
	v_fmamk_f32 v26, v26, 0x3fb8aa3b, v8
	v_fmamk_f32 v27, v27, 0x3fb8aa3b, v8
	v_fmamk_f32 v28, v28, 0x3fb8aa3b, v8
	v_fmamk_f32 v29, v29, 0x3fb8aa3b, v8
	v_fmamk_f32 v30, v30, 0x3fb8aa3b, v8
	v_fmamk_f32 v31, v31, 0x3fb8aa3b, v8
	v_exp_f32 v24, v24
	v_exp_f32 v25, v25
	v_exp_f32 v26, v26
	v_exp_f32 v27, v27
	v_exp_f32 v28, v28
	v_exp_f32 v29, v29
	v_exp_f32 v30, v30
	v_exp_f32 v31, v31
	v_pk_add_f32 v[16:17], v[16:17], v[24:25]
	v_pk_add_f32 v[18:19], v[18:19], v[26:27]
	v_pk_add_f32 v[16:17], v[16:17], v[28:29]
	v_pk_add_f32 v[18:19], v[18:19], v[30:31]
	v_lshlrev_b32 v24, 16, v144
	v_and_b32 v25, 0xffff0000, v144
	v_lshlrev_b32 v26, 16, v145
	v_and_b32 v27, 0xffff0000, v145
	v_lshlrev_b32 v28, 16, v146
	v_and_b32 v29, 0xffff0000, v146
	v_lshlrev_b32 v30, 16, v147
	v_and_b32 v31, 0xffff0000, v147
	v_fmamk_f32 v24, v24, 0x3fb8aa3b, v8
	v_fmamk_f32 v25, v25, 0x3fb8aa3b, v8
	v_fmamk_f32 v26, v26, 0x3fb8aa3b, v8
	v_fmamk_f32 v27, v27, 0x3fb8aa3b, v8
	v_fmamk_f32 v28, v28, 0x3fb8aa3b, v8
	v_fmamk_f32 v29, v29, 0x3fb8aa3b, v8
	v_fmamk_f32 v30, v30, 0x3fb8aa3b, v8
	v_fmamk_f32 v31, v31, 0x3fb8aa3b, v8
	v_exp_f32 v24, v24
	v_exp_f32 v25, v25
	v_exp_f32 v26, v26
	v_exp_f32 v27, v27
	v_exp_f32 v28, v28
	v_exp_f32 v29, v29
	v_exp_f32 v30, v30
	v_exp_f32 v31, v31
	v_pk_add_f32 v[16:17], v[16:17], v[24:25]
	v_pk_add_f32 v[18:19], v[18:19], v[26:27]
	v_pk_add_f32 v[16:17], v[16:17], v[28:29]
	v_pk_add_f32 v[18:19], v[18:19], v[30:31]
	v_lshlrev_b32 v24, 16, v148
	v_and_b32 v25, 0xffff0000, v148
	v_lshlrev_b32 v26, 16, v149
	v_and_b32 v27, 0xffff0000, v149
	v_lshlrev_b32 v28, 16, v150
	v_and_b32 v29, 0xffff0000, v150
	v_lshlrev_b32 v30, 16, v151
	v_and_b32 v31, 0xffff0000, v151
	v_fmamk_f32 v24, v24, 0x3fb8aa3b, v8
	v_fmamk_f32 v25, v25, 0x3fb8aa3b, v8
	v_fmamk_f32 v26, v26, 0x3fb8aa3b, v8
	v_fmamk_f32 v27, v27, 0x3fb8aa3b, v8
	v_fmamk_f32 v28, v28, 0x3fb8aa3b, v8
	v_fmamk_f32 v29, v29, 0x3fb8aa3b, v8
	v_fmamk_f32 v30, v30, 0x3fb8aa3b, v8
	v_fmamk_f32 v31, v31, 0x3fb8aa3b, v8
	v_exp_f32 v24, v24
	v_exp_f32 v25, v25
	v_exp_f32 v26, v26
	v_exp_f32 v27, v27
	v_exp_f32 v28, v28
	v_exp_f32 v29, v29
	v_exp_f32 v30, v30
	v_exp_f32 v31, v31
	v_pk_add_f32 v[16:17], v[16:17], v[24:25]
	v_pk_add_f32 v[18:19], v[18:19], v[26:27]
	v_pk_add_f32 v[16:17], v[16:17], v[28:29]
	v_pk_add_f32 v[18:19], v[18:19], v[30:31]
	v_lshlrev_b32 v24, 16, v152
	v_and_b32 v25, 0xffff0000, v152
	v_lshlrev_b32 v26, 16, v153
	v_and_b32 v27, 0xffff0000, v153
	v_lshlrev_b32 v28, 16, v154
	v_and_b32 v29, 0xffff0000, v154
	v_lshlrev_b32 v30, 16, v155
	v_and_b32 v31, 0xffff0000, v155
	v_fmamk_f32 v24, v24, 0x3fb8aa3b, v8
	v_fmamk_f32 v25, v25, 0x3fb8aa3b, v8
	v_fmamk_f32 v26, v26, 0x3fb8aa3b, v8
	v_fmamk_f32 v27, v27, 0x3fb8aa3b, v8
	v_fmamk_f32 v28, v28, 0x3fb8aa3b, v8
	v_fmamk_f32 v29, v29, 0x3fb8aa3b, v8
	v_fmamk_f32 v30, v30, 0x3fb8aa3b, v8
	v_fmamk_f32 v31, v31, 0x3fb8aa3b, v8
	v_exp_f32 v24, v24
	v_exp_f32 v25, v25
	v_exp_f32 v26, v26
	v_exp_f32 v27, v27
	v_exp_f32 v28, v28
	v_exp_f32 v29, v29
	v_exp_f32 v30, v30
	v_exp_f32 v31, v31
	v_pk_add_f32 v[16:17], v[16:17], v[24:25]
	v_pk_add_f32 v[18:19], v[18:19], v[26:27]
	v_pk_add_f32 v[16:17], v[16:17], v[28:29]
	v_pk_add_f32 v[18:19], v[18:19], v[30:31]
	v_lshlrev_b32 v24, 16, v156
	v_and_b32 v25, 0xffff0000, v156
	v_lshlrev_b32 v26, 16, v157
	v_and_b32 v27, 0xffff0000, v157
	v_lshlrev_b32 v28, 16, v158
	v_and_b32 v29, 0xffff0000, v158
	v_lshlrev_b32 v30, 16, v159
	v_and_b32 v31, 0xffff0000, v159
	v_fmamk_f32 v24, v24, 0x3fb8aa3b, v8
	v_fmamk_f32 v25, v25, 0x3fb8aa3b, v8
	v_fmamk_f32 v26, v26, 0x3fb8aa3b, v8
	v_fmamk_f32 v27, v27, 0x3fb8aa3b, v8
	v_fmamk_f32 v28, v28, 0x3fb8aa3b, v8
	v_fmamk_f32 v29, v29, 0x3fb8aa3b, v8
	v_fmamk_f32 v30, v30, 0x3fb8aa3b, v8
	v_fmamk_f32 v31, v31, 0x3fb8aa3b, v8
	v_exp_f32 v24, v24
	v_exp_f32 v25, v25
	v_exp_f32 v26, v26
	v_exp_f32 v27, v27
	v_exp_f32 v28, v28
	v_exp_f32 v29, v29
	v_exp_f32 v30, v30
	v_exp_f32 v31, v31
	v_pk_add_f32 v[16:17], v[16:17], v[24:25]
	v_pk_add_f32 v[18:19], v[18:19], v[26:27]
	v_pk_add_f32 v[16:17], v[16:17], v[28:29]
	v_pk_add_f32 v[18:19], v[18:19], v[30:31]
	s_waitcnt lgkmcnt(0)
	v_lshlrev_b32 v24, 16, v160
	v_and_b32 v25, 0xffff0000, v160
	v_lshlrev_b32 v26, 16, v161
	v_and_b32 v27, 0xffff0000, v161
	v_lshlrev_b32 v28, 16, v162
	v_and_b32 v29, 0xffff0000, v162
	v_lshlrev_b32 v30, 16, v163
	v_and_b32 v31, 0xffff0000, v163
	v_fmamk_f32 v24, v24, 0x3fb8aa3b, v8
	v_fmamk_f32 v25, v25, 0x3fb8aa3b, v8
	v_fmamk_f32 v26, v26, 0x3fb8aa3b, v8
	v_fmamk_f32 v27, v27, 0x3fb8aa3b, v8
	v_fmamk_f32 v28, v28, 0x3fb8aa3b, v8
	v_fmamk_f32 v29, v29, 0x3fb8aa3b, v8
	v_fmamk_f32 v30, v30, 0x3fb8aa3b, v8
	v_fmamk_f32 v31, v31, 0x3fb8aa3b, v8
	v_exp_f32 v24, v24
	v_exp_f32 v25, v25
	v_exp_f32 v26, v26
	v_exp_f32 v27, v27
	v_exp_f32 v28, v28
	v_exp_f32 v29, v29
	v_exp_f32 v30, v30
	v_exp_f32 v31, v31
	v_pk_add_f32 v[16:17], v[16:17], v[24:25]
	v_pk_add_f32 v[18:19], v[18:19], v[26:27]
	v_pk_add_f32 v[16:17], v[16:17], v[28:29]
	v_pk_add_f32 v[18:19], v[18:19], v[30:31]
	v_lshlrev_b32 v24, 16, v164
	v_and_b32 v25, 0xffff0000, v164
	v_lshlrev_b32 v26, 16, v165
	v_and_b32 v27, 0xffff0000, v165
	v_lshlrev_b32 v28, 16, v166
	v_and_b32 v29, 0xffff0000, v166
	v_lshlrev_b32 v30, 16, v167
	v_and_b32 v31, 0xffff0000, v167
	v_fmamk_f32 v24, v24, 0x3fb8aa3b, v8
	v_fmamk_f32 v25, v25, 0x3fb8aa3b, v8
	v_fmamk_f32 v26, v26, 0x3fb8aa3b, v8
	v_fmamk_f32 v27, v27, 0x3fb8aa3b, v8
	v_fmamk_f32 v28, v28, 0x3fb8aa3b, v8
	v_fmamk_f32 v29, v29, 0x3fb8aa3b, v8
	v_fmamk_f32 v30, v30, 0x3fb8aa3b, v8
	v_fmamk_f32 v31, v31, 0x3fb8aa3b, v8
	v_exp_f32 v24, v24
	v_exp_f32 v25, v25
	v_exp_f32 v26, v26
	v_exp_f32 v27, v27
	v_exp_f32 v28, v28
	v_exp_f32 v29, v29
	v_exp_f32 v30, v30
	v_exp_f32 v31, v31
	v_pk_add_f32 v[16:17], v[16:17], v[24:25]
	v_pk_add_f32 v[18:19], v[18:19], v[26:27]
	v_pk_add_f32 v[16:17], v[16:17], v[28:29]
	v_pk_add_f32 v[18:19], v[18:19], v[30:31]
	v_lshlrev_b32 v24, 16, v168
	v_and_b32 v25, 0xffff0000, v168
	v_lshlrev_b32 v26, 16, v169
	v_and_b32 v27, 0xffff0000, v169
	v_lshlrev_b32 v28, 16, v170
	v_and_b32 v29, 0xffff0000, v170
	v_lshlrev_b32 v30, 16, v171
	v_and_b32 v31, 0xffff0000, v171
	v_fmamk_f32 v24, v24, 0x3fb8aa3b, v8
	v_fmamk_f32 v25, v25, 0x3fb8aa3b, v8
	v_fmamk_f32 v26, v26, 0x3fb8aa3b, v8
	v_fmamk_f32 v27, v27, 0x3fb8aa3b, v8
	v_fmamk_f32 v28, v28, 0x3fb8aa3b, v8
	v_fmamk_f32 v29, v29, 0x3fb8aa3b, v8
	v_fmamk_f32 v30, v30, 0x3fb8aa3b, v8
	v_fmamk_f32 v31, v31, 0x3fb8aa3b, v8
	v_exp_f32 v24, v24
	v_exp_f32 v25, v25
	v_exp_f32 v26, v26
	v_exp_f32 v27, v27
	v_exp_f32 v28, v28
	v_exp_f32 v29, v29
	v_exp_f32 v30, v30
	v_exp_f32 v31, v31
	v_pk_add_f32 v[16:17], v[16:17], v[24:25]
	v_pk_add_f32 v[18:19], v[18:19], v[26:27]
	v_pk_add_f32 v[16:17], v[16:17], v[28:29]
	v_pk_add_f32 v[18:19], v[18:19], v[30:31]
	v_lshlrev_b32 v24, 16, v172
	v_and_b32 v25, 0xffff0000, v172
	v_lshlrev_b32 v26, 16, v173
	v_and_b32 v27, 0xffff0000, v173
	v_lshlrev_b32 v28, 16, v174
	v_and_b32 v29, 0xffff0000, v174
	v_lshlrev_b32 v30, 16, v175
	v_and_b32 v31, 0xffff0000, v175
	v_fmamk_f32 v24, v24, 0x3fb8aa3b, v8
	v_fmamk_f32 v25, v25, 0x3fb8aa3b, v8
	v_fmamk_f32 v26, v26, 0x3fb8aa3b, v8
	v_fmamk_f32 v27, v27, 0x3fb8aa3b, v8
	v_fmamk_f32 v28, v28, 0x3fb8aa3b, v8
	v_fmamk_f32 v29, v29, 0x3fb8aa3b, v8
	v_fmamk_f32 v30, v30, 0x3fb8aa3b, v8
	v_fmamk_f32 v31, v31, 0x3fb8aa3b, v8
	v_exp_f32 v24, v24
	v_exp_f32 v25, v25
	v_exp_f32 v26, v26
	v_exp_f32 v27, v27
	v_exp_f32 v28, v28
	v_exp_f32 v29, v29
	v_exp_f32 v30, v30
	v_exp_f32 v31, v31
	v_pk_add_f32 v[16:17], v[16:17], v[24:25]
	v_pk_add_f32 v[18:19], v[18:19], v[26:27]
	v_pk_add_f32 v[16:17], v[16:17], v[28:29]
	v_pk_add_f32 v[18:19], v[18:19], v[30:31]
	v_lshlrev_b32 v24, 16, v176
	v_and_b32 v25, 0xffff0000, v176
	v_lshlrev_b32 v26, 16, v177
	v_and_b32 v27, 0xffff0000, v177
	v_lshlrev_b32 v28, 16, v178
	v_and_b32 v29, 0xffff0000, v178
	v_lshlrev_b32 v30, 16, v179
	v_and_b32 v31, 0xffff0000, v179
	v_fmamk_f32 v24, v24, 0x3fb8aa3b, v8
	v_fmamk_f32 v25, v25, 0x3fb8aa3b, v8
	v_fmamk_f32 v26, v26, 0x3fb8aa3b, v8
	v_fmamk_f32 v27, v27, 0x3fb8aa3b, v8
	v_fmamk_f32 v28, v28, 0x3fb8aa3b, v8
	v_fmamk_f32 v29, v29, 0x3fb8aa3b, v8
	v_fmamk_f32 v30, v30, 0x3fb8aa3b, v8
	v_fmamk_f32 v31, v31, 0x3fb8aa3b, v8
	v_exp_f32 v24, v24
	v_exp_f32 v25, v25
	v_exp_f32 v26, v26
	v_exp_f32 v27, v27
	v_exp_f32 v28, v28
	v_exp_f32 v29, v29
	v_exp_f32 v30, v30
	v_exp_f32 v31, v31
	v_pk_add_f32 v[16:17], v[16:17], v[24:25]
	v_pk_add_f32 v[18:19], v[18:19], v[26:27]
	v_pk_add_f32 v[16:17], v[16:17], v[28:29]
	v_pk_add_f32 v[18:19], v[18:19], v[30:31]
	v_lshlrev_b32 v24, 16, v180
	v_and_b32 v25, 0xffff0000, v180
	v_lshlrev_b32 v26, 16, v181
	v_and_b32 v27, 0xffff0000, v181
	v_lshlrev_b32 v28, 16, v182
	v_and_b32 v29, 0xffff0000, v182
	v_lshlrev_b32 v30, 16, v183
	v_and_b32 v31, 0xffff0000, v183
	v_fmamk_f32 v24, v24, 0x3fb8aa3b, v8
	v_fmamk_f32 v25, v25, 0x3fb8aa3b, v8
	v_fmamk_f32 v26, v26, 0x3fb8aa3b, v8
	v_fmamk_f32 v27, v27, 0x3fb8aa3b, v8
	v_fmamk_f32 v28, v28, 0x3fb8aa3b, v8
	v_fmamk_f32 v29, v29, 0x3fb8aa3b, v8
	v_fmamk_f32 v30, v30, 0x3fb8aa3b, v8
	v_fmamk_f32 v31, v31, 0x3fb8aa3b, v8
	v_exp_f32 v24, v24
	v_exp_f32 v25, v25
	v_exp_f32 v26, v26
	v_exp_f32 v27, v27
	v_exp_f32 v28, v28
	v_exp_f32 v29, v29
	v_exp_f32 v30, v30
	v_exp_f32 v31, v31
	v_pk_add_f32 v[16:17], v[16:17], v[24:25]
	v_pk_add_f32 v[18:19], v[18:19], v[26:27]
	v_pk_add_f32 v[16:17], v[16:17], v[28:29]
	v_pk_add_f32 v[18:19], v[18:19], v[30:31]
	v_lshlrev_b32 v24, 16, v184
	v_and_b32 v25, 0xffff0000, v184
	v_lshlrev_b32 v26, 16, v185
	v_and_b32 v27, 0xffff0000, v185
	v_lshlrev_b32 v28, 16, v186
	v_and_b32 v29, 0xffff0000, v186
	v_lshlrev_b32 v30, 16, v187
	v_and_b32 v31, 0xffff0000, v187
	v_fmamk_f32 v24, v24, 0x3fb8aa3b, v8
	v_fmamk_f32 v25, v25, 0x3fb8aa3b, v8
	v_fmamk_f32 v26, v26, 0x3fb8aa3b, v8
	v_fmamk_f32 v27, v27, 0x3fb8aa3b, v8
	v_fmamk_f32 v28, v28, 0x3fb8aa3b, v8
	v_fmamk_f32 v29, v29, 0x3fb8aa3b, v8
	v_fmamk_f32 v30, v30, 0x3fb8aa3b, v8
	v_fmamk_f32 v31, v31, 0x3fb8aa3b, v8
	v_exp_f32 v24, v24
	v_exp_f32 v25, v25
	v_exp_f32 v26, v26
	v_exp_f32 v27, v27
	v_exp_f32 v28, v28
	v_exp_f32 v29, v29
	v_exp_f32 v30, v30
	v_exp_f32 v31, v31
	v_pk_add_f32 v[16:17], v[16:17], v[24:25]
	v_pk_add_f32 v[18:19], v[18:19], v[26:27]
	v_pk_add_f32 v[16:17], v[16:17], v[28:29]
	v_pk_add_f32 v[18:19], v[18:19], v[30:31]
	v_lshlrev_b32 v24, 16, v188
	v_and_b32 v25, 0xffff0000, v188
	v_lshlrev_b32 v26, 16, v189
	v_and_b32 v27, 0xffff0000, v189
	v_lshlrev_b32 v28, 16, v190
	v_and_b32 v29, 0xffff0000, v190
	v_lshlrev_b32 v30, 16, v191
	v_and_b32 v31, 0xffff0000, v191
	v_fmamk_f32 v24, v24, 0x3fb8aa3b, v8
	v_fmamk_f32 v25, v25, 0x3fb8aa3b, v8
	v_fmamk_f32 v26, v26, 0x3fb8aa3b, v8
	v_fmamk_f32 v27, v27, 0x3fb8aa3b, v8
	v_fmamk_f32 v28, v28, 0x3fb8aa3b, v8
	v_fmamk_f32 v29, v29, 0x3fb8aa3b, v8
	v_fmamk_f32 v30, v30, 0x3fb8aa3b, v8
	v_fmamk_f32 v31, v31, 0x3fb8aa3b, v8
	v_exp_f32 v24, v24
	v_exp_f32 v25, v25
	v_exp_f32 v26, v26
	v_exp_f32 v27, v27
	v_exp_f32 v28, v28
	v_exp_f32 v29, v29
	v_exp_f32 v30, v30
	v_exp_f32 v31, v31
	v_pk_add_f32 v[16:17], v[16:17], v[24:25]
	v_pk_add_f32 v[18:19], v[18:19], v[26:27]
	v_pk_add_f32 v[16:17], v[16:17], v[28:29]
	v_pk_add_f32 v[18:19], v[18:19], v[30:31]
	v_pk_add_f32 v[16:17], v[16:17], v[18:19]
	v_add_f32 v9, v16, v17
	s_nop 1
	v_add_f32_dpp v9, v9, v9 row_ror:1 row_mask:0xf bank_mask:0xf
	s_nop 1
	v_add_f32_dpp v9, v9, v9 row_ror:2 row_mask:0xf bank_mask:0xf
	s_nop 1
	v_add_f32_dpp v9, v9, v9 row_ror:4 row_mask:0xf bank_mask:0xf
	s_nop 1
	v_add_f32_dpp v9, v9, v9 row_ror:8 row_mask:0xf bank_mask:0xf
	v_mov_b32 v16, v9
	s_nop 1
	v_permlane16_swap_b32 v16, v9
	v_add_f32 v9, v9, v16
	v_mov_b32 v16, v9
	s_nop 1
	v_permlane32_swap_b32 v16, v9
	v_add_f32 v9, v9, v16
	s_mov_b32 s68, 0
L_nm_f:
	v_cmp_eq_u32 vcc, 0, v14
	s_cbranch_vccz L_nm_go
	s_sleep 20
	ds_read_b32 v14, v15 offset:3112
	s_waitcnt lgkmcnt(0)
	s_add_u32 s68, s68, 1
	s_cmp_lt_u32 s68, 131072
	s_cbranch_scc1 L_nm_f
L_nm_go:
	s_lshl_b32 s60, s37, 7
	s_add_u32 s60, s60, 458752
	s_and_b32 s61, s60, 0xfffffe7f
	s_mov_b64 exec, 0xffff
	v_lshlrev_b32 v2, 3, v0
	buffer_store_dwordx2 v[8:9], v2, s[44:47], s60 offen sc1
	s_mov_b64 exec, -1
	v_lshlrev_b32 v2, 5, v10
	s_mov_b32 s68, 0
L_prog_27:
	ds_read_b32 v14, v10 offset:3072
	s_waitcnt lgkmcnt(0)
	v_lshrrev_b32 v14, 12, v14
	s_nop 1
	v_min_u32_dpp v14, v14, v14 quad_perm:[1,0,3,2] row_mask:0xf bank_mask:0xf
	s_nop 1
	v_min_u32_dpp v14, v14, v14 quad_perm:[2,3,0,1] row_mask:0xf bank_mask:0xf
	s_nop 0
	v_readfirstlane_b32 s64, v14
	s_cmp_ge_u32 s64, 274
	s_cbranch_scc1 L_prog_27_d
	s_sleep 4
	s_add_u32 s68, s68, 1
	s_cmp_lt_u32 s68, 131072
	s_cbranch_scc1 L_prog_27
L_prog_27_d:
	s_mov_b32 s68, 0
L_poll_28:
	buffer_load_dwordx2 v[24:25], v2, s[44:47], s61 offen sc1
	s_waitcnt vmcnt(0)
	v_max_u32 v26, v24, v25
	v_cmpx_eq_u32 vcc, -1, v26
	s_cbranch_execz L_poll_28_d
	s_sleep 20
	s_add_u32 s68, s68, 1
	s_cmp_lt_u32 s68, 131072
	s_cbranch_scc1 L_poll_28
L_poll_28_d:
	s_mov_b64 exec, -1
	s_nop 2
	v_min_f32_dpp v26, v24, v24 quad_perm:[1,0,3,2] row_mask:0xf bank_mask:0xf
	s_nop 1
	v_min_f32_dpp v26, v26, v26 quad_perm:[2,3,0,1] row_mask:0xf bank_mask:0xf
	v_sub_f32 v24, v26, v24
	v_exp_f32 v24, v24
	s_nop 0
	v_mul_f32 v25, v24, v25
	s_nop 1
	v_add_f32_dpp v25, v25, v25 quad_perm:[1,0,3,2] row_mask:0xf bank_mask:0xf
	s_nop 1
	v_add_f32_dpp v25, v25, v25 quad_perm:[2,3,0,1] row_mask:0xf bank_mask:0xf
	v_log_f32 v25, v25
	s_nop 0
	v_sub_f32 v26, v26, v25
	v_sub_f32 v20, v26, v20
	v_exp_f32 v20, v20
	ds_write_b32 v15, v26 offset:3124
	ds_write_b32 v10, v20 offset:2320
	v_mov_b32 v14, 1
	v_mov_b32 v15, 0
	ds_write_b32 v15, v14 offset:3116
	s_branch L_tail
L_bar1:
	s_barrier
L_waitq:
	s_mov_b32 s68, 0
	v_mov_b32 v15, 0
L_h_q:
	ds_read_b32 v14, v15 offset:3120
	s_waitcnt lgkmcnt(0)
	v_cmp_eq_u32 vcc, 0, v14
	s_cbranch_vccz L_route
	s_sleep 8
	s_add_u32 s68, s68, 1
	s_cmp_lt_u32 s68, 131072
	s_cbranch_scc1 L_h_q
L_route:
	v_and_b32 v10, 3, v0
	v_lshlrev_b32 v10, 2, v10
	s_cmp_eq_u32 s3, 4
	s_cbranch_scc1 L_ctl
	s_cmp_eq_u32 s3, 7
	s_cbranch_scc1 L_stage
	s_waitcnt vmcnt(0)
	s_mov_b64 exec, 1
	s_lshl_b32 s61, s32, 5
	s_add_u32 s61, s61, s33
	s_lshl_b32 s61, s61, 2
	s_add_u32 s61, s61, 32768
	buffer_store_dword v15, v15, s[44:47], s61 offen sc1
	s_mov_b64 exec, -1
	s_mov_b32 s68, 0
L_prog_29:
	ds_read_b32 v14, v10 offset:3072
	s_waitcnt lgkmcnt(0)
	v_lshrrev_b32 v14, 12, v14
	s_nop 1
	v_min_u32_dpp v14, v14, v14 quad_perm:[1,0,3,2] row_mask:0xf bank_mask:0xf
	s_nop 1
	v_min_u32_dpp v14, v14, v14 quad_perm:[2,3,0,1] row_mask:0xf bank_mask:0xf
	s_nop 0
	v_readfirstlane_b32 s64, v14
	s_cmp_ge_u32 s64, 208
	s_cbranch_scc1 L_prog_29_d
	s_sleep 4
	s_add_u32 s68, s68, 1
	s_cmp_lt_u32 s68, 131072
	s_cbranch_scc1 L_prog_29
L_prog_29_d:
	s_mov_b32 s52, s12
	s_mov_b32 s53, s13
	s_mov_b32 s54, 4194304
	s_mov_b32 s55, 0x20000
	v_lshrrev_b32 v3, 3, v0
	v_lshlrev_b32 v1, 13, v3
	v_and_b32 v2, 7, v0
	v_lshl_add_u32 v1, v2, 4, v1
	s_lshl_b32 s60, s34, 17
	s_lshl_b32 s61, s36, 7
	s_add_u32 s60, s60, s61
	s_add_u32 s61, s60, 0
	buffer_load_dwordx4 v[128:131], v1, s[52:55], s61 offen offset:0 nt
	s_waitcnt vmcnt(2)
	s_add_u32 s61, s60, 0
	buffer_load_dwordx4 v[132:135], v1, s[52:55], s61 offen offset:1024 nt
	s_waitcnt vmcnt(2)
	s_add_u32 s61, s60, 0
	buffer_load_dwordx4 v[136:139], v1, s[52:55], s61 offen offset:2048 nt
	s_waitcnt vmcnt(2)
	s_add_u32 s61, s60, 0
	buffer_load_dwordx4 v[140:143], v1, s[52:55], s61 offen offset:3072 nt
	s_waitcnt vmcnt(2)
	s_add_u32 s61, s60, 4096
	buffer_load_dwordx4 v[144:147], v1, s[52:55], s61 offen offset:0 nt
	s_waitcnt vmcnt(2)
	s_add_u32 s61, s60, 4096
	buffer_load_dwordx4 v[148:151], v1, s[52:55], s61 offen offset:1024 nt
	s_waitcnt vmcnt(2)
	s_add_u32 s61, s60, 4096
	buffer_load_dwordx4 v[152:155], v1, s[52:55], s61 offen offset:2048 nt
	s_waitcnt vmcnt(2)
	s_add_u32 s61, s60, 4096
	buffer_load_dwordx4 v[156:159], v1, s[52:55], s61 offen offset:3072 nt
	s_waitcnt vmcnt(2)
	s_add_u32 s61, s60, 65536
	buffer_load_dwordx4 v[160:163], v1, s[52:55], s61 offen offset:0 nt
	s_waitcnt vmcnt(2)
	s_add_u32 s61, s60, 65536
	buffer_load_dwordx4 v[164:167], v1, s[52:55], s61 offen offset:1024 nt
	s_waitcnt vmcnt(2)
	s_add_u32 s61, s60, 65536
	buffer_load_dwordx4 v[168:171], v1, s[52:55], s61 offen offset:2048 nt
	s_waitcnt vmcnt(2)
	s_add_u32 s61, s60, 65536
	buffer_load_dwordx4 v[172:175], v1, s[52:55], s61 offen offset:3072 nt
	s_waitcnt vmcnt(2)
	s_add_u32 s61, s60, 69632
	buffer_load_dwordx4 v[176:179], v1, s[52:55], s61 offen offset:0 nt
	s_waitcnt vmcnt(2)
	s_add_u32 s61, s60, 69632
	buffer_load_dwordx4 v[180:183], v1, s[52:55], s61 offen offset:1024 nt
	s_waitcnt vmcnt(2)
	s_add_u32 s61, s60, 69632
	buffer_load_dwordx4 v[184:187], v1, s[52:55], s61 offen offset:2048 nt
	s_waitcnt vmcnt(2)
	s_add_u32 s61, s60, 69632
	buffer_load_dwordx4 v[188:191], v1, s[52:55], s61 offen offset:3072 nt
	s_waitcnt vmcnt(2)
	v_lshlrev_b32 v3, 6, v3
	v_and_b32 v4, 3, v0
	v_lshl_add_u32 v3, v4, 4, v3
	v_bfe_u32 v4, v0, 2, 1
	v_lshl_add_u32 v3, v4, 13, v3
	s_waitcnt vmcnt(0)
	v_perm_b32 v192, v132, v128, s69
	v_perm_b32 v193, v132, v128, s70
	v_perm_b32 v194, v133, v129, s69
	v_perm_b32 v195, v133, v129, s70
	v_perm_b32 v196, v134, v130, s69
	v_perm_b32 v197, v134, v130, s70
	v_perm_b32 v198, v135, v131, s69
	v_perm_b32 v199, v135, v131, s70
	v_perm_b32 v200, v140, v136, s69
	v_perm_b32 v201, v140, v136, s70
	v_perm_b32 v202, v141, v137, s69
	v_perm_b32 v203, v141, v137, s70
	v_perm_b32 v204, v142, v138, s69
	v_perm_b32 v205, v142, v138, s70
	v_perm_b32 v206, v143, v139, s69
	v_perm_b32 v207, v143, v139, s70
	v_perm_b32 v208, v148, v144, s69
	v_perm_b32 v209, v148, v144, s70
	v_perm_b32 v210, v149, v145, s69
	v_perm_b32 v211, v149, v145, s70
	v_perm_b32 v212, v150, v146, s69
	v_perm_b32 v213, v150, v146, s70
	v_perm_b32 v214, v151, v147, s69
	v_perm_b32 v215, v151, v147, s70
	v_perm_b32 v216, v156, v152, s69
	v_perm_b32 v217, v156, v152, s70
	v_perm_b32 v218, v157, v153, s69
	v_perm_b32 v219, v157, v153, s70
	v_perm_b32 v220, v158, v154, s69
	v_perm_b32 v221, v158, v154, s70
	v_perm_b32 v222, v159, v155, s69
	v_perm_b32 v223, v159, v155, s70
	ds_write_b128 v3, v[192:195] offset:20480
	ds_write_b128 v3, v[196:199] offset:21504
	ds_write_b128 v3, v[200:203] offset:22528
	ds_write_b128 v3, v[204:207] offset:23552
	ds_write_b128 v3, v[208:211] offset:24576
	ds_write_b128 v3, v[212:215] offset:25600
	ds_write_b128 v3, v[216:219] offset:26624
	ds_write_b128 v3, v[220:223] offset:27648
	v_perm_b32 v224, v164, v160, s69
	v_perm_b32 v225, v164, v160, s70
	v_perm_b32 v226, v165, v161, s69
	v_perm_b32 v227, v165, v161, s70
	v_perm_b32 v228, v166, v162, s69
	v_perm_b32 v229, v166, v162, s70
	v_perm_b32 v230, v167, v163, s69
	v_perm_b32 v231, v167, v163, s70
	v_perm_b32 v232, v172, v168, s69
	v_perm_b32 v233, v172, v168, s70
	v_perm_b32 v234, v173, v169, s69
	v_perm_b32 v235, v173, v169, s70
	v_perm_b32 v236, v174, v170, s69
	v_perm_b32 v237, v174, v170, s70
	v_perm_b32 v238, v175, v171, s69
	v_perm_b32 v239, v175, v171, s70
	v_perm_b32 v240, v180, v176, s69
	v_perm_b32 v241, v180, v176, s70
	v_perm_b32 v242, v181, v177, s69
	v_perm_b32 v243, v181, v177, s70
	v_perm_b32 v244, v182, v178, s69
	v_perm_b32 v245, v182, v178, s70
	v_perm_b32 v246, v183, v179, s69
	v_perm_b32 v247, v183, v179, s70
	v_perm_b32 v248, v188, v184, s69
	v_perm_b32 v249, v188, v184, s70
	v_perm_b32 v250, v189, v185, s69
	v_perm_b32 v251, v189, v185, s70
	v_perm_b32 v252, v190, v186, s69
	v_perm_b32 v253, v190, v186, s70
	v_perm_b32 v254, v191, v187, s69
	v_perm_b32 v255, v191, v187, s70
	ds_write_b128 v3, v[224:227] offset:20992
	ds_write_b128 v3, v[228:231] offset:22016
	ds_write_b128 v3, v[232:235] offset:23040
	ds_write_b128 v3, v[236:239] offset:24064
	ds_write_b128 v3, v[240:243] offset:25088
	ds_write_b128 v3, v[244:247] offset:26112
	ds_write_b128 v3, v[248:251] offset:27136
	ds_write_b128 v3, v[252:255] offset:28160
	v_mov_b32 v14, 1
	v_mov_b32 v15, 0
	ds_write_b32 v15, v14 offset:3104
	s_branch L_tail
L_ctl:
	s_mov_b32 s68, 0
L_prog_30:
	ds_read_b32 v14, v10 offset:3072
	s_waitcnt lgkmcnt(0)
	v_lshrrev_b32 v14, 12, v14
	s_nop 1
	v_add_u32_dpp v14, v14, v14 quad_perm:[1,0,3,2] row_mask:0xf bank_mask:0xf
	s_nop 1
	v_add_u32_dpp v14, v14, v14 quad_perm:[2,3,0,1] row_mask:0xf bank_mask:0xf
	s_nop 0
	v_readfirstlane_b32 s64, v14
	s_cmp_ge_u32 s64, 472
	s_cbranch_scc1 L_prog_30_d
	s_sleep 4
	s_add_u32 s68, s68, 1
	s_cmp_lt_u32 s68, 131072
	s_cbranch_scc1 L_prog_30
L_prog_30_d:
	v_lshlrev_b32 v9, 4, v0
	s_mov_b32 s60, 32768
	s_mov_b32 s68, 0
L_poll_31:
	buffer_load_dwordx4 v[4:7], v9, s[44:47], s60 offen sc1
	s_waitcnt vmcnt(0)
	v_max3_u32 v8, v4, v5, v6
	v_max_u32 v8, v8, v7
	v_cmpx_eq_u32 vcc, -1, v8
	s_cbranch_execz L_poll_31_d
	s_sleep 16
	s_add_u32 s68, s68, 1
	s_cmp_lt_u32 s68, 131072
	s_cbranch_scc1 L_poll_31
L_poll_31_d:
	s_mov_b64 exec, -1
	v_mov_b32 v14, 1
	v_mov_b32 v15, 0
	ds_write_b32 v15, v14 offset:3112
	v_lshlrev_b32 v2, 7, v0
	v_lshlrev_b32 v3, 4, v0
	s_mov_b32 s90, 1564672
	s_mov_b32 s91, 1566720
	s_mov_b32 s92, 2
	s_mov_b32 s94, 504
	s_mov_b32 s93, 168
	s_mov_b32 s96, 0
	s_mov_b32 s97, 0
	s_mov_b32 s98, 0
	s_mov_b32 s99, 0
	s_getreg_b32 s60, hwreg(HW_REG_XCC_ID, 0, 3)
	s_lshl_b32 s60, s60, 12
	s_add_u32 s95, s60, 1605632
L_tick:
	s_cmp_eq_u32 s2, 0
	s_cselect_b32 s93, s94, s93
	s_mov_b32 s68, 0
L_prog_32:
	s_call_b64 s[42:43], L_serve
	s_cmp_ge_u32 s64, s93
	s_cbranch_scc1 L_prog_32_d
	s_sleep 4
	s_add_u32 s68, s68, 1
	s_cmp_lt_u32 s68, 131072
	s_cbranch_scc1 L_prog_32
L_prog_32_d:
	v_mov_b32 v4, 0
	v_mov_b32 v5, 0
	v_mov_b32 v6, 0
	v_mov_b32 v7, 0
	s_cmp_lg_u32 s2, 0
	s_cbranch_scc1 L_tk_poll
	s_mov_b64 exec, 0xff
	buffer_store_dwordx4 v[4:7], v3, s[44:47], s90 offen sc1
	s_mov_b64 exec, -1
L_tk_poll:
	s_cmp_lg_u32 s33, 1
	s_cbranch_scc1 L_tk_local
	s_mov_b32 s68, 0
	buffer_load_dword v8, v15, s[44:47], s90 offen sc1
L_tk_far:
	buffer_load_dword v9, v15, s[44:47], s90 offen sc1
	s_waitcnt vmcnt(1)
	v_cmp_eq_u32 vcc, -1, v8
	s_cbranch_vccz L_tk_pass
	s_call_b64 s[42:43], L_serve
	s_sleep 1
	buffer_load_dword v8, v15, s[44:47], s90 offen sc1
	s_waitcnt vmcnt(1)
	v_cmp_eq_u32 vcc, -1, v9
	s_cbranch_vccz L_tk_pass
	s_call_b64 s[42:43], L_serve
	s_sleep 1
	s_cmp_ge_u32 s64, 2032
	s_cbranch_scc1 L_ctl_done
	s_add_u32 s68, s68, 1
	s_cmp_lt_u32 s68, 131072
	s_cbranch_scc1 L_tk_far
L_tk_pass:
	s_mov_b64 exec, 0xff
	buffer_store_dwordx4 v[4:7], v3, s[44:47], s95 offen
	s_mov_b64 exec, -1
	s_waitcnt vmcnt(0)
L_tk_local:
	s_mov_b32 s68, 0
	buffer_load_dword v8, v15, s[44:47], s95 offen sc1
L_tk_again:
	buffer_load_dword v9, v15, s[44:47], s95 offen sc1
	s_waitcnt vmcnt(1)
	v_cmp_eq_u32 vcc, -1, v8
	s_cbranch_vccz L_tk_seen
	s_call_b64 s[42:43], L_serve
	s_sleep 1
	buffer_load_dword v8, v15, s[44:47], s95 offen sc1
	s_waitcnt vmcnt(1)
	v_cmp_eq_u32 vcc, -1, v9
	s_cbranch_vccz L_tk_seen
	s_call_b64 s[42:43], L_serve
	s_sleep 1
	s_cmp_ge_u32 s64, 2032
	s_cbranch_scc1 L_ctl_done
	s_add_u32 s68, s68, 1
	s_cmp_lt_u32 s68, 131072
	s_cbranch_scc1 L_tk_again
L_tk_seen:
	s_call_b64 s[42:43], L_serve
	s_and_b32 s60, s33, 15
	s_cmp_lg_u32 s60, 8
	s_cbranch_scc1 L_tk_nopub
	s_lshr_b32 s60, s33, 4
	s_lshl_b32 s60, s60, 3
	s_add_u32 s60, s60, s32
	s_lshl_b32 s60, s60, 7
	s_add_u32 s60, s60, s91
	v_mov_b32 v4, s64
	v_mov_b32 v5, s64
	v_mov_b32 v6, s64
	v_mov_b32 v7, s64
	s_mov_b64 exec, 0xff
	buffer_store_dwordx4 v[4:7], v3, s[44:47], s60 offen offset:2048 sc1
	s_mov_b64 exec, -1
L_tk_nopub:
	s_waitcnt vmcnt(0)
	v_mov_b32 v8, s96
	v_mov_b32 v9, s96
	s_mov_b64 exec, 0xffff
	s_cmp_eq_u32 s96, 0
	s_cbranch_scc1 L_tk_calc
	buffer_load_dword v9, v2, s[44:47], s91 offen sc1
L_tk_calc:
	s_mov_b32 s96, s64
	s_add_u32 s93, s64, 64
	s_min_u32 s93, s93, 2032
	s_add_u32 s90, s90, 128
	s_add_u32 s95, s95, 128
	s_add_u32 s91, s91, 2048
	s_add_u32 s94, s94, 112
	s_waitcnt vmcnt(0)
	v_cmp_eq_u32 vcc, -1, v9
	s_nop 1
	v_cndmask_b32 v9, v9, v8, vcc
	v_sub_u32 v9, v9, v8
	s_nop 1
	v_add_u32_dpp v9, v9, v9 row_ror:8 row_mask:0xf bank_mask:0xf
	s_nop 1
	v_add_u32_dpp v9, v9, v9 row_ror:4 row_mask:0xf bank_mask:0xf
	s_nop 1
	v_add_u32_dpp v9, v9, v9 row_ror:2 row_mask:0xf bank_mask:0xf
	s_nop 1
	v_add_u32_dpp v9, v9, v9 row_ror:1 row_mask:0xf bank_mask:0xf
	s_nop 0
	v_readfirstlane_b32 s60, v9
	s_mov_b64 exec, -1
	s_sub_u32 s61, s60, s98
	s_cmp_gt_u32 s90, 1564928
	s_cselect_b32 s62, 3, 0
	s_mul_i32 s61, s61, s62
	s_ashr_i32 s61, s61, 4
	s_add_u32 s99, s99, s61
	s_sub_u32 s60, s60, s97
	s_add_u32 s98, s60, s99
	s_mul_i32 s60, s98, 11
	s_ashr_i32 s60, s60, 4
	s_add_u32 s60, s60, s99
	s_abs_i32 s61, s60
	s_cmp_gt_i32 s60, 0
	s_cselect_b32 s66, 34, -32
	s_cselect_b32 s63, 30, 32
	s_cselect_b32 s65, 3, 1
	s_mul_i32 s62, s61, s63
	s_add_u32 s62, s62, 512
	s_lshr_b32 s62, s62, 10
	s_cmp_le_u32 s62, 4
	s_cbranch_scc1 L_tk_act
	s_cmp_gt_i32 s60, 0
	s_cselect_b32 s66, 56, -86
	s_cselect_b32 s63, 18, 11
	s_cselect_b32 s65, 4, 0
	s_mul_i32 s62, s61, s63
	s_add_u32 s62, s62, 512
	s_lshr_b32 s62, s62, 10
	s_cmp_le_u32 s62, 4
	s_cbranch_scc1 L_tk_act
	s_cmp_lt_i32 s60, 0
	s_cbranch_scc1 L_tk_act
	s_cmp_lt_u32 s64, 792
	s_cbranch_scc1 L_tk_far_behind
	s_mov_b32 s65, 5
	s_mov_b32 s66, 91
	s_mul_i32 s62, s61, 11
	s_add_u32 s62, s62, 512
	s_lshr_b32 s62, s62, 10
L_tk_far_behind:
	s_mov_b32 s92, s65
	s_mul_i32 s97, s66, 7
	s_cmp_ge_u32 s62, 6
	s_cbranch_scc1 L_tk_next
L_tk_act:
	s_min_u32 s62, s62, 4
	s_mul_i32 s97, s62, s66
	s_lshl_b32 s62, s62, 4
	s_cbranch_scc0 L_tk_mid
	s_add_u32 s67, s62, s64
	s_min_u32 s67, s67, 2032
	s_mov_b32 s92, s65
	s_mov_b32 s68, 0
L_prog_33:
	s_call_b64 s[42:43], L_serve
	s_cmp_ge_u32 s64, s67
	s_cbranch_scc1 L_prog_33_d
	s_sleep 4
	s_add_u32 s68, s68, 1
	s_cmp_lt_u32 s68, 131072
	s_cbranch_scc1 L_prog_33
L_prog_33_d:
L_tk_mid:
	s_mov_b32 s92, 2
L_tk_next:
	s_cmp_lt_u32 s90, 1566464
	s_cbranch_scc1 L_tick
	s_mov_b32 s68, 0
L_prog_34:
	s_call_b64 s[42:43], L_serve
	s_cmp_ge_u32 s64, 2032
	s_cbranch_scc1 L_prog_34_d
	s_sleep 4
	s_add_u32 s68, s68, 1
	s_cmp_lt_u32 s68, 131072
	s_cbranch_scc1 L_prog_34
L_prog_34_d:
L_ctl_done:
	s_waitcnt vmcnt(0)
	s_branch L_tail
L_serve:
	ds_read_b32 v16, v10 offset:3072
	v_mov_b32 v17, s92
	s_waitcnt lgkmcnt(0)
	v_lshrrev_b32 v16, 12, v16
	s_nop 1
	v_add_u32_dpp v14, v16, v16 quad_perm:[1,0,3,2] row_mask:0xf bank_mask:0xf
	s_nop 1
	v_add_u32_dpp v14, v14, v14 quad_perm:[2,3,0,1] row_mask:0xf bank_mask:0xf
	v_lshlrev_b32 v16, 2, v16
	v_sub_u32 v16, v16, v14
	v_cmp_ge_i32 vcc, -5, v16
	s_nop 1
	v_addc_co_u32 v17, vcc, 0, v17, vcc
	v_cmp_le_i32 vcc, 5, v16
	s_nop 1
	v_subb_co_u32 v17, vcc, v17, v15, vcc
	v_med3_i32 v17, v17, 0, 5
	v_readfirstlane_b32 s64, v14
	ds_write_b32 v10, v17 offset:3088
	s_setpc_b64 s[42:43]
L_stage:
	s_cmp_ge_u32 s38, 224
	s_cbranch_scc1 L_stage_done
	s_mov_b32 s52, s16
	s_mov_b32 s53, s17
	s_mov_b32 s54, 1835008
	s_mov_b32 s55, 0x20000
	s_mov_b32 s56, s18
	s_mov_b32 s57, s19
	s_mov_b32 s58, 1835008
	s_mov_b32 s59, 0x20000
	s_mov_b32 s60, 14336
	v_mul_lo_u32 v1, s60, v0
	s_lshl_b32 s61, s38, 4
	v_add_u32 v1, s61, v1
	s_mov_b32 s60, 0
	buffer_load_dwordx4 v[128:131], v1, s[52:55], s60 offen nt
	s_waitcnt vmcnt(1)
	buffer_load_dwordx4 v[132:135], v1, s[56:59], s60 offen nt
	s_waitcnt vmcnt(1)
	s_mov_b32 s60, 3584
	buffer_load_dwordx4 v[136:139], v1, s[52:55], s60 offen nt
	s_waitcnt vmcnt(1)
	buffer_load_dwordx4 v[140:143], v1, s[56:59], s60 offen nt
	s_waitcnt vmcnt(1)
	s_mov_b32 s60, 7168
	buffer_load_dwordx4 v[144:147], v1, s[52:55], s60 offen nt
	s_waitcnt vmcnt(1)
	buffer_load_dwordx4 v[148:151], v1, s[56:59], s60 offen nt
	s_waitcnt vmcnt(1)
	s_mov_b32 s60, 10752
	buffer_load_dwordx4 v[152:155], v1, s[52:55], s60 offen nt
	s_waitcnt vmcnt(1)
	buffer_load_dwordx4 v[156:159], v1, s[56:59], s60 offen nt
	s_waitcnt vmcnt(1)
	s_mov_b32 s60, 917504
	buffer_load_dwordx4 v[160:163], v1, s[52:55], s60 offen nt
	s_waitcnt vmcnt(1)
	buffer_load_dwordx4 v[164:167], v1, s[56:59], s60 offen nt
	s_waitcnt vmcnt(1)
	s_mov_b32 s60, 921088
	buffer_load_dwordx4 v[168:171], v1, s[52:55], s60 offen nt
	s_waitcnt vmcnt(1)
	buffer_load_dwordx4 v[172:175], v1, s[56:59], s60 offen nt
	s_waitcnt vmcnt(1)
	s_mov_b32 s60, 924672
	buffer_load_dwordx4 v[176:179], v1, s[52:55], s60 offen nt
	s_waitcnt vmcnt(1)
	buffer_load_dwordx4 v[180:183], v1, s[56:59], s60 offen nt
	s_waitcnt vmcnt(1)
	s_mov_b32 s60, 928256
	buffer_load_dwordx4 v[184:187], v1, s[52:55], s60 offen nt
	s_waitcnt vmcnt(1)
	buffer_load_dwordx4 v[188:191], v1, s[56:59], s60 offen nt
	s_waitcnt vmcnt(1)
	s_mov_b32 s52, s20
	s_mov_b32 s53, s21
	s_mov_b32 s54, 1835008
	s_mov_b32 s55, 0x20000
	s_lshl_b32 s60, s38, 13
	s_add_u32 s61, s60, 4096
	v_lshlrev_b32 v1, 3, v0
	buffer_load_dwordx2 v[40:41], v1, s[52:55], s60 offen offset:0 nt
	buffer_load_dwordx2 v[42:43], v1, s[52:55], s60 offen offset:512 nt
	buffer_load_dwordx2 v[44:45], v1, s[52:55], s60 offen offset:1024 nt
	buffer_load_dwordx2 v[46:47], v1, s[52:55], s60 offen offset:1536 nt
	buffer_load_dwordx2 v[48:49], v1, s[52:55], s60 offen offset:2048 nt
	buffer_load_dwordx2 v[50:51], v1, s[52:55], s60 offen offset:2560 nt
	buffer_load_dwordx2 v[52:53], v1, s[52:55], s60 offen offset:3072 nt
	buffer_load_dwordx2 v[54:55], v1, s[52:55], s60 offen offset:3584 nt
	buffer_load_dwordx2 v[56:57], v1, s[52:55], s61 offen offset:0 nt
	buffer_load_dwordx2 v[58:59], v1, s[52:55], s61 offen offset:512 nt
	buffer_load_dwordx2 v[60:61], v1, s[52:55], s61 offen offset:1024 nt
	buffer_load_dwordx2 v[62:63], v1, s[52:55], s61 offen offset:1536 nt
	buffer_load_dwordx2 v[64:65], v1, s[52:55], s61 offen offset:2048 nt
	buffer_load_dwordx2 v[66:67], v1, s[52:55], s61 offen offset:2560 nt
	buffer_load_dwordx2 v[68:69], v1, s[52:55], s61 offen offset:3072 nt
	buffer_load_dwordx2 v[70:71], v1, s[52:55], s61 offen offset:3584 nt
	s_waitcnt vmcnt(16)
	v_perm_b32 v192, v136, v128, s69
	v_perm_b32 v193, v136, v128, s70
	v_perm_b32 v194, v137, v129, s69
	v_perm_b32 v195, v137, v129, s70
	v_perm_b32 v196, v138, v130, s69
	v_perm_b32 v197, v138, v130, s70
	v_perm_b32 v198, v139, v131, s69
	v_perm_b32 v199, v139, v131, s70
	v_perm_b32 v200, v140, v132, s69
	v_perm_b32 v201, v140, v132, s70
	v_perm_b32 v202, v141, v133, s69
	v_perm_b32 v203, v141, v133, s70
	v_perm_b32 v204, v142, v134, s69
	v_perm_b32 v205, v142, v134, s70
	v_perm_b32 v206, v143, v135, s69
	v_perm_b32 v207, v143, v135, s70
	v_perm_b32 v208, v152, v144, s69
	v_perm_b32 v209, v152, v144, s70
	v_perm_b32 v210, v153, v145, s69
	v_perm_b32 v211, v153, v145, s70
	v_perm_b32 v212, v154, v146, s69
	v_perm_b32 v213, v154, v146, s70
	v_perm_b32 v214, v155, v147, s69
	v_perm_b32 v215, v155, v147, s70
	v_perm_b32 v216, v156, v148, s69
	v_perm_b32 v217, v156, v148, s70
	v_perm_b32 v218, v157, v149, s69
	v_perm_b32 v219, v157, v149, s70
	v_perm_b32 v220, v158, v150, s69
	v_perm_b32 v221, v158, v150, s70
	v_perm_b32 v222, v159, v151, s69
	v_perm_b32 v223, v159, v151, s70
	v_perm_b32 v224, v168, v160, s69
	v_perm_b32 v225, v168, v160, s70
	v_perm_b32 v226, v169, v161, s69
	v_perm_b32 v227, v169, v161, s70
	v_perm_b32 v228, v170, v162, s69
	v_perm_b32 v229, v170, v162, s70
	v_perm_b32 v230, v171, v163, s69
	v_perm_b32 v231, v171, v163, s70
	v_perm_b32 v232, v172, v164, s69
	v_perm_b32 v233, v172, v164, s70
	v_perm_b32 v234, v173, v165, s69
	v_perm_b32 v235, v173, v165, s70
	v_perm_b32 v236, v174, v166, s69
	v_perm_b32 v237, v174, v166, s70
	v_perm_b32 v238, v175, v167, s69
	v_perm_b32 v239, v175, v167, s70
	v_perm_b32 v240, v184, v176, s69
	v_perm_b32 v241, v184, v176, s70
	v_perm_b32 v242, v185, v177, s69
	v_perm_b32 v243, v185, v177, s70
	v_perm_b32 v244, v186, v178, s69
	v_perm_b32 v245, v186, v178, s70
	v_perm_b32 v246, v187, v179, s69
	v_perm_b32 v247, v187, v179, s70
	v_perm_b32 v248, v188, v180, s69
	v_perm_b32 v249, v188, v180, s70
	v_perm_b32 v250, v189, v181, s69
	v_perm_b32 v251, v189, v181, s70
	v_perm_b32 v252, v190, v182, s69
	v_perm_b32 v253, v190, v182, s70
	v_perm_b32 v254, v191, v183, s69
	v_perm_b32 v255, v191, v183, s70
	s_waitcnt vmcnt(0)
	v_perm_b32 v128, v44, v40, s69
	v_perm_b32 v129, v44, v40, s70
	v_perm_b32 v130, v45, v41, s69
	v_perm_b32 v131, v45, v41, s70
	v_perm_b32 v132, v46, v42, s69
	v_perm_b32 v133, v46, v42, s70
	v_perm_b32 v134, v47, v43, s69
	v_perm_b32 v135, v47, v43, s70
	v_perm_b32 v136, v52, v48, s69
	v_perm_b32 v137, v52, v48, s70
	v_perm_b32 v138, v53, v49, s69
	v_perm_b32 v139, v53, v49, s70
	v_perm_b32 v140, v54, v50, s69
	v_perm_b32 v141, v54, v50, s70
	v_perm_b32 v142, v55, v51, s69
	v_perm_b32 v143, v55, v51, s70
	v_perm_b32 v144, v60, v56, s69
	v_perm_b32 v145, v60, v56, s70
	v_perm_b32 v146, v61, v57, s69
	v_perm_b32 v147, v61, v57, s70
	v_perm_b32 v148, v62, v58, s69
	v_perm_b32 v149, v62, v58, s70
	v_perm_b32 v150, v63, v59, s69
	v_perm_b32 v151, v63, v59, s70
	v_perm_b32 v152, v68, v64, s69
	v_perm_b32 v153, v68, v64, s70
	v_perm_b32 v154, v69, v65, s69
	v_perm_b32 v155, v69, v65, s70
	v_perm_b32 v156, v70, v66, s69
	v_perm_b32 v157, v70, v66, s70
	v_perm_b32 v158, v71, v67, s69
	v_perm_b32 v159, v71, v67, s70
	v_lshlrev_b32 v2, 4, v0
	s_mov_b32 s68, 0
L_prog_35:
	ds_read_b32 v14, v10 offset:3072
	s_waitcnt lgkmcnt(0)
	v_lshrrev_b32 v14, 12, v14
	s_nop 1
	v_min_u32_dpp v14, v14, v14 quad_perm:[1,0,3,2] row_mask:0xf bank_mask:0xf
	s_nop 1
	v_min_u32_dpp v14, v14, v14 quad_perm:[2,3,0,1] row_mask:0xf bank_mask:0xf
	s_nop 0
	v_readfirstlane_b32 s64, v14
	s_cmp_ge_u32 s64, 208
	s_cbranch_scc1 L_prog_35_d
	s_sleep 4
	s_add_u32 s68, s68, 1
	s_cmp_lt_u32 s68, 131072
	s_cbranch_scc1 L_prog_35
L_prog_35_d:
	ds_write_b128 v2, v[192:195] offset:36864
	ds_write_b128 v2, v[196:199] offset:37888
	ds_write_b128 v2, v[200:203] offset:38912
	ds_write_b128 v2, v[204:207] offset:39936
	ds_write_b128 v2, v[208:211] offset:40960
	ds_write_b128 v2, v[212:215] offset:41984
	ds_write_b128 v2, v[216:219] offset:43008
	ds_write_b128 v2, v[220:223] offset:44032
	ds_write_b128 v2, v[224:227] offset:45056
	ds_write_b128 v2, v[228:231] offset:46080
	ds_write_b128 v2, v[232:235] offset:47104
	ds_write_b128 v2, v[236:239] offset:48128
	ds_write_b128 v2, v[240:243] offset:49152
	ds_write_b128 v2, v[244:247] offset:50176
	ds_write_b128 v2, v[248:251] offset:51200
	ds_write_b128 v2, v[252:255] offset:52224
	ds_write_b128 v2, v[128:131] offset:53248
	ds_write_b128 v2, v[132:135] offset:54272
	ds_write_b128 v2, v[136:139] offset:55296
	ds_write_b128 v2, v[140:143] offset:56320
	ds_write_b128 v2, v[144:147] offset:57344
	ds_write_b128 v2, v[148:151] offset:58368
	ds_write_b128 v2, v[152:155] offset:59392
	ds_write_b128 v2, v[156:159] offset:60416
L_stage_done:
	v_mov_b32 v14, 1
	v_mov_b32 v15, 0
	ds_write_b32 v15, v14 offset:3108
L_tail:
	s_and_b32 s64, s3, 1
	s_bfe_u32 s65, s3, 0x10001
	v_and_b32 v2, 3, v0
	s_lshl_b32 s60, s64, 13
	v_lshl_add_u32 v7, v0, 4, s60
	v_mov_b32 v106, 0
	v_mov_b32 v107, 0
	v_mov_b32 v108, 0
	v_mov_b32 v109, 0
	v_mov_b32 v110, 0
	v_mov_b32 v111, 0
	v_mov_b32 v112, 0
	v_mov_b32 v113, 0
	v_lshlrev_b32 v1, 5, v2
	v_lshl_add_u32 v1, v13, 4, v1
	v_lshl_add_u32 v1, v12, 3, v1
	s_lshl_b32 s66, s65, 4
	s_lshl_b32 s61, s36, 1
	s_add_u32 s66, s66, s61
	s_add_u32 s66, s66, s64
	s_lshl_b32 s66, s66, 5
	s_add_u32 s66, s66, s34
	s_lshl_b32 s66, s66, 7
	s_add_u32 s66, s66, 491520
	v_lshlrev_b32 v3, 3, v0
	s_lshl_b32 s67, s65, 5
	s_add_u32 s67, s67, s34
	s_lshl_b32 s67, s67, 11
	s_add_u32 s67, s67, 327680
	s_add_u32 s60, s36, 0
	s_and_b32 s60, s60, 3
	s_lshl_b32 s60, s60, 9
	s_add_u32 s84, s60, s67
	s_add_u32 s60, s36, 1
	s_and_b32 s60, s60, 3
	s_lshl_b32 s60, s60, 9
	s_add_u32 s85, s60, s67
	s_add_u32 s60, s36, 2
	s_and_b32 s60, s60, 3
	s_lshl_b32 s60, s60, 9
	s_add_u32 s86, s60, s67
	s_add_u32 s60, s36, 3
	s_and_b32 s60, s60, 3
	s_lshl_b32 s60, s60, 9
	s_add_u32 s87, s60, s67
	s_mov_b32 s68, 0
	v_mov_b32 v15, 0
L_fl:
	ds_read_b96 v[72:74], v15 offset:3104
	s_waitcnt lgkmcnt(0)
	v_min3_u32 v14, v72, v73, v74
	v_cmp_eq_u32 vcc, 0, v14
	s_cbranch_vccz L_fl_d
	s_sleep 20
	s_add_u32 s68, s68, 1
	s_cmp_lt_u32 s68, 131072
	s_cbranch_scc1 L_fl
L_fl_d:
	ds_read_b128 v[40:43], v7 offset:20480
	ds_read_b128 v[44:47], v7 offset:21504
	ds_read_b128 v[48:51], v7 offset:22528
	ds_read_b128 v[52:55], v7 offset:23552
	ds_read_b128 v[56:59], v7 offset:24576
	ds_read_b128 v[60:63], v7 offset:25600
	ds_read_b128 v[64:67], v7 offset:26624
	ds_read_b128 v[68:71], v7 offset:27648
	s_cmp_eq_u32 s3, 4
	s_cbranch_scc1 L_bar2
	s_cmp_eq_u32 s3, 7
	s_cbranch_scc1 L_preR
	s_cmp_ge_u32 s38, 224
	s_cbranch_scc1 L_bar2
	s_sub_u32 s63, s3, 5
	s_lshl_b32 s60, s63, 13
	s_add_u32 s60, s60, 1546240
	s_add_u32 s61, s60, 2048
	v_lshlrev_b32 v5, 4, v0
	s_waitcnt lgkmcnt(0)
	ds_read_b128 v[128:131], v5 offset:36864
	ds_read_b128 v[132:135], v5 offset:37888
	ds_read_b128 v[136:139], v5 offset:38912
	ds_read_b128 v[140:143], v5 offset:39936
	ds_read_b128 v[144:147], v5 offset:40960
	ds_read_b128 v[148:151], v5 offset:41984
	ds_read_b128 v[152:155], v5 offset:43008
	ds_read_b128 v[156:159], v5 offset:44032
	ds_read_b128 v[160:163], v5 offset:45056
	ds_read_b128 v[164:167], v5 offset:46080
	ds_read_b128 v[168:171], v5 offset:47104
	ds_read_b128 v[172:175], v5 offset:48128
	s_waitcnt lgkmcnt(0)
	ds_read_b128 v[176:179], v5 offset:49152
	ds_read_b128 v[180:183], v5 offset:50176
	ds_read_b128 v[184:187], v5 offset:51200
	ds_read_b128 v[188:191], v5 offset:52224
	ds_read_b128 v[192:195], v5 offset:53248
	ds_read_b128 v[196:199], v5 offset:54272
	ds_read_b128 v[200:203], v5 offset:55296
	ds_read_b128 v[204:207], v5 offset:56320
	ds_read_b128 v[208:211], v5 offset:57344
	ds_read_b128 v[212:215], v5 offset:58368
	ds_read_b128 v[216:219], v5 offset:59392
	ds_read_b128 v[220:223], v5 offset:60416
	s_mov_b32 s68, 0
L_poll_36:
	buffer_load_dwordx4 v[224:227], v5, s[44:47], s61 offen offset:0 sc1
	buffer_load_dwordx4 v[228:231], v5, s[44:47], s61 offen offset:1024 sc1
	buffer_load_dwordx4 v[232:235], v5, s[44:47], s60 offen offset:0 sc1
	buffer_load_dwordx4 v[236:239], v5, s[44:47], s60 offen offset:1024 sc1
	s_waitcnt vmcnt(0)
	v_max3_u32 v8, v224, v225, v226
	v_max3_u32 v8, v8, v227, v228
	v_max3_u32 v8, v8, v229, v230
	v_max3_u32 v8, v8, v231, v232
	v_max3_u32 v8, v8, v233, v234
	v_max3_u32 v8, v8, v235, v236
	v_max3_u32 v8, v8, v237, v238
	v_max_u32 v8, v8, v239
	v_cmpx_eq_u32 vcc, -1, v8
	s_cbranch_execz L_poll_36_d
	s_sleep 20
	s_add_u32 s68, s68, 1
	s_cmp_lt_u32 s68, 131072
	s_cbranch_scc1 L_poll_36
L_poll_36_d:
	s_mov_b64 exec, -1
	s_branch L_bar2
L_preR:
	s_cmp_ge_u32 s39, 32
	s_cbranch_scc1 L_bar2
	s_mov_b32 s56, s4
	s_mov_b32 s57, s5
	s_mov_b32 s58, 2048
	s_mov_b32 s59, 0x20000
	v_and_b32 v5, 7, v0
	v_lshlrev_b32 v5, 2, v5
	v_lshl_add_u32 v5, v13, 1, v5
	v_add_u32 v5, v5, v12
	v_lshlrev_b32 v6, 1, v5
	v_lshlrev_b32 v5, 2, v5
	s_lshl_b32 s60, s39, 6
	buffer_load_ushort v34, v6, s[56:59], s60 offen
	s_lshr_b32 s60, s39, 4
	s_lshl_b32 s60, s60, 13
	s_and_b32 s61, s39, 15
	s_lshl_b32 s61, s61, 7
	s_add_u32 s60, s60, s61
	s_add_u32 s60, s60, 1544192
	s_add_u32 s61, s60, 6144
	s_mov_b32 s68, 0
L_poll_37:
	buffer_load_dword v32, v5, s[44:47], s60 offen sc1
	buffer_load_dword v33, v5, s[44:47], s61 offen sc1
	s_waitcnt vmcnt(0)
	v_max_u32 v8, v32, v33
	v_cmpx_eq_u32 vcc, -1, v8
	s_cbranch_execz L_poll_37_d
	s_sleep 20
	s_add_u32 s68, s68, 1
	s_cmp_lt_u32 s68, 131072
	s_cbranch_scc1 L_poll_37
L_poll_37_d:
	s_mov_b64 exec, -1
	v_lshlrev_b32 v34, 16, v34
L_bar2:
	s_mov_b32 s68, 0
	s_waitcnt lgkmcnt(0)
	s_barrier
	s_cmp_lg_u32 s65, s35
	s_cbranch_scc1 L_h0_first
	ds_read_b64 v[80:81], v3 offset:256
	ds_read_b64 v[82:83], v3 offset:768
	ds_read_b64 v[84:85], v3 offset:1280
	ds_read_b64 v[86:87], v3 offset:1792
	s_waitcnt lgkmcnt(2)
	v_pk_add_f32 v[16:17], v[80:81], v[82:83]
	s_waitcnt lgkmcnt(0)
	v_pk_add_f32 v[84:85], v[84:85], v[86:87]
	v_pk_add_f32 v[16:17], v[16:17], v[84:85]
	s_cmp_lg_u32 s64, 0
	s_cbranch_scc1 L_h0_first
	buffer_store_dwordx2 v[16:17], v3, s[44:47], s84 offen sc1
	s_waitcnt vmcnt(0)
L_h0_first:
	s_barrier
L_h0_again:
	s_cmp_eq_u32 s65, s35
	s_cbranch_scc1 L_g0
	buffer_load_dwordx2 v[16:17], v3, s[44:47], s84 offen sc1
L_g0:
	buffer_load_dwordx2 v[18:19], v3, s[44:47], s85 offen sc1
	buffer_load_dwordx2 v[20:21], v3, s[44:47], s86 offen sc1
	buffer_load_dwordx2 v[22:23], v3, s[44:47], s87 offen sc1
	s_waitcnt vmcnt(0)
	v_max3_u32 v26, v16, v17, v18
	v_max3_u32 v26, v26, v19, v20
	v_max3_u32 v26, v26, v21, v22
	v_max_u32 v26, v26, v23
	v_cmpx_eq_u32 vcc, -1, v26
	s_cbranch_execz L_h0_done
	s_sleep 2
	s_add_u32 s68, s68, 1
	s_cmp_lt_u32 s68, 131072
	s_cbranch_scc1 L_h0_again
L_h0_done:
	s_mov_b64 exec, -1
	v_pk_add_f32 v[16:17], v[16:17], v[18:19]
	v_pk_add_f32 v[20:21], v[20:21], v[22:23]
	v_pk_add_f32 v[16:17], v[16:17], v[20:21]
	v_cvt_pk_bf16_f32 v16, v16, v17
	s_nop 1
	v_mov_b32_dpp v20, v16 quad_perm:[0,0,0,0] row_mask:0xf bank_mask:0xf
	v_mov_b32_dpp v21, v16 quad_perm:[1,1,1,1] row_mask:0xf bank_mask:0xf
	v_mov_b32_dpp v22, v16 quad_perm:[2,2,2,2] row_mask:0xf bank_mask:0xf
	v_mov_b32_dpp v23, v16 quad_perm:[3,3,3,3] row_mask:0xf bank_mask:0xf
	v_dot2c_f32_bf16 v106, v20, v40
	v_dot2c_f32_bf16 v107, v20, v41
	v_dot2c_f32_bf16 v108, v20, v42
	v_dot2c_f32_bf16 v109, v20, v43
	v_dot2c_f32_bf16 v110, v20, v44
	v_dot2c_f32_bf16 v111, v20, v45
	v_dot2c_f32_bf16 v112, v20, v46
	v_dot2c_f32_bf16 v113, v20, v47
	v_dot2c_f32_bf16 v106, v21, v48
	v_dot2c_f32_bf16 v107, v21, v49
	v_dot2c_f32_bf16 v108, v21, v50
	v_dot2c_f32_bf16 v109, v21, v51
	v_dot2c_f32_bf16 v110, v21, v52
	v_dot2c_f32_bf16 v111, v21, v53
	v_dot2c_f32_bf16 v112, v21, v54
	v_dot2c_f32_bf16 v113, v21, v55
	v_dot2c_f32_bf16 v106, v22, v56
	v_dot2c_f32_bf16 v107, v22, v57
	v_dot2c_f32_bf16 v108, v22, v58
	v_dot2c_f32_bf16 v109, v22, v59
	v_dot2c_f32_bf16 v110, v22, v60
	v_dot2c_f32_bf16 v111, v22, v61
	v_dot2c_f32_bf16 v112, v22, v62
	v_dot2c_f32_bf16 v113, v22, v63
	v_dot2c_f32_bf16 v106, v23, v64
	v_dot2c_f32_bf16 v107, v23, v65
	v_dot2c_f32_bf16 v108, v23, v66
	v_dot2c_f32_bf16 v109, v23, v67
	v_dot2c_f32_bf16 v110, v23, v68
	v_dot2c_f32_bf16 v111, v23, v69
	v_dot2c_f32_bf16 v112, v23, v70
	v_dot2c_f32_bf16 v113, v23, v71
	v_permlane32_swap_b32 v106, v110
	v_permlane32_swap_b32 v107, v111
	v_permlane32_swap_b32 v108, v112
	v_permlane32_swap_b32 v109, v113
	v_add_f32 v106, v106, v110
	v_add_f32 v107, v107, v111
	v_add_f32 v108, v108, v112
	v_add_f32 v109, v109, v113
	s_nop 0
	v_permlane16_swap_b32 v106, v108
	v_permlane16_swap_b32 v107, v109
	v_add_f32 v106, v106, v108
	v_add_f32 v107, v107, v109
	s_nop 0
	v_add_f32_dpp v106, v106, v106 row_ror:8 row_mask:0xf bank_mask:0xf
	v_add_f32_dpp v107, v107, v107 row_ror:8 row_mask:0xf bank_mask:0xf
	s_nop 0
	v_add_f32_dpp v106, v106, v106 row_ror:4 row_mask:0xf bank_mask:0xf
	v_add_f32_dpp v107, v107, v107 row_ror:4 row_mask:0xf bank_mask:0xf
	s_mov_b32 exec_lo, 0xf000f
	s_mov_b32 exec_hi, 0xf000f
	buffer_store_dwordx2 v[106:107], v1, s[44:47], s66 offen sc1
	s_mov_b64 exec, -1
	s_cmp_eq_u32 s3, 7
	s_cbranch_scc1 L_taskR
	s_cmp_eq_u32 s3, 4
	s_cbranch_scc1 L_toG
	s_cmp_ge_u32 s38, 224
	s_cbranch_scc1 L_fin
	v_mov_b32 v106, 0
	v_mov_b32 v107, 0
	v_mov_b32 v108, 0
	v_mov_b32 v109, 0
	v_mov_b32 v110, 0
	v_mov_b32 v111, 0
	v_mov_b32 v112, 0
	v_mov_b32 v113, 0
	v_mov_b32 v114, 0
	v_mov_b32 v115, 0
	v_mov_b32 v116, 0
	v_mov_b32 v117, 0
	v_mov_b32 v118, 0
	v_mov_b32 v119, 0
	v_mov_b32 v120, 0
	v_mov_b32 v121, 0
	v_mov_b32 v16, 0
	v_mov_b32 v17, 0
	v_mov_b32 v18, 0
	v_mov_b32 v19, 0
	v_mov_b32 v20, 0
	v_mov_b32 v21, 0
	v_mov_b32 v22, 0
	v_mov_b32 v23, 0
	v_lshrrev_b32 v1, 3, v0
	v_mul_u32_u24 v1, 28672, v1
	v_and_b32 v2, 7, v0
	v_lshl_add_u32 v1, v2, 4, v1
	s_mul_i32 s66, s63, 458752
	s_lshl_b32 s61, s38, 7
	s_add_u32 s66, s66, s61
	s_add_u32 s66, s66, 622592
	s_add_u32 s67, s66, 229376
	s_lshl_b32 s60, s63, 11
	s_add_u32 s60, s60, 1638400
	s_lshl_b32 s61, s32, 12
	s_add_u32 s60, s60, s61
	s_mov_b32 s68, 0
L_poll_38:
	buffer_load_dwordx4 v[240:243], v5, s[44:47], s60 offen offset:0 sc1
	buffer_load_dwordx4 v[244:247], v5, s[44:47], s60 offen offset:1024 sc1
	s_waitcnt vmcnt(0)
	v_max3_u32 v8, v240, v241, v242
	v_max3_u32 v8, v8, v243, v244
	v_max3_u32 v8, v8, v245, v246
	v_max_u32 v8, v8, v247
	v_cmpx_eq_u32 vcc, -1, v8
	s_cbranch_execz L_poll_38_d
	s_add_u32 s68, s68, 1
	s_cmp_lt_u32 s68, 131072
	s_cbranch_scc1 L_poll_38
L_poll_38_d:
	s_mov_b64 exec, -1
	s_nop 1
	v_readfirstlane_b32 s60, v240
	s_nop 1
	v_pk_add_f32 v[24:25], v[240:241], s[60:61] op_sel_hi:[1,0] neg_lo:[0,1] neg_hi:[0,1]
	v_pk_add_f32 v[26:27], v[242:243], s[60:61] op_sel_hi:[1,0] neg_lo:[0,1] neg_hi:[0,1]
	v_pk_add_f32 v[28:29], v[244:245], s[60:61] op_sel_hi:[1,0] neg_lo:[0,1] neg_hi:[0,1]
	v_pk_add_f32 v[30:31], v[246:247], s[60:61] op_sel_hi:[1,0] neg_lo:[0,1] neg_hi:[0,1]
	v_pk_mul_f32 v[8:9], v[24:25], v[24:25]
	v_pk_add_f32 v[6:7], v[24:25], v[26:27]
	v_pk_fma_f32 v[8:9], v[26:27], v[26:27], v[8:9]
	v_pk_add_f32 v[6:7], v[6:7], v[28:29]
	v_pk_fma_f32 v[8:9], v[28:29], v[28:29], v[8:9]
	v_pk_add_f32 v[6:7], v[6:7], v[30:31]
	v_pk_fma_f32 v[8:9], v[30:31], v[30:31], v[8:9]
	v_add_f32 v6, v6, v7
	v_add_f32 v7, v8, v9
	s_nop 0
	v_add_f32_dpp v6, v6, v6 row_ror:8 row_mask:0xf bank_mask:0xf
	v_add_f32_dpp v7, v7, v7 row_ror:8 row_mask:0xf bank_mask:0xf
	s_nop 0
	v_add_f32_dpp v6, v6, v6 row_ror:4 row_mask:0xf bank_mask:0xf
	v_add_f32_dpp v7, v7, v7 row_ror:4 row_mask:0xf bank_mask:0xf
	s_nop 0
	v_add_f32_dpp v6, v6, v6 row_ror:2 row_mask:0xf bank_mask:0xf
	v_add_f32_dpp v7, v7, v7 row_ror:2 row_mask:0xf bank_mask:0xf
	s_nop 0
	v_add_f32_dpp v6, v6, v6 row_ror:1 row_mask:0xf bank_mask:0xf
	v_add_f32_dpp v7, v7, v7 row_ror:1 row_mask:0xf bank_mask:0xf
	s_nop 0
	v_add_f32_dpp v6, v6, v6 row_bcast:15 row_mask:0xa bank_mask:0xf
	v_add_f32_dpp v7, v7, v7 row_bcast:15 row_mask:0xa bank_mask:0xf
	s_nop 0
	v_add_f32_dpp v6, v6, v6 row_bcast:31 row_mask:0xc bank_mask:0xf
	v_add_f32_dpp v7, v7, v7 row_bcast:31 row_mask:0xc bank_mask:0xf
	v_readlane_b32 s61, v6, 63
	v_readlane_b32 s62, v7, 63
	v_mov_b32 v8, 0x3b000000
	v_mul_f32 v6, s61, v8
	v_mul_f32 v8, s62, v8
	v_fma_f32 v8, -v6, v6, v8
	v_add_f32 v6, s60, v6
	v_max_f32 v8, 0, v8
	v_sub_f32 v6, 0, v6
	v_cvt_pk_bf16_f32 v8, 0, v8
	v_cvt_pk_bf16_f32 v6, 0, v6
	v_add_f32 v8, 0x3727c5ac, v8
	v_cvt_pk_bf16_f32 v8, 0, v8
	v_sqrt_f32 v8, v8
	s_nop 0
	v_cvt_pk_bf16_f32 v8, 0, v8
	v_rcp_f32 v8, v8
	v_pk_add_f32 v[240:241], v[240:241], v[6:7] op_sel_hi:[1,0]
	v_pk_add_f32 v[242:243], v[242:243], v[6:7] op_sel_hi:[1,0]
	v_pk_add_f32 v[244:245], v[244:245], v[6:7] op_sel_hi:[1,0]
	v_pk_add_f32 v[246:247], v[246:247], v[6:7] op_sel_hi:[1,0]
	v_cvt_pk_bf16_f32 v240, 0, v240
	v_cvt_pk_bf16_f32 v241, 0, v241
	v_cvt_pk_bf16_f32 v242, 0, v242
	v_cvt_pk_bf16_f32 v243, 0, v243
	v_cvt_pk_bf16_f32 v244, 0, v244
	v_cvt_pk_bf16_f32 v245, 0, v245
	v_cvt_pk_bf16_f32 v246, 0, v246
	v_cvt_pk_bf16_f32 v247, 0, v247
	v_pk_mul_f32 v[240:241], v[240:241], v[8:9] op_sel_hi:[1,0]
	v_pk_mul_f32 v[242:243], v[242:243], v[8:9] op_sel_hi:[1,0]
	v_pk_mul_f32 v[244:245], v[244:245], v[8:9] op_sel_hi:[1,0]
	v_pk_mul_f32 v[246:247], v[246:247], v[8:9] op_sel_hi:[1,0]
	v_cvt_pk_bf16_f32 v240, 0, v240
	v_cvt_pk_bf16_f32 v241, 0, v241
	v_cvt_pk_bf16_f32 v242, 0, v242
	v_cvt_pk_bf16_f32 v243, 0, v243
	v_cvt_pk_bf16_f32 v244, 0, v244
	v_cvt_pk_bf16_f32 v245, 0, v245
	v_cvt_pk_bf16_f32 v246, 0, v246
	v_cvt_pk_bf16_f32 v247, 0, v247
	v_pk_mul_f32 v[240:241], v[240:241], v[224:225]
	v_pk_mul_f32 v[242:243], v[242:243], v[226:227]
	v_pk_mul_f32 v[244:245], v[244:245], v[228:229]
	v_pk_mul_f32 v[246:247], v[246:247], v[230:231]
	v_cvt_pk_bf16_f32 v240, 0, v240
	v_cvt_pk_bf16_f32 v241, 0, v241
	v_cvt_pk_bf16_f32 v242, 0, v242
	v_cvt_pk_bf16_f32 v243, 0, v243
	v_cvt_pk_bf16_f32 v244, 0, v244
	v_cvt_pk_bf16_f32 v245, 0, v245
	v_cvt_pk_bf16_f32 v246, 0, v246
	v_cvt_pk_bf16_f32 v247, 0, v247
	v_pk_add_f32 v[240:241], v[240:241], v[232:233]
	v_pk_add_f32 v[242:243], v[242:243], v[234:235]
	v_pk_add_f32 v[244:245], v[244:245], v[236:237]
	v_pk_add_f32 v[246:247], v[246:247], v[238:239]
	v_cvt_pk_bf16_f32 v24, v240, v241
	v_cvt_pk_bf16_f32 v25, v242, v243
	v_cvt_pk_bf16_f32 v26, v244, v245
	v_cvt_pk_bf16_f32 v27, v246, v247
	v_dot2c_f32_bf16 v106, v24, v128
	v_dot2c_f32_bf16 v107, v24, v129
	v_dot2c_f32_bf16 v108, v24, v130
	v_dot2c_f32_bf16 v109, v24, v131
	v_dot2c_f32_bf16 v110, v24, v132
	v_dot2c_f32_bf16 v111, v24, v133
	v_dot2c_f32_bf16 v112, v24, v134
	v_dot2c_f32_bf16 v113, v24, v135
	v_dot2c_f32_bf16 v114, v24, v136
	v_dot2c_f32_bf16 v115, v24, v137
	v_dot2c_f32_bf16 v116, v24, v138
	v_dot2c_f32_bf16 v117, v24, v139
	v_dot2c_f32_bf16 v118, v24, v140
	v_dot2c_f32_bf16 v119, v24, v141
	v_dot2c_f32_bf16 v120, v24, v142
	v_dot2c_f32_bf16 v121, v24, v143
	v_dot2c_f32_bf16 v106, v25, v144
	v_dot2c_f32_bf16 v107, v25, v145
	v_dot2c_f32_bf16 v108, v25, v146
	v_dot2c_f32_bf16 v109, v25, v147
	v_dot2c_f32_bf16 v110, v25, v148
	v_dot2c_f32_bf16 v111, v25, v149
	v_dot2c_f32_bf16 v112, v25, v150
	v_dot2c_f32_bf16 v113, v25, v151
	v_dot2c_f32_bf16 v114, v25, v152
	v_dot2c_f32_bf16 v115, v25, v153
	v_dot2c_f32_bf16 v116, v25, v154
	v_dot2c_f32_bf16 v117, v25, v155
	v_dot2c_f32_bf16 v118, v25, v156
	v_dot2c_f32_bf16 v119, v25, v157
	v_dot2c_f32_bf16 v120, v25, v158
	v_dot2c_f32_bf16 v121, v25, v159
	v_dot2c_f32_bf16 v106, v26, v160
	v_dot2c_f32_bf16 v107, v26, v161
	v_dot2c_f32_bf16 v108, v26, v162
	v_dot2c_f32_bf16 v109, v26, v163
	v_dot2c_f32_bf16 v110, v26, v164
	v_dot2c_f32_bf16 v111, v26, v165
	v_dot2c_f32_bf16 v112, v26, v166
	v_dot2c_f32_bf16 v113, v26, v167
	v_dot2c_f32_bf16 v114, v26, v168
	v_dot2c_f32_bf16 v115, v26, v169
	v_dot2c_f32_bf16 v116, v26, v170
	v_dot2c_f32_bf16 v117, v26, v171
	v_dot2c_f32_bf16 v118, v26, v172
	v_dot2c_f32_bf16 v119, v26, v173
	v_dot2c_f32_bf16 v120, v26, v174
	v_dot2c_f32_bf16 v121, v26, v175
	v_dot2c_f32_bf16 v106, v27, v176
	v_dot2c_f32_bf16 v107, v27, v177
	v_dot2c_f32_bf16 v108, v27, v178
	v_dot2c_f32_bf16 v109, v27, v179
	v_dot2c_f32_bf16 v110, v27, v180
	v_dot2c_f32_bf16 v111, v27, v181
	v_dot2c_f32_bf16 v112, v27, v182
	v_dot2c_f32_bf16 v113, v27, v183
	v_dot2c_f32_bf16 v114, v27, v184
	v_dot2c_f32_bf16 v115, v27, v185
	v_dot2c_f32_bf16 v116, v27, v186
	v_dot2c_f32_bf16 v117, v27, v187
	v_dot2c_f32_bf16 v118, v27, v188
	v_dot2c_f32_bf16 v119, v27, v189
	v_dot2c_f32_bf16 v120, v27, v190
	v_dot2c_f32_bf16 v121, v27, v191
	v_permlane32_swap_b32 v106, v114
	v_permlane32_swap_b32 v107, v115
	v_permlane32_swap_b32 v108, v116
	v_permlane32_swap_b32 v109, v117
	v_permlane32_swap_b32 v110, v118
	v_permlane32_swap_b32 v111, v119
	v_permlane32_swap_b32 v112, v120
	v_permlane32_swap_b32 v113, v121
	v_add_f32 v106, v106, v114
	v_add_f32 v107, v107, v115
	v_add_f32 v108, v108, v116
	v_add_f32 v109, v109, v117
	v_add_f32 v110, v110, v118
	v_add_f32 v111, v111, v119
	v_add_f32 v112, v112, v120
	v_add_f32 v113, v113, v121
	v_permlane16_swap_b32 v106, v110
	v_permlane16_swap_b32 v107, v111
	v_permlane16_swap_b32 v108, v112
	v_permlane16_swap_b32 v109, v113
	v_add_f32 v106, v106, v110
	v_add_f32 v107, v107, v111
	v_add_f32 v108, v108, v112
	v_add_f32 v109, v109, v113
	v_add_f32_dpp v106, v106, v106 row_ror:8 row_mask:0xf bank_mask:0xf
	v_add_f32_dpp v107, v107, v107 row_ror:8 row_mask:0xf bank_mask:0xf
	v_add_f32_dpp v108, v108, v108 row_ror:8 row_mask:0xf bank_mask:0xf
	v_add_f32_dpp v109, v109, v109 row_ror:8 row_mask:0xf bank_mask:0xf
	v_add_f32_dpp v106, v106, v106 row_ror:4 row_mask:0xf bank_mask:0xf
	v_add_f32_dpp v107, v107, v107 row_ror:4 row_mask:0xf bank_mask:0xf
	v_add_f32_dpp v108, v108, v108 row_ror:4 row_mask:0xf bank_mask:0xf
	v_add_f32_dpp v109, v109, v109 row_ror:4 row_mask:0xf bank_mask:0xf
	v_add_f32_dpp v106, v106, v106 row_ror:2 row_mask:0xf bank_mask:0xf
	v_add_f32_dpp v107, v107, v107 row_ror:2 row_mask:0xf bank_mask:0xf
	v_add_f32_dpp v108, v108, v108 row_ror:2 row_mask:0xf bank_mask:0xf
	v_add_f32_dpp v109, v109, v109 row_ror:2 row_mask:0xf bank_mask:0xf
	v_add_f32_dpp v106, v106, v106 row_ror:1 row_mask:0xf bank_mask:0xf
	v_add_f32_dpp v107, v107, v107 row_ror:1 row_mask:0xf bank_mask:0xf
	v_add_f32_dpp v108, v108, v108 row_ror:1 row_mask:0xf bank_mask:0xf
	v_add_f32_dpp v109, v109, v109 row_ror:1 row_mask:0xf bank_mask:0xf
	v_cvt_pk_bf16_f32 v106, 0, v106
	v_cvt_pk_bf16_f32 v107, 0, v107
	v_cvt_pk_bf16_f32 v108, 0, v108
	v_cvt_pk_bf16_f32 v109, 0, v109
	v_mov_b32 v110, v106
	v_mov_b32 v111, v107
	v_mov_b32 v112, v108
	v_mov_b32 v113, v109
	v_permlane32_swap_b32 v106, v110
	v_permlane32_swap_b32 v107, v111
	v_permlane32_swap_b32 v108, v112
	v_permlane32_swap_b32 v109, v113
	v_pk_mul_f32 v[106:107], v[106:107], v[110:111]
	v_pk_mul_f32 v[108:109], v[108:109], v[112:113]
	v_cvt_pk_bf16_f32 v6, v106, v107
	v_cvt_pk_bf16_f32 v7, v108, v109
	v_readlane_b32 s60, v6, 0
	v_readlane_b32 s61, v7, 0
	v_readlane_b32 s62, v6, 16
	v_readlane_b32 s63, v7, 16
	v_dot2c_f32_bf16 v16, s60, v192
	v_dot2c_f32_bf16 v17, s60, v193
	v_dot2c_f32_bf16 v18, s60, v194
	v_dot2c_f32_bf16 v19, s60, v195
	v_dot2c_f32_bf16 v20, s60, v196
	v_dot2c_f32_bf16 v21, s60, v197
	v_dot2c_f32_bf16 v22, s60, v198
	v_dot2c_f32_bf16 v23, s60, v199
	v_dot2c_f32_bf16 v16, s61, v200
	v_dot2c_f32_bf16 v17, s61, v201
	v_dot2c_f32_bf16 v18, s61, v202
	v_dot2c_f32_bf16 v19, s61, v203
	v_dot2c_f32_bf16 v20, s61, v204
	v_dot2c_f32_bf16 v21, s61, v205
	v_dot2c_f32_bf16 v22, s61, v206
	v_dot2c_f32_bf16 v23, s61, v207
	v_dot2c_f32_bf16 v16, s62, v208
	v_dot2c_f32_bf16 v17, s62, v209
	v_dot2c_f32_bf16 v18, s62, v210
	v_dot2c_f32_bf16 v19, s62, v211
	v_dot2c_f32_bf16 v20, s62, v212
	v_dot2c_f32_bf16 v21, s62, v213
	v_dot2c_f32_bf16 v22, s62, v214
	v_dot2c_f32_bf16 v23, s62, v215
	v_dot2c_f32_bf16 v16, s63, v216
	v_dot2c_f32_bf16 v17, s63, v217
	v_dot2c_f32_bf16 v18, s63, v218
	v_dot2c_f32_bf16 v19, s63, v219
	v_dot2c_f32_bf16 v20, s63, v220
	v_dot2c_f32_bf16 v21, s63, v221
	v_dot2c_f32_bf16 v22, s63, v222
	v_dot2c_f32_bf16 v23, s63, v223
	buffer_store_dwordx4 v[16:19], v1, s[44:47], s66 offen sc1
	s_nop 1
	buffer_store_dwordx4 v[20:23], v1, s[44:47], s67 offen sc1
	s_cmp_ge_u32 s39, 32
	s_cbranch_scc1 L_fin
	s_waitcnt vmcnt(0)
	s_branch L_taskG
L_taskR:
	s_cmp_ge_u32 s39, 32
	s_cbranch_scc1 L_fin
	v_lshlrev_b32 v1, 4, v0
	s_lshl_b32 s60, s39, 12
	s_add_u32 s60, s60, 491520
	s_lshl_b32 s61, s39, 7
	s_add_u32 s61, s61, 1638400
	v_bfe_u32 v2, v0, 3, 1
	v_lshl_add_u32 v2, v2, 12, v5
	s_add_u32 s62, s61, 8192
	s_add_u32 s63, s61, 16384
	s_add_u32 s64, s61, 24576
	s_mov_b32 s68, 0
L_poll_39:
	buffer_load_dwordx4 v[16:19], v1, s[44:47], s60 offen offset:0 sc1
	buffer_load_dwordx4 v[20:23], v1, s[44:47], s60 offen offset:1024 sc1
	buffer_load_dwordx4 v[24:27], v1, s[44:47], s60 offen offset:2048 sc1
	buffer_load_dwordx4 v[28:31], v1, s[44:47], s60 offen offset:3072 sc1
	s_waitcnt vmcnt(0)
	v_max3_u32 v8, v16, v17, v18
	v_max3_u32 v8, v8, v19, v20
	v_max3_u32 v8, v8, v21, v22
	v_max3_u32 v8, v8, v23, v24
	v_max3_u32 v8, v8, v25, v26
	v_max3_u32 v8, v8, v27, v28
	v_max3_u32 v8, v8, v29, v30
	v_max_u32 v8, v8, v31
	v_cmpx_eq_u32 vcc, -1, v8
	s_cbranch_execz L_poll_39_d
	s_add_u32 s68, s68, 1
	s_cmp_lt_u32 s68, 131072
	s_cbranch_scc1 L_poll_39
L_poll_39_d:
	s_mov_b64 exec, -1
	v_pk_add_f32 v[16:17], v[16:17], v[20:21]
	v_pk_add_f32 v[18:19], v[18:19], v[22:23]
	v_pk_add_f32 v[24:25], v[24:25], v[28:29]
	v_pk_add_f32 v[26:27], v[26:27], v[30:31]
	v_pk_add_f32 v[16:17], v[16:17], v[24:25]
	v_pk_add_f32 v[18:19], v[18:19], v[26:27]
	s_nop 1
	v_permlane32_swap_b32 v16, v18
	v_permlane32_swap_b32 v17, v19
	v_add_f32 v16, v16, v18
	v_add_f32 v17, v17, v19
	s_nop 1
	v_permlane16_swap_b32 v16, v17
	v_add_f32 v16, v16, v17
	s_nop 1
	v_add_f32_dpp v16, v16, v16 row_ror:8 row_mask:0xf bank_mask:0xf
	v_cvt_pk_bf16_f32 v16, 0, v16
	v_mul_f32 v16, v32, v16
	v_cvt_pk_bf16_f32 v16, 0, v16
	v_add_f32 v16, v34, v16
	v_cvt_pk_bf16_f32 v34, 0, v16
	buffer_store_dword v34, v2, s[44:47], s61 offen sc1
	buffer_store_dword v34, v2, s[44:47], s62 offen sc1
	buffer_store_dword v34, v2, s[44:47], s63 offen sc1
	buffer_store_dword v34, v2, s[44:47], s64 offen sc1
	s_mov_b64 exec, -1
L_toG:
	s_cmp_ge_u32 s39, 32
	s_cbranch_scc1 L_fin
L_taskG:
	s_mov_b32 s56, s26
	s_mov_b32 s57, s27
	s_mov_b32 s58, 2048
	s_mov_b32 s59, 0x20000
	v_lshlrev_b32 v1, 4, v0
	s_mul_i32 s60, s39, 28672
	s_sub_u32 s61, s3, 4
	s_mul_i32 s62, s61, 7168
	s_add_u32 s60, s60, s62
	s_add_u32 s60, s60, 622592
	s_add_u32 s62, s60, 4096
	v_and_b32 v2, 7, v0
	v_lshlrev_b32 v2, 2, v2
	v_lshl_add_u32 v2, v13, 1, v2
	v_add_lshl_u32 v2, v2, v12, 2
	s_lshl_b32 s61, s61, 7
	v_add_u32 v3, s61, v2
	s_barrier
	s_mov_b32 s68, 0
L_poll_40:
	buffer_load_dwordx4 v[128:131], v1, s[44:47], s60 offen offset:0 sc1
	buffer_load_dwordx4 v[132:135], v1, s[44:47], s60 offen offset:1024 sc1
	buffer_load_dwordx4 v[136:139], v1, s[44:47], s60 offen offset:2048 sc1
	buffer_load_dwordx4 v[140:143], v1, s[44:47], s60 offen offset:3072 sc1
	buffer_load_dwordx4 v[144:147], v1, s[44:47], s62 offen offset:0 sc1
	buffer_load_dwordx4 v[148:151], v1, s[44:47], s62 offen offset:1024 sc1
	buffer_load_dwordx4 v[152:155], v1, s[44:47], s62 offen offset:2048 sc1
	s_waitcnt vmcnt(0)
	v_max3_u32 v8, v128, v129, v130
	v_max3_u32 v8, v8, v131, v132
	v_max3_u32 v8, v8, v133, v134
	v_max3_u32 v8, v8, v135, v136
	v_max3_u32 v8, v8, v137, v138
	v_max3_u32 v8, v8, v139, v140
	v_max3_u32 v8, v8, v141, v142
	v_max3_u32 v8, v8, v143, v144
	v_max3_u32 v8, v8, v145, v146
	v_max3_u32 v8, v8, v147, v148
	v_max3_u32 v8, v8, v149, v150
	v_max3_u32 v8, v8, v151, v152
	v_max3_u32 v8, v8, v153, v154
	v_max_u32 v8, v8, v155
	v_cmpx_eq_u32 vcc, -1, v8
	s_cbranch_execz L_poll_40_d
	s_add_u32 s68, s68, 1
	s_cmp_lt_u32 s68, 131072
	s_cbranch_scc1 L_poll_40
L_poll_40_d:
	s_mov_b64 exec, -1
	v_pk_add_f32 v[128:129], v[128:129], v[132:133]
	v_pk_add_f32 v[130:131], v[130:131], v[134:135]
	v_pk_add_f32 v[136:137], v[136:137], v[140:141]
	v_pk_add_f32 v[138:139], v[138:139], v[142:143]
	v_pk_add_f32 v[144:145], v[144:145], v[148:149]
	v_pk_add_f32 v[146:147], v[146:147], v[150:151]
	v_pk_add_f32 v[128:129], v[128:129], v[136:137]
	v_pk_add_f32 v[130:131], v[130:131], v[138:139]
	v_pk_add_f32 v[144:145], v[144:145], v[152:153]
	v_pk_add_f32 v[146:147], v[146:147], v[154:155]
	v_pk_add_f32 v[128:129], v[128:129], v[144:145]
	v_pk_add_f32 v[130:131], v[130:131], v[146:147]
	s_nop 1
	v_permlane32_swap_b32 v128, v130
	v_permlane32_swap_b32 v129, v131
	v_add_f32 v128, v128, v130
	v_add_f32 v129, v129, v131
	s_nop 1
	v_permlane16_swap_b32 v128, v129
	v_add_f32 v128, v128, v129
	s_nop 1
	v_add_f32_dpp v128, v128, v128 row_ror:8 row_mask:0xf bank_mask:0xf
	ds_write_b32 v3, v128 offset:2560
	s_waitcnt lgkmcnt(0)
	s_barrier
	s_cmp_lg_u32 s3, 7
	s_cbranch_scc1 L_fin
	ds_read_b32 v16, v2 offset:2560
	ds_read_b32 v17, v2 offset:2688
	ds_read_b32 v18, v2 offset:2816
	ds_read_b32 v19, v2 offset:2944
	s_lshl_b32 s60, s39, 6
	s_waitcnt lgkmcnt(0)
	v_pk_add_f32 v[16:17], v[16:17], v[18:19]
	v_add_f32 v16, v16, v17
	v_cvt_pk_bf16_f32 v16, 0, v16
	v_mul_f32 v16, v33, v16
	v_cvt_pk_bf16_f32 v16, 0, v16
	v_add_f32 v16, v34, v16
	v_cvt_pk_bf16_f32 v16, v16, v16
	s_mov_b32 exec_lo, 0xff00ff
	s_mov_b32 exec_hi, 0xff00ff
	buffer_store_short v16, v6, s[56:59], s60 offen
L_fin:
	s_endpgm
.section .rodata,"a"
.p2align 6
.amdhsa_kernel adaLN_cond__mha_block_cached__glu_gated_bilinear__decode_kernel
.amdhsa_next_free_vgpr 256
.amdhsa_next_free_sgpr 102
.amdhsa_accum_offset 256
.amdhsa_group_segment_fixed_size 0
.amdhsa_kernarg_size 112
.amdhsa_user_sgpr_count 2
.amdhsa_user_sgpr_kernarg_segment_ptr 1
.amdhsa_system_sgpr_workgroup_id_x 1
.end_amdhsa_kernel
```
